```python
import torch

def _softmax(x, axis=-1):
    return torch.softmax(x, dim=axis)

def _gelu(x):
    return torch.nn.functional.gelu(x, approximate='tanh')

def _silu(x):
    return torch.nn.functional.silu(x)

def _sigmoid(x):
    return torch.sigmoid(x)

def _layernorm(x, axis=-1, eps=1e-05):
    m = x.mean(dim=axis, keepdim=True)
    v = x.var(dim=axis, keepdim=True, unbiased=False)
    return (x - m) / torch.sqrt(v + eps)

def _scatter_add(tgt, idx, src, axis=0):
    return tgt.clone().index_add_(axis, idx, src)

def _segment_sum(src, seg, n):
    out = torch.zeros((n,) + src.shape[1:], dtype=src.dtype)
    return out.index_add_(0, seg, src)

def _pad(x, pw):
    flat = tuple((v for pair in reversed(pw) for v in pair))
    return torch.nn.functional.pad(x, flat)
kernel_name = 'interleave_layers__memory_aug_recurrent_mem_tr__sliding_local_dilated__prompt'

def setup_inputs():

    _w = lambda a: (lambda t: t.to(torch.bfloat16) if t.is_floating_point() else t)(torch.as_tensor(a))

    def _A_setup():
        B, S, Dm = (1, 2048, 512)
        H, Dh = (32, 128)
        M, seg = (8, 32)
        seg = min(seg, S)
        S = S // seg * seg
        return {'x': _w((lambda *s: torch.randn(*s, dtype=torch.bfloat16) * 0.05)(B, S, Dm)), 'mem0': _w((lambda *s: torch.randn(*s, dtype=torch.bfloat16) * 0.8)(B, M, Dm)), 'Wq': _w((lambda *s: torch.randn(*s, dtype=torch.bfloat16) * 0.8)(Dm, H, Dh) * Dm ** (-0.5)), 'Wk': _w((lambda *s: torch.randn(*s, dtype=torch.bfloat16) * 0.8)(Dm, H, Dh) * Dm ** (-0.5)), 'Wv': _w((lambda *s: torch.randn(*s, dtype=torch.bfloat16) * 0.8)(Dm, H, Dh) * Dm ** (-0.5)), 'Wo': _w((lambda *s: torch.randn(*s, dtype=torch.bfloat16) * 0.8)(H, Dh, Dm) * (H * Dh) ** (-0.5)), 'seg_len': seg}
    _A_in = _A_setup()

    def _B_setup():
        B, S, D = (1, 2048, 512)
        return {'x': _w((lambda *s: torch.randn(*s, dtype=torch.bfloat16) * 0.05)(B, S, D)), 'wqkv': _w((lambda *s: torch.randn(*s, dtype=torch.bfloat16) * 0.05)(D, 3 * D)), 'wo': _w((lambda *s: torch.randn(*s, dtype=torch.bfloat16) * 0.05)(D, D))}
    _B_in = _B_setup()
    return {'A_x': _A_in['x'], 'A_mem0': _A_in['mem0'], 'A_Wq': _A_in['Wq'], 'A_Wk': _A_in['Wk'], 'A_Wv': _A_in['Wv'], 'A_Wo': _A_in['Wo'], 'A_seg_len': _A_in['seg_len'], 'B_x': _B_in['x'], 'B_wqkv': _B_in['wqkv'], 'B_wo': _B_in['wo']}

def reference(A_x, A_mem0, A_Wq, A_Wk, A_Wv, A_Wo, A_seg_len, B_x, B_wqkv, B_wo):

    def _A_ref(x, mem0, Wq, Wk, Wv, Wo, seg_len):
        B, S, Dm = x.shape
        H, Dh = (Wq.shape[1], Wq.shape[2])
        M = mem0.shape[1]
        scale = Dh ** (-0.5)
        n_seg = S // seg_len
        L = M + seg_len
        idx = torch.arange(L)
        mask = (idx[:, None] < M) | (idx[:, None] >= idx[None, :])
        mem = mem0
        outs = []
        for s in range(n_seg):
            xs = x[:, s * seg_len:(s + 1) * seg_len, :].clone()
            h = torch.concatenate([mem, xs], axis=1)
            q = torch.einsum('btd,dhe->bhte', h, Wq)
            k = torch.einsum('btd,dhe->bhte', h, Wk)
            v = torch.einsum('btd,dhe->bhte', h, Wv)
            scores = torch.einsum('bhqe,bhke->bhqk', q, k) * scale
            scores = torch.where(mask[None, None], scores, -1000000000.0)
            p = _softmax(scores, axis=-1)
            o = torch.einsum('bhqk,bhke->bhqe', p, v)
            o = torch.einsum('bhte,hed->btd', o, Wo)
            mem = o[:, :M, :].clone()
            outs.append(o[:, M:, :])
        return torch.concatenate(outs, axis=1)

    def _B_ref(x, wqkv, wo):
        B, S, D = x.shape
        H = 32
        Dh = D // H
        W, dil = (8, 2)
        qkv = (lambda x, *d: x.permute(*d))((x @ wqkv).reshape(B, S, 3, H, Dh), 2, 0, 3, 1, 4)
        q, k, v = (qkv[0], qkv[1], qkv[2])
        scale = Dh ** (-0.5)
        pos = torch.arange(S)
        off = torch.arange(W) * dil
        idx = pos[:, None] - off[None, :]
        mask = idx >= 0
        idx_c = torch.where(mask, idx, 0).reshape(-1)
        kg = k[:, :, idx_c, :].reshape(B, H, S, W, Dh)
        vg = v[:, :, idx_c, :].reshape(B, H, S, W, Dh)
        logits = torch.einsum('bhsd,bhswd->bhsw', q, kg) * scale
        logits = torch.where(mask[None, None, :, :], logits, -1000000000.0)
        attn = _softmax(logits, axis=-1)
        o = torch.einsum('bhsw,bhswd->bhsd', attn, vg)
        return (lambda x, *d: x.permute(*d))(o, 0, 2, 1, 3).reshape(B, S, D) @ wo
    x = A_x
    x = x + _A_ref(_layernorm(x, axis=-1), A_mem0, A_Wq, A_Wk, A_Wv, A_Wo, A_seg_len)
    x = x + _B_ref(_layernorm(x, axis=-1), B_wqkv, B_wo)
    x = x + _A_ref(_layernorm(x, axis=-1), A_mem0, A_Wq, A_Wk, A_Wv, A_Wo, A_seg_len)
    x = x + _B_ref(_layernorm(x, axis=-1), B_wqkv, B_wo)
    return x
```

```asm
; @launch grid=(256,1,1) block=(256,1,1) lds=163840
.amdgcn_target "amdgcn-amd-amdhsa--gfx950"
.text
.globl interleave_layers__memory_aug_recurrent_mem_tr__sliding_local_dilated__prompt_kernel
.p2align 8
.type interleave_layers__memory_aug_recurrent_mem_tr__sliding_local_dilated__prompt_kernel,@function
interleave_layers__memory_aug_recurrent_mem_tr__sliding_local_dilated__prompt_kernel:
 s_cmp_ge_u32 s2, 256
 s_cbranch_scc1 L_exit
 s_load_dwordx16 s[4:19], s[0:1], 0
 s_load_dwordx8 s[20:27], s[0:1], 64
 s_load_dwordx2 s[28:29], s[0:1], 96
 s_getreg_b32 s44, hwreg(HW_REG_XCC_ID, 0, 4)
 v_lshrrev_b32 v1, 6, v0
 s_nop 0
 v_readfirstlane_b32 s46, v1
 s_mov_b32 s3, 1
 s_mov_b32 s31, 0
 s_waitcnt lgkmcnt(0)
 s_mov_b32 s32, s28
 s_mov_b32 s33, s29
 s_mov_b32 s34, 0x10000000
 s_mov_b32 s35, 0x20000
 s_cmp_lg_u32 s46, 0
 s_cbranch_scc1 L_notw0
 s_mov_b32 s45, 1
 s_mul_i32 s49, s44, 43
 s_lshr_b32 s49, s49, 7
 s_mul_i32 s48, s49, 3
 s_sub_u32 s48, s44, s48
 s_lshl_b32 s48, s48, 6
 s_lshl_b32 s49, s49, 2
 s_add_u32 s48, s48, s49
 s_cmp_gt_u32 s44, 7
 s_cselect_b32 s48, 12, s48
 s_atomic_add s45, s[26:27], s48 glc
 s_waitcnt lgkmcnt(0)
 s_cmp_gt_u32 s44, 7
 s_cselect_b32 s45, 32, s45
 s_cmp_lt_u32 s45, 32
 s_cbranch_scc1 L_haverole
 s_mov_b32 s30, 0
L_cnt_1:
 s_load_dwordx4 s[72:75], s[26:27], 0 glc
 s_load_dwordx4 s[76:79], s[26:27], 64 glc
 s_load_dwordx4 s[80:83], s[26:27], 128 glc
 s_add_u32 s30, s30, 1
 s_cmp_gt_u32 s30, 524288
 s_cbranch_scc1 L_exit
 s_waitcnt lgkmcnt(0)
 s_mov_b32 s54, s75
 s_add_u32 s54, s54, s72
 s_add_u32 s54, s54, s76
 s_add_u32 s54, s54, s80
 s_add_u32 s54, s54, s73
 s_add_u32 s54, s54, s77
 s_add_u32 s54, s54, s81
 s_add_u32 s54, s54, s74
 s_add_u32 s54, s54, s78
 s_sleep 4
 s_cmp_lt_u32 s54, 256
 s_cbranch_scc1 L_cnt_1
 s_mov_b32 s49, 1
 s_atomic_add s49, s[26:27], 0x4c glc
 s_waitcnt lgkmcnt(0)
 s_mov_b32 s44, 0
 s_min_u32 s54, s72, 32
 s_add_u32 s45, s54, s49
 s_cmp_lt_u32 s45, 32
 s_cbranch_scc1 L_haverole
 s_sub_u32 s49, s45, 32
 s_mov_b32 s44, 1
 s_min_u32 s54, s76, 32
 s_add_u32 s45, s54, s49
 s_cmp_lt_u32 s45, 32
 s_cbranch_scc1 L_haverole
 s_sub_u32 s49, s45, 32
 s_mov_b32 s44, 2
 s_min_u32 s54, s80, 32
 s_add_u32 s45, s54, s49
 s_cmp_lt_u32 s45, 32
 s_cbranch_scc1 L_haverole
 s_sub_u32 s49, s45, 32
 s_mov_b32 s44, 3
 s_min_u32 s54, s73, 32
 s_add_u32 s45, s54, s49
 s_cmp_lt_u32 s45, 32
 s_cbranch_scc1 L_haverole
 s_sub_u32 s49, s45, 32
 s_mov_b32 s44, 4
 s_min_u32 s54, s77, 32
 s_add_u32 s45, s54, s49
 s_cmp_lt_u32 s45, 32
 s_cbranch_scc1 L_haverole
 s_sub_u32 s49, s45, 32
 s_mov_b32 s44, 5
 s_min_u32 s54, s81, 32
 s_add_u32 s45, s54, s49
 s_cmp_lt_u32 s45, 32
 s_cbranch_scc1 L_haverole
 s_sub_u32 s49, s45, 32
 s_mov_b32 s44, 6
 s_min_u32 s54, s74, 32
 s_add_u32 s45, s54, s49
 s_cmp_lt_u32 s45, 32
 s_cbranch_scc1 L_haverole
 s_sub_u32 s49, s45, 32
 s_mov_b32 s44, 7
 s_min_u32 s54, s78, 32
 s_add_u32 s45, s54, s49
 s_cmp_lt_u32 s45, 32
 s_cbranch_scc1 L_haverole
 s_sub_u32 s49, s45, 32
 s_mov_b32 s44, 8
L_haverole:
 s_lshl_b32 s48, s44, 8
 s_or_b32 s48, s48, s45
 v_mov_b32 v1, s48
 v_mov_b32 v2, 0x27ff0
 ds_write_b32 v2, v1
 s_waitcnt lgkmcnt(0)
 s_branch L_bar0
L_notw0:
L_bar0:
 s_barrier
 v_mov_b32 v2, 0x27ff0
 ds_read_b32 v1, v2
 s_waitcnt lgkmcnt(0)
 v_readfirstlane_b32 s48, v1
 s_barrier
 s_and_b32 s45, s48, 31
 s_lshr_b32 s44, s48, 8
 s_cmp_gt_u32 s44, 7
 s_cbranch_scc1 L_exit
 s_cmp_lg_u32 s44, 0
 s_cbranch_scc1 L_ng_2
 s_mov_b32 s47, 0
 s_mov_b32 s51, 0
 s_branch L_wa
L_ng_2:
 s_cmp_lg_u32 s44, 1
 s_cbranch_scc1 L_ng_3
 s_mov_b32 s47, 1
 s_mov_b32 s51, 0
 s_branch L_wa
L_ng_3:
 s_cmp_lg_u32 s44, 2
 s_cbranch_scc1 L_ng_4
 s_mov_b32 s47, 1
 s_mov_b32 s51, 0
 s_mov_b32 s50, 0
 s_getpc_b64 s[98:99]
 s_branch L_init
 s_branch L_chain
L_ng_4:
 s_cmp_lg_u32 s44, 3
 s_cbranch_scc1 L_ng_5
 s_mov_b32 s47, 0
 s_mov_b32 s51, 0
 s_branch L_chain
L_ng_5:
 s_cmp_lg_u32 s44, 4
 s_cbranch_scc1 L_ng_6
 s_mov_b32 s47, 0
 s_mov_b32 s51, 1
 s_branch L_wa
L_ng_6:
 s_cmp_lg_u32 s44, 5
 s_cbranch_scc1 L_ng_7
 s_mov_b32 s47, 1
 s_mov_b32 s51, 1
 s_mov_b32 s50, 1
 s_getpc_b64 s[98:99]
 s_branch L_init
 s_branch L_wa
L_ng_7:
 s_cmp_lg_u32 s44, 6
 s_cbranch_scc1 L_ng_8
 s_mov_b32 s47, 0
 s_mov_b32 s51, 0
 s_branch L_wo
L_ng_8:
 s_cmp_lg_u32 s44, 7
 s_cbranch_scc1 L_ng_9
 s_mov_b32 s47, 1
 s_mov_b32 s51, 0
 s_branch L_wo
L_ng_9:
L_done:
L_exit:
 s_endpgm
L_init:
 s_lshl_b32 s50, s50, 5
 s_add_u32 s50, s50, s45
 v_lshlrev_b32 v1, 4, v0
 v_mov_b32 v4, 0
 v_mov_b32 v5, 0
 v_mov_b32 v6, 0
 v_mov_b32 v7, 0
 s_lshl_b32 s49, s50, 12
 buffer_store_dwordx4 v[4:7], v1, s[32:35], s49 offen sc1
 v_mov_b32 v8, -1
 v_mov_b32 v9, -1
 v_mov_b32 v10, -1
 v_mov_b32 v11, -1
 s_mul_i32 s49, s50, 94208
 s_add_u32 s49, s49, 0x40000
 buffer_store_dwordx4 v[8:11], v1, s[32:35], s49 offen sc1
 s_add_u32 s49, s49, 4096
 buffer_store_dwordx4 v[8:11], v1, s[32:35], s49 offen sc1
 s_add_u32 s49, s49, 4096
 buffer_store_dwordx4 v[8:11], v1, s[32:35], s49 offen sc1
 s_add_u32 s49, s49, 4096
 buffer_store_dwordx4 v[8:11], v1, s[32:35], s49 offen sc1
 s_add_u32 s49, s49, 4096
 buffer_store_dwordx4 v[8:11], v1, s[32:35], s49 offen sc1
 s_add_u32 s49, s49, 4096
 buffer_store_dwordx4 v[8:11], v1, s[32:35], s49 offen sc1
 s_add_u32 s49, s49, 4096
 buffer_store_dwordx4 v[8:11], v1, s[32:35], s49 offen sc1
 s_add_u32 s49, s49, 4096
 buffer_store_dwordx4 v[8:11], v1, s[32:35], s49 offen sc1
 s_add_u32 s49, s49, 4096
 buffer_store_dwordx4 v[8:11], v1, s[32:35], s49 offen sc1
 s_add_u32 s49, s49, 4096
 buffer_store_dwordx4 v[8:11], v1, s[32:35], s49 offen sc1
 s_add_u32 s49, s49, 4096
 buffer_store_dwordx4 v[8:11], v1, s[32:35], s49 offen sc1
 s_add_u32 s49, s49, 4096
 buffer_store_dwordx4 v[8:11], v1, s[32:35], s49 offen sc1
 s_add_u32 s49, s49, 4096
 buffer_store_dwordx4 v[8:11], v1, s[32:35], s49 offen sc1
 s_add_u32 s49, s49, 4096
 buffer_store_dwordx4 v[8:11], v1, s[32:35], s49 offen sc1
 s_add_u32 s49, s49, 4096
 buffer_store_dwordx4 v[8:11], v1, s[32:35], s49 offen sc1
 s_add_u32 s49, s49, 4096
 buffer_store_dwordx4 v[8:11], v1, s[32:35], s49 offen sc1
 s_add_u32 s49, s49, 4096
 buffer_store_dwordx4 v[8:11], v1, s[32:35], s49 offen sc1
 s_add_u32 s49, s49, 4096
 buffer_store_dwordx4 v[8:11], v1, s[32:35], s49 offen sc1
 s_add_u32 s49, s49, 4096
 buffer_store_dwordx4 v[8:11], v1, s[32:35], s49 offen sc1
 s_add_u32 s49, s49, 4096
 buffer_store_dwordx4 v[8:11], v1, s[32:35], s49 offen sc1
 s_add_u32 s49, s49, 4096
 buffer_store_dwordx4 v[8:11], v1, s[32:35], s49 offen sc1
 s_add_u32 s49, s49, 4096
 buffer_store_dwordx4 v[8:11], v1, s[32:35], s49 offen sc1
 s_add_u32 s49, s49, 4096
 buffer_store_dwordx4 v[8:11], v1, s[32:35], s49 offen sc1
 s_waitcnt vmcnt(0)
 s_barrier
 s_cmp_lg_u32 s46, 0
 s_cbranch_scc1 L_init_done
 s_mov_b32 s49, 1
 s_atomic_add s49, s[26:27], 0x8c glc
 s_waitcnt lgkmcnt(0)
 s_cmp_lg_u32 s49, 63
 s_cbranch_scc1 L_init_done
 s_mov_b32 s30, 0
L_cnt_10:
 s_load_dwordx4 s[72:75], s[26:27], 0 glc
 s_load_dwordx4 s[76:79], s[26:27], 64 glc
 s_load_dwordx4 s[80:83], s[26:27], 128 glc
 s_add_u32 s30, s30, 1
 s_cmp_gt_u32 s30, 524288
 s_cbranch_scc1 L_exit
 s_waitcnt lgkmcnt(0)
 s_mov_b32 s54, s75
 s_add_u32 s54, s54, s72
 s_add_u32 s54, s54, s76
 s_add_u32 s54, s54, s80
 s_add_u32 s54, s54, s73
 s_add_u32 s54, s54, s77
 s_add_u32 s54, s54, s81
 s_add_u32 s54, s54, s74
 s_add_u32 s54, s54, s78
 s_sleep 4
 s_cmp_lt_u32 s54, 256
 s_cbranch_scc1 L_cnt_10
 s_mov_b32 s49, 0x100
 s_cmp_ge_u32 s72, 32
 s_cselect_b32 s48, 1, 0
 s_or_b32 s49, s49, s48
 s_cmp_ge_u32 s76, 32
 s_cselect_b32 s48, 2, 0
 s_or_b32 s49, s49, s48
 s_cmp_ge_u32 s80, 32
 s_cselect_b32 s48, 4, 0
 s_or_b32 s49, s49, s48
 s_cmp_ge_u32 s73, 32
 s_cselect_b32 s48, 8, 0
 s_or_b32 s49, s49, s48
 s_cmp_ge_u32 s77, 32
 s_cselect_b32 s48, 16, 0
 s_or_b32 s49, s49, s48
 s_cmp_ge_u32 s81, 32
 s_cselect_b32 s48, 32, 0
 s_or_b32 s49, s49, s48
 s_cmp_ge_u32 s74, 32
 s_cselect_b32 s48, 64, 0
 s_or_b32 s49, s49, s48
 s_cmp_ge_u32 s78, 32
 s_cselect_b32 s48, 128, 0
 s_or_b32 s49, s49, s48
 v_mov_b32 v4, s49
 v_mov_b32 v5, 0
 s_mov_b64 exec, 1
 global_store_dword v5, v4, s[26:27] offset:192 sc1
 s_mov_b64 exec, -1
L_init_done:
 s_add_u32 s98, s98, 4
 s_addc_u32 s99, s99, 0
 s_setpc_b64 s[98:99]
L_chain:
 v_and_b32 v0, 63, v0
 v_lshlrev_b32 v1, 4, v0
 s_lshl_b32 s66, s46, 15
 s_lshl_b32 s67, s46, 1
 v_bfe_u32 v15, v0, 4, 1
 v_lshlrev_b32_e64 v32, 18, v15
 v_bfe_u32 v15, v0, 5, 1
 v_lshl_add_u32 v32, v15, 17, v32
 v_lshrrev_b32 v15, 4, v0
 v_lshlrev_b32 v15, 1, v15
 v_and_b32 v38, 15, v0
 v_xor_b32 v15, v15, v38
 v_lshl_add_u32 v32, v15, 4, v32
 v_xor_b32 v38, 128, v32
 v_lshrrev_b32 v15, 4, v0
 v_lshlrev_b32 v33, 11, v15
 v_bfe_u32 v15, v0, 2, 2
 v_lshl_add_u32 v33, v15, 8, v33
 v_bfe_u32 v39, v0, 2, 3
 v_lshlrev_b32 v39, 1, v39
 v_bfe_u32 v15, v0, 1, 1
 s_lshl_b32 s48, s46, 2
 v_add_u32 v15, s48, v15
 v_xor_b32 v15, v15, v39
 v_lshl_add_u32 v33, v15, 4, v33
 v_and_b32 v15, 1, v0
 v_lshl_add_u32 v33, v15, 3, v33
 v_xor_b32 v39, 32, v33
 s_lshl_b32 s72, s46, 12
 v_lshrrev_b32 v34, 3, v0
 v_lshlrev_b32 v34, 10, v34
 v_and_b32 v15, 7, v0
 v_lshl_add_u32 v34, v15, 4, v34
 v_bfe_u32 v15, v0, 4, 1
 v_lshlrev_b32_e64 v35, 11, v15
 v_bfe_u32 v15, v0, 5, 1
 v_lshl_add_u32 v35, v15, 9, v35
 v_bfe_u32 v15, v0, 2, 1
 v_lshl_add_u32 v35, v15, 7, v35
 v_bfe_u32 v15, v0, 3, 1
 v_lshl_add_u32 v35, v15, 5, v35
 v_and_b32 v15, 3, v0
 v_lshl_add_u32 v35, v15, 3, v35
 v_add_u32 v35, s72, v35
 s_add_u32 s48, s66, s72
 v_add_u32 v3, s48, v1
 s_lshl_b32 s70, s45, 8
 s_lshl_b32 s49, s46, 15
 s_add_u32 s70, s70, s49
 s_lshl_b32 s71, s45, 17
 s_lshl_b32 s49, s46, 8
 s_add_u32 s71, s71, s49
 s_lshr_b32 s54, 166, s44
 s_and_b32 s54, s54, 1
 s_cbranch_scc0 L_nolate_11
 s_cmp_lg_u32 s46, 0
 s_cbranch_scc1 L_lated_13
 s_mov_b32 s30, 0
L_winit_14:
 v_mov_b32 v124, 0
 global_load_dword v125, v124, s[26:27] offset:192 sc1
L_wchk_16:
 s_add_u32 s30, s30, 1
 s_cmp_gt_u32 s30, 524288
 s_cbranch_scc1 L_exit
 s_waitcnt vmcnt(0)
 v_readfirstlane_b32 s54, v125
 s_nop 0
 s_cmp_lg_u32 s54, 0
 s_cbranch_scc1 L_wdone_15
 s_sleep 8
 s_branch L_winit_14
L_wdone_15:
 s_lshr_b32 s3, s54, s44
 s_and_b32 s3, s3, 1
 s_lshl_b32 s52, s44, 11
 s_mov_b32 s30, 0
L_late_12:
 buffer_load_dword v125, off, s[32:35], s52 offset:1792 sc1
 s_add_u32 s30, s30, 1
 s_waitcnt vmcnt(0)
 s_cmp_gt_u32 s30, 200
 s_cbranch_scc1 L_lated_13
 v_readfirstlane_b32 s54, v125
 s_nop 0
 s_cmp_ge_u32 s54, 1
 s_cbranch_scc1 L_lated_13
 s_sleep 8
 s_branch L_late_12
L_lated_13:
 s_barrier
L_nolate_11:
 s_mov_b32 s36, s10
 s_mov_b32 s37, s11
 s_mov_b32 s38, 0x400000
 s_mov_b32 s39, 0x20000
 s_add_u32 m0, s72, 0
 s_add_u32 s48, s70, 0
 buffer_load_dwordx4 v32, s[36:39], s48 offen offset:0 lds
 s_add_u32 s48, s48, 7168
 buffer_load_dwordx4 v32, s[36:39], s48 offen offset:1024 lds
 s_add_u32 s48, s48, 7168
 buffer_load_dwordx4 v38, s[36:39], s48 offen offset:2048 lds
 s_add_u32 s48, s48, 7168
 buffer_load_dwordx4 v38, s[36:39], s48 offen offset:3072 lds
 s_add_u32 m0, s72, 16384
 s_add_u32 s48, s70, 524288
 buffer_load_dwordx4 v32, s[36:39], s48 offen offset:0 lds
 s_add_u32 s48, s48, 7168
 buffer_load_dwordx4 v32, s[36:39], s48 offen offset:1024 lds
 s_add_u32 s48, s48, 7168
 buffer_load_dwordx4 v38, s[36:39], s48 offen offset:2048 lds
 s_add_u32 s48, s48, 7168
 buffer_load_dwordx4 v38, s[36:39], s48 offen offset:3072 lds
 s_add_u32 m0, s72, 32768
 s_add_u32 s48, s70, 1048576
 buffer_load_dwordx4 v32, s[36:39], s48 offen offset:0 lds
 s_add_u32 s48, s48, 7168
 buffer_load_dwordx4 v32, s[36:39], s48 offen offset:1024 lds
 s_add_u32 s48, s48, 7168
 buffer_load_dwordx4 v38, s[36:39], s48 offen offset:2048 lds
 s_add_u32 s48, s48, 7168
 buffer_load_dwordx4 v38, s[36:39], s48 offen offset:3072 lds
 s_add_u32 m0, s72, 49152
 s_add_u32 s48, s70, 1572864
 buffer_load_dwordx4 v32, s[36:39], s48 offen offset:0 lds
 s_add_u32 s48, s48, 7168
 buffer_load_dwordx4 v32, s[36:39], s48 offen offset:1024 lds
 s_add_u32 s48, s48, 7168
 buffer_load_dwordx4 v38, s[36:39], s48 offen offset:2048 lds
 s_add_u32 s48, s48, 7168
 buffer_load_dwordx4 v38, s[36:39], s48 offen offset:3072 lds
 s_add_u32 m0, s72, 65536
 s_add_u32 s48, s70, 2097152
 buffer_load_dwordx4 v32, s[36:39], s48 offen offset:0 lds
 s_add_u32 s48, s48, 7168
 buffer_load_dwordx4 v32, s[36:39], s48 offen offset:1024 lds
 s_add_u32 s48, s48, 7168
 buffer_load_dwordx4 v38, s[36:39], s48 offen offset:2048 lds
 s_add_u32 s48, s48, 7168
 buffer_load_dwordx4 v38, s[36:39], s48 offen offset:3072 lds
 s_add_u32 m0, s72, 81920
 s_add_u32 s48, s70, 2621440
 buffer_load_dwordx4 v32, s[36:39], s48 offen offset:0 lds
 s_add_u32 s48, s48, 7168
 buffer_load_dwordx4 v32, s[36:39], s48 offen offset:1024 lds
 s_add_u32 s48, s48, 7168
 buffer_load_dwordx4 v38, s[36:39], s48 offen offset:2048 lds
 s_add_u32 s48, s48, 7168
 buffer_load_dwordx4 v38, s[36:39], s48 offen offset:3072 lds
 s_add_u32 m0, s72, 98304
 s_add_u32 s48, s70, 3145728
 buffer_load_dwordx4 v32, s[36:39], s48 offen offset:0 lds
 s_add_u32 s48, s48, 7168
 buffer_load_dwordx4 v32, s[36:39], s48 offen offset:1024 lds
 s_add_u32 s48, s48, 7168
 buffer_load_dwordx4 v38, s[36:39], s48 offen offset:2048 lds
 s_add_u32 s48, s48, 7168
 buffer_load_dwordx4 v38, s[36:39], s48 offen offset:3072 lds
 s_add_u32 m0, s72, 114688
 s_add_u32 s48, s70, 3670016
 buffer_load_dwordx4 v32, s[36:39], s48 offen offset:0 lds
 s_add_u32 s48, s48, 7168
 buffer_load_dwordx4 v32, s[36:39], s48 offen offset:1024 lds
 s_add_u32 s48, s48, 7168
 buffer_load_dwordx4 v38, s[36:39], s48 offen offset:2048 lds
 s_add_u32 s48, s48, 7168
 buffer_load_dwordx4 v38, s[36:39], s48 offen offset:3072 lds
 v_and_b32 v96, 1, v0
 v_lshlrev_b32 v96, 4, v96
 v_mov_b32 v97, 0x3f80
 v_lshlrev_b32 v96, v96, v97
 v_bfe_u32 v97, v0, 1, 2
 v_bfe_u32 v98, v0, 3, 1
 v_cmp_eq_u32 vcc, 0, v97
 s_nop 1
 v_cndmask_b32 v99, 0, v96, vcc
 v_cmp_eq_u32 vcc, 1, v97
 s_nop 1
 v_cndmask_b32 v99, 0, v96, vcc
 v_cmp_eq_u32 vcc, 2, v97
 s_nop 1
 v_cndmask_b32 v99, 0, v96, vcc
 v_cmp_eq_u32 vcc, 3, v97
 s_nop 1
 v_cndmask_b32 v99, 0, v96, vcc
 v_bfe_u32 v97, v0, 2, 1
 v_bfe_u32 v99, v0, 4, 1
 v_cmp_eq_u32 vcc, v97, v99
 s_nop 1
 v_cndmask_b32_e64 v96, 0, v96, vcc
 v_bfe_u32 v97, v0, 1, 1
 v_lshl_add_u32 v97, v98, 1, v97
 v_cmp_eq_u32 vcc, 0, v97
 s_nop 1
 v_cndmask_b32 v16, 0, v96, vcc
 v_cmp_eq_u32 vcc, 1, v97
 s_nop 1
 v_cndmask_b32 v17, 0, v96, vcc
 v_cmp_eq_u32 vcc, 2, v97
 s_nop 1
 v_cndmask_b32 v18, 0, v96, vcc
 v_cmp_eq_u32 vcc, 3, v97
 s_nop 1
 v_cndmask_b32 v19, 0, v96, vcc
 v_and_b32 v96, 1, v0
 v_lshlrev_b32 v96, 4, v96
 v_mov_b32 v97, 0x3e03
 v_lshlrev_b32_e64 v96, v96, v97
 v_bfe_u32 v97, v0, 1, 2
 v_bfe_u32 v98, v0, 3, 1
 v_cmp_eq_u32 vcc, 0, v97
 s_nop 1
 v_cndmask_b32 v99, 0, v96, vcc
 v_mov_b32 v28, v99
 v_cmp_eq_u32 vcc, 0, v98
 s_nop 1
 v_cndmask_b32 v112, 0, v99, vcc
 v_cmp_eq_u32 vcc, 1, v98
 s_nop 1
 v_cndmask_b32 v116, 0, v99, vcc
 v_cmp_eq_u32 vcc, 1, v97
 s_nop 1
 v_cndmask_b32 v99, 0, v96, vcc
 v_mov_b32 v29, v99
 v_cmp_eq_u32 vcc, 0, v98
 s_nop 1
 v_cndmask_b32 v113, 0, v99, vcc
 v_cmp_eq_u32 vcc, 1, v98
 s_nop 1
 v_cndmask_b32 v117, 0, v99, vcc
 v_cmp_eq_u32 vcc, 2, v97
 s_nop 1
 v_cndmask_b32 v99, 0, v96, vcc
 v_mov_b32 v30, v99
 v_cmp_eq_u32 vcc, 0, v98
 s_nop 1
 v_cndmask_b32 v114, 0, v99, vcc
 v_cmp_eq_u32 vcc, 1, v98
 s_nop 1
 v_cndmask_b32 v118, 0, v99, vcc
 v_cmp_eq_u32 vcc, 3, v97
 s_nop 1
 v_cndmask_b32 v99, 0, v96, vcc
 v_mov_b32 v31, v99
 v_cmp_eq_u32 vcc, 0, v98
 s_nop 1
 v_cndmask_b32 v115, 0, v99, vcc
 v_cmp_eq_u32 vcc, 1, v98
 s_nop 1
 v_cndmask_b32 v119, 0, v99, vcc
 v_mov_b32 v2, 0x44444444
 v_mov_b32 v96, 0xeeeeeeee
 v_and_b32 v97, 8, v0
 v_cmp_ne_u32 vcc, 0, v97
 s_nop 1
 v_cndmask_b32 v2, v2, v96, vcc
 v_and_b32 v96, 15, v0
 v_lshrrev_b32 v97, 4, v0
 v_and_b32 v98, 7, v0
 s_mov_b32 s64, 0xff00ff00
 s_mov_b32 s65, 0xff00ff00
 v_lshlrev_b32 v99, 3, v98
 v_and_b32_e64 v15, 1, v97
 v_lshl_add_u32 v99, v15, 6, v99
 v_add_u32 v99, 163584, v99
 v_lshrrev_b32 v15, 1, v97
 v_lshlrev_b32 v4, 8, v15
 v_lshl_add_u32 v4, v98, 4, v4
 v_and_b32 v15, 1, v97
 v_lshl_add_u32 v4, v15, 3, v4
 s_lshl_b32 s48, s46, 9
 s_add_u32 s49, s48, 159744
 v_add_u32 v4, s49, v4
 v_cndmask_b32 v4, v4, v99, s[64:65]
 v_lshlrev_b32 v5, 4, v98
 v_lshl_add_u32 v5, v15, 3, v5
 s_lshl_b32 s49, s46, 7
 s_add_u32 s49, s49, 161792
 v_add_u32 v5, s49, v5
 s_mov_b32 s98, 0
 s_mov_b32 s99, 0x00ff00ff
 v_cndmask_b32 v5, v99, v5, s[98:99]
 v_lshlrev_b32 v6, 9, v97
 v_lshl_add_u32 v6, v96, 4, v6
 v_add_u32 v6, 159744, v6
 v_lshlrev_b32_e64 v7, 7, v97
 v_lshl_add_u32 v7, v98, 4, v7
 v_add_u32 v7, 161792, v7
 s_lshl_b32 s49, s46, 9
 s_add_u32 s49, s49, -6144
 v_bfe_u32 v15, v0, 3, 1
 v_lshl_add_u32 v8, v15, 3, v7
 v_add_u32 v8, s49, v8
 v_and_b32 v9, 0xf0, v1
 v_add_u32 v9, 162304, v9
 v_lshrrev_b32 v15, 2, v96
 v_lshl_add_u32 v15, v15, 2, v97
 v_lshlrev_b32 v10, 11, v15
 v_and_b32 v15, 3, v0
 v_lshl_add_u32 v10, v15, 4, v10
 s_lshl_b32 s48, s46, 16
 s_lshl_b32 s49, s45, 6
 s_add_u32 s48, s48, s49
 v_add_u32 v10, s48, v10
 s_lshl_b32 s50, s45, 2
 s_add_u32 s50, s50, s46
 s_lshl_b32 s48, s50, 11
 v_add_u32 v11, s48, v1
 v_lshlrev_b32 v12, 4, v97
 v_lshl_add_u32 v12, v96, 2, v12
 s_lshl_b32 s48, s50, 6
 v_add_u32 v12, s48, v12
 v_mov_b32 v15, 0x80000000
 v_cmp_gt_u32 vcc, 4, v96
 s_nop 1
 v_cndmask_b32 v12, v15, v12, vcc
 v_and_b32 v100, 3, v0
 v_lshlrev_b32 v100, 1, v100
 v_lshl_add_u32 v100, v97, 10, v100
 v_and_b32 v104, 3, v0
 v_bfe_u32 v105, v0, 2, 2
 v_lshl_add_u32 v104, v104, 2, v105
 v_and_b32 v105, 1, v104
 v_lshlrev_b32 v105, 4, v105
 v_mov_b32 v106, 0x3f80
 v_lshlrev_b32 v105, v105, v106
 v_lshrrev_b32 v104, 1, v104
 v_cmp_eq_u32 vcc, 0, v104
 s_nop 1
 v_cndmask_b32 v108, 0, v105, vcc
 v_cmp_eq_u32 vcc, 1, v104
 s_nop 1
 v_cndmask_b32 v109, 0, v105, vcc
 v_cmp_eq_u32 vcc, 2, v104
 s_nop 1
 v_cndmask_b32 v110, 0, v105, vcc
 v_cmp_eq_u32 vcc, 3, v104
 s_nop 1
 v_cndmask_b32 v111, 0, v105, vcc
 v_and_b32 v104, 0xf0, v1
 v_add_u32 v104, 162304, v104
 ds_write_b128 v104, v[108:111]
 ds_write_b128 v104, v[112:115] offset:256
 ds_write_b128 v104, v[116:119] offset:512
 v_mov_b32 v120, 0x3f803f80
 v_mov_b32 v121, 0x3f803f80
 v_mov_b32 v122, 0x3f803f80
 v_mov_b32 v123, 0x3f803f80
 v_mov_b32 v124, 0x3f003f00
 v_mov_b32 v125, 0x3f003f00
 v_mov_b32 v126, 0x3f003f00
 v_mov_b32 v127, 0x3f003f00
 ds_write_b128 v104, v[120:123] offset:768
 ds_write_b128 v104, v[124:127] offset:1024
 s_and_b32 s48, s50, 1
 s_lshl_b32 s48, s48, 12
 s_lshr_b32 s49, s50, 4
 s_lshl_b32 s49, s49, 7
 s_add_u32 s48, s48, s49
 s_bfe_u32 s49, s50, 0x10001
 s_lshl_b32 s49, s49, 5
 s_add_u32 s48, s48, s49
 s_bfe_u32 s49, s50, 0x20002
 s_lshl_b32 s49, s49, 3
 s_add_u32 s48, s48, s49
 s_mov_b32 s40, s6
 s_mov_b32 s41, s7
 s_mov_b32 s42, 0x2000
 s_mov_b32 s43, 0x20000
 buffer_load_ushort v36, v100, s[40:43], s48 offen
 buffer_load_ushort v37, v100, s[40:43], s48 offen offset:64
 s_mov_b32 s55, 0
 s_mov_b32 s56, 0
 s_lshl_b32 s48, s47, 14
 s_add_u32 s57, s48, 0x140000
 s_add_u32 s58, s57, 8192
 s_lshl_b32 s48, s46, 11
 s_add_u32 s92, s48, s57
 s_add_u32 s48, s48, 131072
 v_add_u32 v0, s48, v1
 s_lshl_b32 s48, s47, 19
 s_add_u32 s59, s48, 0x40000
 s_lshl_b32 s48, s47, 18
 s_add_u32 s61, s48, 0x180000
 s_add_u32 s62, s61, 32768
 s_lshl_b32 s48, s47, 21
 s_lshl_b32 s49, s50, 12
 s_add_u32 s48, s48, s49
 s_add_u32 s93, s48, 0x200000
 s_mov_b32 s60, s93
 s_mov_b32 s96, 0x3f800000
 s_mov_b32 s97, s96
 s_mov_b32 s63, 0x42400000
 s_waitcnt vmcnt(28)
 s_barrier
 s_cmp_lg_u32 s46, 0
 s_cbranch_scc1 L_cw_18
 ds_read_b64_tr_b16 a[0:1], v33 offset:0
 ds_read_b64_tr_b16 a[2:3], v33 offset:1024
 ds_read_b64_tr_b16 a[4:5], v33 offset:8192
 ds_read_b64_tr_b16 a[6:7], v33 offset:9216
 ds_read_b64_tr_b16 a[8:9], v39 offset:0
 ds_read_b64_tr_b16 a[10:11], v39 offset:1024
 ds_read_b64_tr_b16 a[12:13], v39 offset:8192
 ds_read_b64_tr_b16 a[14:15], v39 offset:9216
 s_branch L_cw_17
L_cw_18:
 s_cmp_lg_u32 s46, 1
 s_cbranch_scc1 L_cw_19
 ds_read_b64_tr_b16 a[32:33], v33 offset:0
 ds_read_b64_tr_b16 a[34:35], v33 offset:1024
 ds_read_b64_tr_b16 a[36:37], v33 offset:8192
 ds_read_b64_tr_b16 a[38:39], v33 offset:9216
 ds_read_b64_tr_b16 a[40:41], v39 offset:0
 ds_read_b64_tr_b16 a[42:43], v39 offset:1024
 ds_read_b64_tr_b16 a[44:45], v39 offset:8192
 ds_read_b64_tr_b16 a[46:47], v39 offset:9216
 s_branch L_cw_17
L_cw_19:
 s_cmp_lg_u32 s46, 2
 s_cbranch_scc1 L_cw_20
 ds_read_b64_tr_b16 a[64:65], v33 offset:0
 ds_read_b64_tr_b16 a[66:67], v33 offset:1024
 ds_read_b64_tr_b16 a[68:69], v33 offset:8192
 ds_read_b64_tr_b16 a[70:71], v33 offset:9216
 ds_read_b64_tr_b16 a[72:73], v39 offset:0
 ds_read_b64_tr_b16 a[74:75], v39 offset:1024
 ds_read_b64_tr_b16 a[76:77], v39 offset:8192
 ds_read_b64_tr_b16 a[78:79], v39 offset:9216
 s_branch L_cw_17
L_cw_20:
 ds_read_b64_tr_b16 a[96:97], v33 offset:0
 ds_read_b64_tr_b16 a[98:99], v33 offset:1024
 ds_read_b64_tr_b16 a[100:101], v33 offset:8192
 ds_read_b64_tr_b16 a[102:103], v33 offset:9216
 ds_read_b64_tr_b16 a[104:105], v39 offset:0
 ds_read_b64_tr_b16 a[106:107], v39 offset:1024
 ds_read_b64_tr_b16 a[108:109], v39 offset:8192
 ds_read_b64_tr_b16 a[110:111], v39 offset:9216
L_cw_17:
 s_waitcnt lgkmcnt(0)
 s_waitcnt vmcnt(24)
 s_barrier
 s_mov_b32 s36, s12
 s_mov_b32 s37, s13
 s_mov_b32 s38, 0x400000
 s_mov_b32 s39, 0x20000
 s_add_u32 m0, s72, 0
 s_add_u32 s48, s70, 0
 buffer_load_dwordx4 v32, s[36:39], s48 offen offset:0 lds
 s_add_u32 s48, s48, 7168
 buffer_load_dwordx4 v32, s[36:39], s48 offen offset:1024 lds
 s_add_u32 s48, s48, 7168
 buffer_load_dwordx4 v38, s[36:39], s48 offen offset:2048 lds
 s_add_u32 s48, s48, 7168
 buffer_load_dwordx4 v38, s[36:39], s48 offen offset:3072 lds
 s_cmp_lg_u32 s46, 0
 s_cbranch_scc1 L_cw_23
 ds_read_b64_tr_b16 a[16:17], v33 offset:16384
 ds_read_b64_tr_b16 a[18:19], v33 offset:17408
 ds_read_b64_tr_b16 a[20:21], v33 offset:24576
 ds_read_b64_tr_b16 a[22:23], v33 offset:25600
 ds_read_b64_tr_b16 a[24:25], v39 offset:16384
 ds_read_b64_tr_b16 a[26:27], v39 offset:17408
 ds_read_b64_tr_b16 a[28:29], v39 offset:24576
 ds_read_b64_tr_b16 a[30:31], v39 offset:25600
 s_branch L_cw_22
L_cw_23:
 s_cmp_lg_u32 s46, 1
 s_cbranch_scc1 L_cw_24
 ds_read_b64_tr_b16 a[48:49], v33 offset:16384
 ds_read_b64_tr_b16 a[50:51], v33 offset:17408
 ds_read_b64_tr_b16 a[52:53], v33 offset:24576
 ds_read_b64_tr_b16 a[54:55], v33 offset:25600
 ds_read_b64_tr_b16 a[56:57], v39 offset:16384
 ds_read_b64_tr_b16 a[58:59], v39 offset:17408
 ds_read_b64_tr_b16 a[60:61], v39 offset:24576
 ds_read_b64_tr_b16 a[62:63], v39 offset:25600
 s_branch L_cw_22
L_cw_24:
 s_cmp_lg_u32 s46, 2
 s_cbranch_scc1 L_cw_25
 ds_read_b64_tr_b16 a[80:81], v33 offset:16384
 ds_read_b64_tr_b16 a[82:83], v33 offset:17408
 ds_read_b64_tr_b16 a[84:85], v33 offset:24576
 ds_read_b64_tr_b16 a[86:87], v33 offset:25600
 ds_read_b64_tr_b16 a[88:89], v39 offset:16384
 ds_read_b64_tr_b16 a[90:91], v39 offset:17408
 ds_read_b64_tr_b16 a[92:93], v39 offset:24576
 ds_read_b64_tr_b16 a[94:95], v39 offset:25600
 s_branch L_cw_22
L_cw_25:
 ds_read_b64_tr_b16 a[112:113], v33 offset:16384
 ds_read_b64_tr_b16 a[114:115], v33 offset:17408
 ds_read_b64_tr_b16 a[116:117], v33 offset:24576
 ds_read_b64_tr_b16 a[118:119], v33 offset:25600
 ds_read_b64_tr_b16 a[120:121], v39 offset:16384
 ds_read_b64_tr_b16 a[122:123], v39 offset:17408
 ds_read_b64_tr_b16 a[124:125], v39 offset:24576
 ds_read_b64_tr_b16 a[126:127], v39 offset:25600
L_cw_22:
 s_waitcnt lgkmcnt(0)
 s_waitcnt vmcnt(24)
 s_barrier
 s_add_u32 m0, s72, 16384
 s_add_u32 s48, s70, 524288
 buffer_load_dwordx4 v32, s[36:39], s48 offen offset:0 lds
 s_add_u32 s48, s48, 7168
 buffer_load_dwordx4 v32, s[36:39], s48 offen offset:1024 lds
 s_add_u32 s48, s48, 7168
 buffer_load_dwordx4 v38, s[36:39], s48 offen offset:2048 lds
 s_add_u32 s48, s48, 7168
 buffer_load_dwordx4 v38, s[36:39], s48 offen offset:3072 lds
 s_cmp_lg_u32 s46, 0
 s_cbranch_scc1 L_cw_28
 ds_read_b64_tr_b16 a[32:33], v33 offset:32768
 ds_read_b64_tr_b16 a[34:35], v33 offset:33792
 ds_read_b64_tr_b16 a[36:37], v33 offset:40960
 ds_read_b64_tr_b16 a[38:39], v33 offset:41984
 ds_read_b64_tr_b16 a[40:41], v39 offset:32768
 ds_read_b64_tr_b16 a[42:43], v39 offset:33792
 ds_read_b64_tr_b16 a[44:45], v39 offset:40960
 ds_read_b64_tr_b16 a[46:47], v39 offset:41984
 s_branch L_cw_27
L_cw_28:
 s_cmp_lg_u32 s46, 1
 s_cbranch_scc1 L_cw_29
 ds_read_b64_tr_b16 a[0:1], v33 offset:32768
 ds_read_b64_tr_b16 a[2:3], v33 offset:33792
 ds_read_b64_tr_b16 a[4:5], v33 offset:40960
 ds_read_b64_tr_b16 a[6:7], v33 offset:41984
 ds_read_b64_tr_b16 a[8:9], v39 offset:32768
 ds_read_b64_tr_b16 a[10:11], v39 offset:33792
 ds_read_b64_tr_b16 a[12:13], v39 offset:40960
 ds_read_b64_tr_b16 a[14:15], v39 offset:41984
 s_branch L_cw_27
L_cw_29:
 s_cmp_lg_u32 s46, 2
 s_cbranch_scc1 L_cw_30
 ds_read_b64_tr_b16 a[96:97], v33 offset:32768
 ds_read_b64_tr_b16 a[98:99], v33 offset:33792
 ds_read_b64_tr_b16 a[100:101], v33 offset:40960
 ds_read_b64_tr_b16 a[102:103], v33 offset:41984
 ds_read_b64_tr_b16 a[104:105], v39 offset:32768
 ds_read_b64_tr_b16 a[106:107], v39 offset:33792
 ds_read_b64_tr_b16 a[108:109], v39 offset:40960
 ds_read_b64_tr_b16 a[110:111], v39 offset:41984
 s_branch L_cw_27
L_cw_30:
 ds_read_b64_tr_b16 a[64:65], v33 offset:32768
 ds_read_b64_tr_b16 a[66:67], v33 offset:33792
 ds_read_b64_tr_b16 a[68:69], v33 offset:40960
 ds_read_b64_tr_b16 a[70:71], v33 offset:41984
 ds_read_b64_tr_b16 a[72:73], v39 offset:32768
 ds_read_b64_tr_b16 a[74:75], v39 offset:33792
 ds_read_b64_tr_b16 a[76:77], v39 offset:40960
 ds_read_b64_tr_b16 a[78:79], v39 offset:41984
L_cw_27:
 s_waitcnt lgkmcnt(0)
 s_waitcnt vmcnt(24)
 s_barrier
 s_add_u32 m0, s72, 32768
 s_add_u32 s48, s70, 1048576
 buffer_load_dwordx4 v32, s[36:39], s48 offen offset:0 lds
 s_add_u32 s48, s48, 7168
 buffer_load_dwordx4 v32, s[36:39], s48 offen offset:1024 lds
 s_add_u32 s48, s48, 7168
 buffer_load_dwordx4 v38, s[36:39], s48 offen offset:2048 lds
 s_add_u32 s48, s48, 7168
 buffer_load_dwordx4 v38, s[36:39], s48 offen offset:3072 lds
 s_cmp_lg_u32 s46, 0
 s_cbranch_scc1 L_cw_33
 ds_read_b64_tr_b16 a[48:49], v33 offset:49152
 ds_read_b64_tr_b16 a[50:51], v33 offset:50176
 ds_read_b64_tr_b16 a[52:53], v33 offset:57344
 ds_read_b64_tr_b16 a[54:55], v33 offset:58368
 ds_read_b64_tr_b16 a[56:57], v39 offset:49152
 ds_read_b64_tr_b16 a[58:59], v39 offset:50176
 ds_read_b64_tr_b16 a[60:61], v39 offset:57344
 ds_read_b64_tr_b16 a[62:63], v39 offset:58368
 s_branch L_cw_32
L_cw_33:
 s_cmp_lg_u32 s46, 1
 s_cbranch_scc1 L_cw_34
 ds_read_b64_tr_b16 a[16:17], v33 offset:49152
 ds_read_b64_tr_b16 a[18:19], v33 offset:50176
 ds_read_b64_tr_b16 a[20:21], v33 offset:57344
 ds_read_b64_tr_b16 a[22:23], v33 offset:58368
 ds_read_b64_tr_b16 a[24:25], v39 offset:49152
 ds_read_b64_tr_b16 a[26:27], v39 offset:50176
 ds_read_b64_tr_b16 a[28:29], v39 offset:57344
 ds_read_b64_tr_b16 a[30:31], v39 offset:58368
 s_branch L_cw_32
L_cw_34:
 s_cmp_lg_u32 s46, 2
 s_cbranch_scc1 L_cw_35
 ds_read_b64_tr_b16 a[112:113], v33 offset:49152
 ds_read_b64_tr_b16 a[114:115], v33 offset:50176
 ds_read_b64_tr_b16 a[116:117], v33 offset:57344
 ds_read_b64_tr_b16 a[118:119], v33 offset:58368
 ds_read_b64_tr_b16 a[120:121], v39 offset:49152
 ds_read_b64_tr_b16 a[122:123], v39 offset:50176
 ds_read_b64_tr_b16 a[124:125], v39 offset:57344
 ds_read_b64_tr_b16 a[126:127], v39 offset:58368
 s_branch L_cw_32
L_cw_35:
 ds_read_b64_tr_b16 a[80:81], v33 offset:49152
 ds_read_b64_tr_b16 a[82:83], v33 offset:50176
 ds_read_b64_tr_b16 a[84:85], v33 offset:57344
 ds_read_b64_tr_b16 a[86:87], v33 offset:58368
 ds_read_b64_tr_b16 a[88:89], v39 offset:49152
 ds_read_b64_tr_b16 a[90:91], v39 offset:50176
 ds_read_b64_tr_b16 a[92:93], v39 offset:57344
 ds_read_b64_tr_b16 a[94:95], v39 offset:58368
L_cw_32:
 s_waitcnt lgkmcnt(0)
 s_waitcnt vmcnt(24)
 s_barrier
 s_add_u32 m0, s72, 49152
 s_add_u32 s48, s70, 1572864
 buffer_load_dwordx4 v32, s[36:39], s48 offen offset:0 lds
 s_add_u32 s48, s48, 7168
 buffer_load_dwordx4 v32, s[36:39], s48 offen offset:1024 lds
 s_add_u32 s48, s48, 7168
 buffer_load_dwordx4 v38, s[36:39], s48 offen offset:2048 lds
 s_add_u32 s48, s48, 7168
 buffer_load_dwordx4 v38, s[36:39], s48 offen offset:3072 lds
 s_cmp_lg_u32 s46, 0
 s_cbranch_scc1 L_cw_38
 v_add_u32 v40, 0x10000, v33
 ds_read_b64_tr_b16 a[64:65], v40 offset:0
 ds_read_b64_tr_b16 a[66:67], v40 offset:1024
 ds_read_b64_tr_b16 a[68:69], v40 offset:8192
 ds_read_b64_tr_b16 a[70:71], v40 offset:9216
 v_add_u32 v40, 0x10000, v39
 ds_read_b64_tr_b16 a[72:73], v40 offset:0
 ds_read_b64_tr_b16 a[74:75], v40 offset:1024
 ds_read_b64_tr_b16 a[76:77], v40 offset:8192
 ds_read_b64_tr_b16 a[78:79], v40 offset:9216
 s_branch L_cw_37
L_cw_38:
 s_cmp_lg_u32 s46, 1
 s_cbranch_scc1 L_cw_39
 v_add_u32 v40, 0x10000, v33
 ds_read_b64_tr_b16 a[96:97], v40 offset:0
 ds_read_b64_tr_b16 a[98:99], v40 offset:1024
 ds_read_b64_tr_b16 a[100:101], v40 offset:8192
 ds_read_b64_tr_b16 a[102:103], v40 offset:9216
 v_add_u32 v40, 0x10000, v39
 ds_read_b64_tr_b16 a[104:105], v40 offset:0
 ds_read_b64_tr_b16 a[106:107], v40 offset:1024
 ds_read_b64_tr_b16 a[108:109], v40 offset:8192
 ds_read_b64_tr_b16 a[110:111], v40 offset:9216
 s_branch L_cw_37
L_cw_39:
 s_cmp_lg_u32 s46, 2
 s_cbranch_scc1 L_cw_40
 v_add_u32 v40, 0x10000, v33
 ds_read_b64_tr_b16 a[0:1], v40 offset:0
 ds_read_b64_tr_b16 a[2:3], v40 offset:1024
 ds_read_b64_tr_b16 a[4:5], v40 offset:8192
 ds_read_b64_tr_b16 a[6:7], v40 offset:9216
 v_add_u32 v40, 0x10000, v39
 ds_read_b64_tr_b16 a[8:9], v40 offset:0
 ds_read_b64_tr_b16 a[10:11], v40 offset:1024
 ds_read_b64_tr_b16 a[12:13], v40 offset:8192
 ds_read_b64_tr_b16 a[14:15], v40 offset:9216
 s_branch L_cw_37
L_cw_40:
 v_add_u32 v40, 0x10000, v33
 ds_read_b64_tr_b16 a[32:33], v40 offset:0
 ds_read_b64_tr_b16 a[34:35], v40 offset:1024
 ds_read_b64_tr_b16 a[36:37], v40 offset:8192
 ds_read_b64_tr_b16 a[38:39], v40 offset:9216
 v_add_u32 v40, 0x10000, v39
 ds_read_b64_tr_b16 a[40:41], v40 offset:0
 ds_read_b64_tr_b16 a[42:43], v40 offset:1024
 ds_read_b64_tr_b16 a[44:45], v40 offset:8192
 ds_read_b64_tr_b16 a[46:47], v40 offset:9216
L_cw_37:
 s_waitcnt lgkmcnt(0)
 s_waitcnt vmcnt(24)
 s_barrier
 s_add_u32 m0, s72, 65536
 s_add_u32 s48, s70, 2097152
 buffer_load_dwordx4 v32, s[36:39], s48 offen offset:0 lds
 s_add_u32 s48, s48, 7168
 buffer_load_dwordx4 v32, s[36:39], s48 offen offset:1024 lds
 s_add_u32 s48, s48, 7168
 buffer_load_dwordx4 v38, s[36:39], s48 offen offset:2048 lds
 s_add_u32 s48, s48, 7168
 buffer_load_dwordx4 v38, s[36:39], s48 offen offset:3072 lds
 s_cmp_lg_u32 s46, 0
 s_cbranch_scc1 L_cw_43
 v_add_u32 v40, 0x10000, v33
 ds_read_b64_tr_b16 a[80:81], v40 offset:16384
 ds_read_b64_tr_b16 a[82:83], v40 offset:17408
 ds_read_b64_tr_b16 a[84:85], v40 offset:24576
 ds_read_b64_tr_b16 a[86:87], v40 offset:25600
 v_add_u32 v40, 0x10000, v39
 ds_read_b64_tr_b16 a[88:89], v40 offset:16384
 ds_read_b64_tr_b16 a[90:91], v40 offset:17408
 ds_read_b64_tr_b16 a[92:93], v40 offset:24576
 ds_read_b64_tr_b16 a[94:95], v40 offset:25600
 s_branch L_cw_42
L_cw_43:
 s_cmp_lg_u32 s46, 1
 s_cbranch_scc1 L_cw_44
 v_add_u32 v40, 0x10000, v33
 ds_read_b64_tr_b16 a[112:113], v40 offset:16384
 ds_read_b64_tr_b16 a[114:115], v40 offset:17408
 ds_read_b64_tr_b16 a[116:117], v40 offset:24576
 ds_read_b64_tr_b16 a[118:119], v40 offset:25600
 v_add_u32 v40, 0x10000, v39
 ds_read_b64_tr_b16 a[120:121], v40 offset:16384
 ds_read_b64_tr_b16 a[122:123], v40 offset:17408
 ds_read_b64_tr_b16 a[124:125], v40 offset:24576
 ds_read_b64_tr_b16 a[126:127], v40 offset:25600
 s_branch L_cw_42
L_cw_44:
 s_cmp_lg_u32 s46, 2
 s_cbranch_scc1 L_cw_45
 v_add_u32 v40, 0x10000, v33
 ds_read_b64_tr_b16 a[16:17], v40 offset:16384
 ds_read_b64_tr_b16 a[18:19], v40 offset:17408
 ds_read_b64_tr_b16 a[20:21], v40 offset:24576
 ds_read_b64_tr_b16 a[22:23], v40 offset:25600
 v_add_u32 v40, 0x10000, v39
 ds_read_b64_tr_b16 a[24:25], v40 offset:16384
 ds_read_b64_tr_b16 a[26:27], v40 offset:17408
 ds_read_b64_tr_b16 a[28:29], v40 offset:24576
 ds_read_b64_tr_b16 a[30:31], v40 offset:25600
 s_branch L_cw_42
L_cw_45:
 v_add_u32 v40, 0x10000, v33
 ds_read_b64_tr_b16 a[48:49], v40 offset:16384
 ds_read_b64_tr_b16 a[50:51], v40 offset:17408
 ds_read_b64_tr_b16 a[52:53], v40 offset:24576
 ds_read_b64_tr_b16 a[54:55], v40 offset:25600
 v_add_u32 v40, 0x10000, v39
 ds_read_b64_tr_b16 a[56:57], v40 offset:16384
 ds_read_b64_tr_b16 a[58:59], v40 offset:17408
 ds_read_b64_tr_b16 a[60:61], v40 offset:24576
 ds_read_b64_tr_b16 a[62:63], v40 offset:25600
L_cw_42:
 s_waitcnt lgkmcnt(0)
 s_waitcnt vmcnt(24)
 s_barrier
 s_add_u32 m0, s72, 81920
 s_add_u32 s48, s70, 2621440
 buffer_load_dwordx4 v32, s[36:39], s48 offen offset:0 lds
 s_add_u32 s48, s48, 7168
 buffer_load_dwordx4 v32, s[36:39], s48 offen offset:1024 lds
 s_add_u32 s48, s48, 7168
 buffer_load_dwordx4 v38, s[36:39], s48 offen offset:2048 lds
 s_add_u32 s48, s48, 7168
 buffer_load_dwordx4 v38, s[36:39], s48 offen offset:3072 lds
 s_cmp_lg_u32 s46, 0
 s_cbranch_scc1 L_cw_48
 v_add_u32 v40, 0x10000, v33
 ds_read_b64_tr_b16 a[96:97], v40 offset:32768
 ds_read_b64_tr_b16 a[98:99], v40 offset:33792
 ds_read_b64_tr_b16 a[100:101], v40 offset:40960
 ds_read_b64_tr_b16 a[102:103], v40 offset:41984
 v_add_u32 v40, 0x10000, v39
 ds_read_b64_tr_b16 a[104:105], v40 offset:32768
 ds_read_b64_tr_b16 a[106:107], v40 offset:33792
 ds_read_b64_tr_b16 a[108:109], v40 offset:40960
 ds_read_b64_tr_b16 a[110:111], v40 offset:41984
 s_branch L_cw_47
L_cw_48:
 s_cmp_lg_u32 s46, 1
 s_cbranch_scc1 L_cw_49
 v_add_u32 v40, 0x10000, v33
 ds_read_b64_tr_b16 a[64:65], v40 offset:32768
 ds_read_b64_tr_b16 a[66:67], v40 offset:33792
 ds_read_b64_tr_b16 a[68:69], v40 offset:40960
 ds_read_b64_tr_b16 a[70:71], v40 offset:41984
 v_add_u32 v40, 0x10000, v39
 ds_read_b64_tr_b16 a[72:73], v40 offset:32768
 ds_read_b64_tr_b16 a[74:75], v40 offset:33792
 ds_read_b64_tr_b16 a[76:77], v40 offset:40960
 ds_read_b64_tr_b16 a[78:79], v40 offset:41984
 s_branch L_cw_47
L_cw_49:
 s_cmp_lg_u32 s46, 2
 s_cbranch_scc1 L_cw_50
 v_add_u32 v40, 0x10000, v33
 ds_read_b64_tr_b16 a[32:33], v40 offset:32768
 ds_read_b64_tr_b16 a[34:35], v40 offset:33792
 ds_read_b64_tr_b16 a[36:37], v40 offset:40960
 ds_read_b64_tr_b16 a[38:39], v40 offset:41984
 v_add_u32 v40, 0x10000, v39
 ds_read_b64_tr_b16 a[40:41], v40 offset:32768
 ds_read_b64_tr_b16 a[42:43], v40 offset:33792
 ds_read_b64_tr_b16 a[44:45], v40 offset:40960
 ds_read_b64_tr_b16 a[46:47], v40 offset:41984
 s_branch L_cw_47
L_cw_50:
 v_add_u32 v40, 0x10000, v33
 ds_read_b64_tr_b16 a[0:1], v40 offset:32768
 ds_read_b64_tr_b16 a[2:3], v40 offset:33792
 ds_read_b64_tr_b16 a[4:5], v40 offset:40960
 ds_read_b64_tr_b16 a[6:7], v40 offset:41984
 v_add_u32 v40, 0x10000, v39
 ds_read_b64_tr_b16 a[8:9], v40 offset:32768
 ds_read_b64_tr_b16 a[10:11], v40 offset:33792
 ds_read_b64_tr_b16 a[12:13], v40 offset:40960
 ds_read_b64_tr_b16 a[14:15], v40 offset:41984
L_cw_47:
 s_waitcnt lgkmcnt(0)
 s_waitcnt vmcnt(24)
 s_barrier
 s_add_u32 m0, s72, 98304
 s_add_u32 s48, s70, 3145728
 buffer_load_dwordx4 v32, s[36:39], s48 offen offset:0 lds
 s_add_u32 s48, s48, 7168
 buffer_load_dwordx4 v32, s[36:39], s48 offen offset:1024 lds
 s_add_u32 s48, s48, 7168
 buffer_load_dwordx4 v38, s[36:39], s48 offen offset:2048 lds
 s_add_u32 s48, s48, 7168
 buffer_load_dwordx4 v38, s[36:39], s48 offen offset:3072 lds
 s_cmp_lg_u32 s46, 0
 s_cbranch_scc1 L_cw_53
 v_add_u32 v40, 0x10000, v33
 ds_read_b64_tr_b16 a[112:113], v40 offset:49152
 ds_read_b64_tr_b16 a[114:115], v40 offset:50176
 ds_read_b64_tr_b16 a[116:117], v40 offset:57344
 ds_read_b64_tr_b16 a[118:119], v40 offset:58368
 v_add_u32 v40, 0x10000, v39
 ds_read_b64_tr_b16 a[120:121], v40 offset:49152
 ds_read_b64_tr_b16 a[122:123], v40 offset:50176
 ds_read_b64_tr_b16 a[124:125], v40 offset:57344
 ds_read_b64_tr_b16 a[126:127], v40 offset:58368
 s_branch L_cw_52
L_cw_53:
 s_cmp_lg_u32 s46, 1
 s_cbranch_scc1 L_cw_54
 v_add_u32 v40, 0x10000, v33
 ds_read_b64_tr_b16 a[80:81], v40 offset:49152
 ds_read_b64_tr_b16 a[82:83], v40 offset:50176
 ds_read_b64_tr_b16 a[84:85], v40 offset:57344
 ds_read_b64_tr_b16 a[86:87], v40 offset:58368
 v_add_u32 v40, 0x10000, v39
 ds_read_b64_tr_b16 a[88:89], v40 offset:49152
 ds_read_b64_tr_b16 a[90:91], v40 offset:50176
 ds_read_b64_tr_b16 a[92:93], v40 offset:57344
 ds_read_b64_tr_b16 a[94:95], v40 offset:58368
 s_branch L_cw_52
L_cw_54:
 s_cmp_lg_u32 s46, 2
 s_cbranch_scc1 L_cw_55
 v_add_u32 v40, 0x10000, v33
 ds_read_b64_tr_b16 a[48:49], v40 offset:49152
 ds_read_b64_tr_b16 a[50:51], v40 offset:50176
 ds_read_b64_tr_b16 a[52:53], v40 offset:57344
 ds_read_b64_tr_b16 a[54:55], v40 offset:58368
 v_add_u32 v40, 0x10000, v39
 ds_read_b64_tr_b16 a[56:57], v40 offset:49152
 ds_read_b64_tr_b16 a[58:59], v40 offset:50176
 ds_read_b64_tr_b16 a[60:61], v40 offset:57344
 ds_read_b64_tr_b16 a[62:63], v40 offset:58368
 s_branch L_cw_52
L_cw_55:
 v_add_u32 v40, 0x10000, v33
 ds_read_b64_tr_b16 a[16:17], v40 offset:49152
 ds_read_b64_tr_b16 a[18:19], v40 offset:50176
 ds_read_b64_tr_b16 a[20:21], v40 offset:57344
 ds_read_b64_tr_b16 a[22:23], v40 offset:58368
 v_add_u32 v40, 0x10000, v39
 ds_read_b64_tr_b16 a[24:25], v40 offset:49152
 ds_read_b64_tr_b16 a[26:27], v40 offset:50176
 ds_read_b64_tr_b16 a[28:29], v40 offset:57344
 ds_read_b64_tr_b16 a[30:31], v40 offset:58368
L_cw_52:
 s_waitcnt lgkmcnt(0)
 s_waitcnt vmcnt(24)
 s_barrier
 s_add_u32 m0, s72, 114688
 s_add_u32 s48, s70, 3670016
 buffer_load_dwordx4 v32, s[36:39], s48 offen offset:0 lds
 s_add_u32 s48, s48, 7168
 buffer_load_dwordx4 v32, s[36:39], s48 offen offset:1024 lds
 s_add_u32 s48, s48, 7168
 buffer_load_dwordx4 v38, s[36:39], s48 offen offset:2048 lds
 s_add_u32 s48, s48, 7168
 buffer_load_dwordx4 v38, s[36:39], s48 offen offset:3072 lds
 s_cmp_lg_u32 s46, 0
 s_cbranch_scc1 L_cw_58
 ds_read_b64_tr_b16 a[128:129], v33 offset:0
 ds_read_b64_tr_b16 a[130:131], v33 offset:1024
 ds_read_b64_tr_b16 a[132:133], v33 offset:8192
 ds_read_b64_tr_b16 a[134:135], v33 offset:9216
 ds_read_b64_tr_b16 a[136:137], v39 offset:0
 ds_read_b64_tr_b16 a[138:139], v39 offset:1024
 ds_read_b64_tr_b16 a[140:141], v39 offset:8192
 ds_read_b64_tr_b16 a[142:143], v39 offset:9216
 s_branch L_cw_57
L_cw_58:
 s_cmp_lg_u32 s46, 1
 s_cbranch_scc1 L_cw_59
 ds_read_b64_tr_b16 a[160:161], v33 offset:0
 ds_read_b64_tr_b16 a[162:163], v33 offset:1024
 ds_read_b64_tr_b16 a[164:165], v33 offset:8192
 ds_read_b64_tr_b16 a[166:167], v33 offset:9216
 ds_read_b64_tr_b16 a[168:169], v39 offset:0
 ds_read_b64_tr_b16 a[170:171], v39 offset:1024
 ds_read_b64_tr_b16 a[172:173], v39 offset:8192
 ds_read_b64_tr_b16 a[174:175], v39 offset:9216
 s_branch L_cw_57
L_cw_59:
 s_cmp_lg_u32 s46, 2
 s_cbranch_scc1 L_cw_60
 ds_read_b64_tr_b16 a[192:193], v33 offset:0
 ds_read_b64_tr_b16 a[194:195], v33 offset:1024
 ds_read_b64_tr_b16 a[196:197], v33 offset:8192
 ds_read_b64_tr_b16 a[198:199], v33 offset:9216
 ds_read_b64_tr_b16 a[200:201], v39 offset:0
 ds_read_b64_tr_b16 a[202:203], v39 offset:1024
 ds_read_b64_tr_b16 a[204:205], v39 offset:8192
 ds_read_b64_tr_b16 a[206:207], v39 offset:9216
 s_branch L_cw_57
L_cw_60:
 ds_read_b64_tr_b16 a[224:225], v33 offset:0
 ds_read_b64_tr_b16 a[226:227], v33 offset:1024
 ds_read_b64_tr_b16 a[228:229], v33 offset:8192
 ds_read_b64_tr_b16 a[230:231], v33 offset:9216
 ds_read_b64_tr_b16 a[232:233], v39 offset:0
 ds_read_b64_tr_b16 a[234:235], v39 offset:1024
 ds_read_b64_tr_b16 a[236:237], v39 offset:8192
 ds_read_b64_tr_b16 a[238:239], v39 offset:9216
L_cw_57:
 s_waitcnt lgkmcnt(0)
 s_waitcnt vmcnt(24)
 s_barrier
 s_mov_b32 s36, s14
 s_mov_b32 s37, s15
 s_mov_b32 s38, 0x400000
 s_mov_b32 s39, 0x20000
 s_add_u32 m0, s72, 0
 s_xor_b32 s48, s46, 0
 s_lshl_b32 s48, s48, 15
 s_add_u32 s48, s48, s71
 buffer_load_dwordx4 v34, s[36:39], s48 offen offset:0 lds
 s_add_u32 s48, s48, 7168
 buffer_load_dwordx4 v34, s[36:39], s48 offen offset:1024 lds
 s_add_u32 s48, s48, 7168
 buffer_load_dwordx4 v34, s[36:39], s48 offen offset:2048 lds
 s_add_u32 s48, s48, 7168
 buffer_load_dwordx4 v34, s[36:39], s48 offen offset:3072 lds
 s_cmp_lg_u32 s46, 0
 s_cbranch_scc1 L_cw_63
 ds_read_b64_tr_b16 a[144:145], v33 offset:16384
 ds_read_b64_tr_b16 a[146:147], v33 offset:17408
 ds_read_b64_tr_b16 a[148:149], v33 offset:24576
 ds_read_b64_tr_b16 a[150:151], v33 offset:25600
 ds_read_b64_tr_b16 a[152:153], v39 offset:16384
 ds_read_b64_tr_b16 a[154:155], v39 offset:17408
 ds_read_b64_tr_b16 a[156:157], v39 offset:24576
 ds_read_b64_tr_b16 a[158:159], v39 offset:25600
 s_branch L_cw_62
L_cw_63:
 s_cmp_lg_u32 s46, 1
 s_cbranch_scc1 L_cw_64
 ds_read_b64_tr_b16 a[176:177], v33 offset:16384
 ds_read_b64_tr_b16 a[178:179], v33 offset:17408
 ds_read_b64_tr_b16 a[180:181], v33 offset:24576
 ds_read_b64_tr_b16 a[182:183], v33 offset:25600
 ds_read_b64_tr_b16 a[184:185], v39 offset:16384
 ds_read_b64_tr_b16 a[186:187], v39 offset:17408
 ds_read_b64_tr_b16 a[188:189], v39 offset:24576
 ds_read_b64_tr_b16 a[190:191], v39 offset:25600
 s_branch L_cw_62
L_cw_64:
 s_cmp_lg_u32 s46, 2
 s_cbranch_scc1 L_cw_65
 ds_read_b64_tr_b16 a[208:209], v33 offset:16384
 ds_read_b64_tr_b16 a[210:211], v33 offset:17408
 ds_read_b64_tr_b16 a[212:213], v33 offset:24576
 ds_read_b64_tr_b16 a[214:215], v33 offset:25600
 ds_read_b64_tr_b16 a[216:217], v39 offset:16384
 ds_read_b64_tr_b16 a[218:219], v39 offset:17408
 ds_read_b64_tr_b16 a[220:221], v39 offset:24576
 ds_read_b64_tr_b16 a[222:223], v39 offset:25600
 s_branch L_cw_62
L_cw_65:
 ds_read_b64_tr_b16 a[240:241], v33 offset:16384
 ds_read_b64_tr_b16 a[242:243], v33 offset:17408
 ds_read_b64_tr_b16 a[244:245], v33 offset:24576
 ds_read_b64_tr_b16 a[246:247], v33 offset:25600
 ds_read_b64_tr_b16 a[248:249], v39 offset:16384
 ds_read_b64_tr_b16 a[250:251], v39 offset:17408
 ds_read_b64_tr_b16 a[252:253], v39 offset:24576
 ds_read_b64_tr_b16 a[254:255], v39 offset:25600
L_cw_62:
 s_waitcnt lgkmcnt(0)
 s_waitcnt vmcnt(24)
 s_barrier
 s_add_u32 m0, s72, 16384
 s_xor_b32 s48, s46, 0
 s_lshl_b32 s48, s48, 15
 s_add_u32 s48, s48, s71
 s_add_u32 s48, s48, 128
 buffer_load_dwordx4 v34, s[36:39], s48 offen offset:0 lds
 s_add_u32 s48, s48, 7168
 buffer_load_dwordx4 v34, s[36:39], s48 offen offset:1024 lds
 s_add_u32 s48, s48, 7168
 buffer_load_dwordx4 v34, s[36:39], s48 offen offset:2048 lds
 s_add_u32 s48, s48, 7168
 buffer_load_dwordx4 v34, s[36:39], s48 offen offset:3072 lds
 s_cmp_lg_u32 s46, 0
 s_cbranch_scc1 L_cw_68
 ds_read_b64_tr_b16 a[160:161], v33 offset:32768
 ds_read_b64_tr_b16 a[162:163], v33 offset:33792
 ds_read_b64_tr_b16 a[164:165], v33 offset:40960
 ds_read_b64_tr_b16 a[166:167], v33 offset:41984
 ds_read_b64_tr_b16 a[168:169], v39 offset:32768
 ds_read_b64_tr_b16 a[170:171], v39 offset:33792
 ds_read_b64_tr_b16 a[172:173], v39 offset:40960
 ds_read_b64_tr_b16 a[174:175], v39 offset:41984
 s_branch L_cw_67
L_cw_68:
 s_cmp_lg_u32 s46, 1
 s_cbranch_scc1 L_cw_69
 ds_read_b64_tr_b16 a[128:129], v33 offset:32768
 ds_read_b64_tr_b16 a[130:131], v33 offset:33792
 ds_read_b64_tr_b16 a[132:133], v33 offset:40960
 ds_read_b64_tr_b16 a[134:135], v33 offset:41984
 ds_read_b64_tr_b16 a[136:137], v39 offset:32768
 ds_read_b64_tr_b16 a[138:139], v39 offset:33792
 ds_read_b64_tr_b16 a[140:141], v39 offset:40960
 ds_read_b64_tr_b16 a[142:143], v39 offset:41984
 s_branch L_cw_67
L_cw_69:
 s_cmp_lg_u32 s46, 2
 s_cbranch_scc1 L_cw_70
 ds_read_b64_tr_b16 a[224:225], v33 offset:32768
 ds_read_b64_tr_b16 a[226:227], v33 offset:33792
 ds_read_b64_tr_b16 a[228:229], v33 offset:40960
 ds_read_b64_tr_b16 a[230:231], v33 offset:41984
 ds_read_b64_tr_b16 a[232:233], v39 offset:32768
 ds_read_b64_tr_b16 a[234:235], v39 offset:33792
 ds_read_b64_tr_b16 a[236:237], v39 offset:40960
 ds_read_b64_tr_b16 a[238:239], v39 offset:41984
 s_branch L_cw_67
L_cw_70:
 ds_read_b64_tr_b16 a[192:193], v33 offset:32768
 ds_read_b64_tr_b16 a[194:195], v33 offset:33792
 ds_read_b64_tr_b16 a[196:197], v33 offset:40960
 ds_read_b64_tr_b16 a[198:199], v33 offset:41984
 ds_read_b64_tr_b16 a[200:201], v39 offset:32768
 ds_read_b64_tr_b16 a[202:203], v39 offset:33792
 ds_read_b64_tr_b16 a[204:205], v39 offset:40960
 ds_read_b64_tr_b16 a[206:207], v39 offset:41984
L_cw_67:
 s_waitcnt lgkmcnt(0)
 s_waitcnt vmcnt(24)
 s_barrier
 s_add_u32 m0, s72, 32768
 s_xor_b32 s48, s46, 1
 s_lshl_b32 s48, s48, 15
 s_add_u32 s48, s48, s71
 buffer_load_dwordx4 v34, s[36:39], s48 offen offset:0 lds
 s_add_u32 s48, s48, 7168
 buffer_load_dwordx4 v34, s[36:39], s48 offen offset:1024 lds
 s_add_u32 s48, s48, 7168
 buffer_load_dwordx4 v34, s[36:39], s48 offen offset:2048 lds
 s_add_u32 s48, s48, 7168
 buffer_load_dwordx4 v34, s[36:39], s48 offen offset:3072 lds
 s_cmp_lg_u32 s46, 0
 s_cbranch_scc1 L_cw_73
 ds_read_b64_tr_b16 a[176:177], v33 offset:49152
 ds_read_b64_tr_b16 a[178:179], v33 offset:50176
 ds_read_b64_tr_b16 a[180:181], v33 offset:57344
 ds_read_b64_tr_b16 a[182:183], v33 offset:58368
 ds_read_b64_tr_b16 a[184:185], v39 offset:49152
 ds_read_b64_tr_b16 a[186:187], v39 offset:50176
 ds_read_b64_tr_b16 a[188:189], v39 offset:57344
 ds_read_b64_tr_b16 a[190:191], v39 offset:58368
 s_branch L_cw_72
L_cw_73:
 s_cmp_lg_u32 s46, 1
 s_cbranch_scc1 L_cw_74
 ds_read_b64_tr_b16 a[144:145], v33 offset:49152
 ds_read_b64_tr_b16 a[146:147], v33 offset:50176
 ds_read_b64_tr_b16 a[148:149], v33 offset:57344
 ds_read_b64_tr_b16 a[150:151], v33 offset:58368
 ds_read_b64_tr_b16 a[152:153], v39 offset:49152
 ds_read_b64_tr_b16 a[154:155], v39 offset:50176
 ds_read_b64_tr_b16 a[156:157], v39 offset:57344
 ds_read_b64_tr_b16 a[158:159], v39 offset:58368
 s_branch L_cw_72
L_cw_74:
 s_cmp_lg_u32 s46, 2
 s_cbranch_scc1 L_cw_75
 ds_read_b64_tr_b16 a[240:241], v33 offset:49152
 ds_read_b64_tr_b16 a[242:243], v33 offset:50176
 ds_read_b64_tr_b16 a[244:245], v33 offset:57344
 ds_read_b64_tr_b16 a[246:247], v33 offset:58368
 ds_read_b64_tr_b16 a[248:249], v39 offset:49152
 ds_read_b64_tr_b16 a[250:251], v39 offset:50176
 ds_read_b64_tr_b16 a[252:253], v39 offset:57344
 ds_read_b64_tr_b16 a[254:255], v39 offset:58368
 s_branch L_cw_72
L_cw_75:
 ds_read_b64_tr_b16 a[208:209], v33 offset:49152
 ds_read_b64_tr_b16 a[210:211], v33 offset:50176
 ds_read_b64_tr_b16 a[212:213], v33 offset:57344
 ds_read_b64_tr_b16 a[214:215], v33 offset:58368
 ds_read_b64_tr_b16 a[216:217], v39 offset:49152
 ds_read_b64_tr_b16 a[218:219], v39 offset:50176
 ds_read_b64_tr_b16 a[220:221], v39 offset:57344
 ds_read_b64_tr_b16 a[222:223], v39 offset:58368
L_cw_72:
 s_waitcnt lgkmcnt(0)
 s_waitcnt vmcnt(24)
 s_barrier
 s_add_u32 m0, s72, 49152
 s_xor_b32 s48, s46, 1
 s_lshl_b32 s48, s48, 15
 s_add_u32 s48, s48, s71
 s_add_u32 s48, s48, 128
 buffer_load_dwordx4 v34, s[36:39], s48 offen offset:0 lds
 s_add_u32 s48, s48, 7168
 buffer_load_dwordx4 v34, s[36:39], s48 offen offset:1024 lds
 s_add_u32 s48, s48, 7168
 buffer_load_dwordx4 v34, s[36:39], s48 offen offset:2048 lds
 s_add_u32 s48, s48, 7168
 buffer_load_dwordx4 v34, s[36:39], s48 offen offset:3072 lds
 s_cmp_lg_u32 s46, 0
 s_cbranch_scc1 L_cw_78
 v_add_u32 v40, 0x10000, v33
 ds_read_b64_tr_b16 a[192:193], v40 offset:0
 ds_read_b64_tr_b16 a[194:195], v40 offset:1024
 ds_read_b64_tr_b16 a[196:197], v40 offset:8192
 ds_read_b64_tr_b16 a[198:199], v40 offset:9216
 v_add_u32 v40, 0x10000, v39
 ds_read_b64_tr_b16 a[200:201], v40 offset:0
 ds_read_b64_tr_b16 a[202:203], v40 offset:1024
 ds_read_b64_tr_b16 a[204:205], v40 offset:8192
 ds_read_b64_tr_b16 a[206:207], v40 offset:9216
 s_branch L_cw_77
L_cw_78:
 s_cmp_lg_u32 s46, 1
 s_cbranch_scc1 L_cw_79
 v_add_u32 v40, 0x10000, v33
 ds_read_b64_tr_b16 a[224:225], v40 offset:0
 ds_read_b64_tr_b16 a[226:227], v40 offset:1024
 ds_read_b64_tr_b16 a[228:229], v40 offset:8192
 ds_read_b64_tr_b16 a[230:231], v40 offset:9216
 v_add_u32 v40, 0x10000, v39
 ds_read_b64_tr_b16 a[232:233], v40 offset:0
 ds_read_b64_tr_b16 a[234:235], v40 offset:1024
 ds_read_b64_tr_b16 a[236:237], v40 offset:8192
 ds_read_b64_tr_b16 a[238:239], v40 offset:9216
 s_branch L_cw_77
L_cw_79:
 s_cmp_lg_u32 s46, 2
 s_cbranch_scc1 L_cw_80
 v_add_u32 v40, 0x10000, v33
 ds_read_b64_tr_b16 a[128:129], v40 offset:0
 ds_read_b64_tr_b16 a[130:131], v40 offset:1024
 ds_read_b64_tr_b16 a[132:133], v40 offset:8192
 ds_read_b64_tr_b16 a[134:135], v40 offset:9216
 v_add_u32 v40, 0x10000, v39
 ds_read_b64_tr_b16 a[136:137], v40 offset:0
 ds_read_b64_tr_b16 a[138:139], v40 offset:1024
 ds_read_b64_tr_b16 a[140:141], v40 offset:8192
 ds_read_b64_tr_b16 a[142:143], v40 offset:9216
 s_branch L_cw_77
L_cw_80:
 v_add_u32 v40, 0x10000, v33
 ds_read_b64_tr_b16 a[160:161], v40 offset:0
 ds_read_b64_tr_b16 a[162:163], v40 offset:1024
 ds_read_b64_tr_b16 a[164:165], v40 offset:8192
 ds_read_b64_tr_b16 a[166:167], v40 offset:9216
 v_add_u32 v40, 0x10000, v39
 ds_read_b64_tr_b16 a[168:169], v40 offset:0
 ds_read_b64_tr_b16 a[170:171], v40 offset:1024
 ds_read_b64_tr_b16 a[172:173], v40 offset:8192
 ds_read_b64_tr_b16 a[174:175], v40 offset:9216
L_cw_77:
 s_waitcnt lgkmcnt(0)
 s_waitcnt vmcnt(24)
 s_barrier
 s_add_u32 m0, s72, 65536
 s_xor_b32 s48, s46, 2
 s_lshl_b32 s48, s48, 15
 s_add_u32 s48, s48, s71
 buffer_load_dwordx4 v34, s[36:39], s48 offen offset:0 lds
 s_add_u32 s48, s48, 7168
 buffer_load_dwordx4 v34, s[36:39], s48 offen offset:1024 lds
 s_add_u32 s48, s48, 7168
 buffer_load_dwordx4 v34, s[36:39], s48 offen offset:2048 lds
 s_add_u32 s48, s48, 7168
 buffer_load_dwordx4 v34, s[36:39], s48 offen offset:3072 lds
 s_cmp_lg_u32 s46, 0
 s_cbranch_scc1 L_cw_83
 v_add_u32 v40, 0x10000, v33
 ds_read_b64_tr_b16 a[208:209], v40 offset:16384
 ds_read_b64_tr_b16 a[210:211], v40 offset:17408
 ds_read_b64_tr_b16 a[212:213], v40 offset:24576
 ds_read_b64_tr_b16 a[214:215], v40 offset:25600
 v_add_u32 v40, 0x10000, v39
 ds_read_b64_tr_b16 a[216:217], v40 offset:16384
 ds_read_b64_tr_b16 a[218:219], v40 offset:17408
 ds_read_b64_tr_b16 a[220:221], v40 offset:24576
 ds_read_b64_tr_b16 a[222:223], v40 offset:25600
 s_branch L_cw_82
L_cw_83:
 s_cmp_lg_u32 s46, 1
 s_cbranch_scc1 L_cw_84
 v_add_u32 v40, 0x10000, v33
 ds_read_b64_tr_b16 a[240:241], v40 offset:16384
 ds_read_b64_tr_b16 a[242:243], v40 offset:17408
 ds_read_b64_tr_b16 a[244:245], v40 offset:24576
 ds_read_b64_tr_b16 a[246:247], v40 offset:25600
 v_add_u32 v40, 0x10000, v39
 ds_read_b64_tr_b16 a[248:249], v40 offset:16384
 ds_read_b64_tr_b16 a[250:251], v40 offset:17408
 ds_read_b64_tr_b16 a[252:253], v40 offset:24576
 ds_read_b64_tr_b16 a[254:255], v40 offset:25600
 s_branch L_cw_82
L_cw_84:
 s_cmp_lg_u32 s46, 2
 s_cbranch_scc1 L_cw_85
 v_add_u32 v40, 0x10000, v33
 ds_read_b64_tr_b16 a[144:145], v40 offset:16384
 ds_read_b64_tr_b16 a[146:147], v40 offset:17408
 ds_read_b64_tr_b16 a[148:149], v40 offset:24576
 ds_read_b64_tr_b16 a[150:151], v40 offset:25600
 v_add_u32 v40, 0x10000, v39
 ds_read_b64_tr_b16 a[152:153], v40 offset:16384
 ds_read_b64_tr_b16 a[154:155], v40 offset:17408
 ds_read_b64_tr_b16 a[156:157], v40 offset:24576
 ds_read_b64_tr_b16 a[158:159], v40 offset:25600
 s_branch L_cw_82
L_cw_85:
 v_add_u32 v40, 0x10000, v33
 ds_read_b64_tr_b16 a[176:177], v40 offset:16384
 ds_read_b64_tr_b16 a[178:179], v40 offset:17408
 ds_read_b64_tr_b16 a[180:181], v40 offset:24576
 ds_read_b64_tr_b16 a[182:183], v40 offset:25600
 v_add_u32 v40, 0x10000, v39
 ds_read_b64_tr_b16 a[184:185], v40 offset:16384
 ds_read_b64_tr_b16 a[186:187], v40 offset:17408
 ds_read_b64_tr_b16 a[188:189], v40 offset:24576
 ds_read_b64_tr_b16 a[190:191], v40 offset:25600
L_cw_82:
 s_waitcnt lgkmcnt(0)
 s_waitcnt vmcnt(24)
 s_barrier
 s_add_u32 m0, s72, 81920
 s_xor_b32 s48, s46, 2
 s_lshl_b32 s48, s48, 15
 s_add_u32 s48, s48, s71
 s_add_u32 s48, s48, 128
 buffer_load_dwordx4 v34, s[36:39], s48 offen offset:0 lds
 s_add_u32 s48, s48, 7168
 buffer_load_dwordx4 v34, s[36:39], s48 offen offset:1024 lds
 s_add_u32 s48, s48, 7168
 buffer_load_dwordx4 v34, s[36:39], s48 offen offset:2048 lds
 s_add_u32 s48, s48, 7168
 buffer_load_dwordx4 v34, s[36:39], s48 offen offset:3072 lds
 s_cmp_lg_u32 s46, 0
 s_cbranch_scc1 L_cw_88
 v_add_u32 v40, 0x10000, v33
 ds_read_b64_tr_b16 a[224:225], v40 offset:32768
 ds_read_b64_tr_b16 a[226:227], v40 offset:33792
 ds_read_b64_tr_b16 a[228:229], v40 offset:40960
 ds_read_b64_tr_b16 a[230:231], v40 offset:41984
 v_add_u32 v40, 0x10000, v39
 ds_read_b64_tr_b16 a[232:233], v40 offset:32768
 ds_read_b64_tr_b16 a[234:235], v40 offset:33792
 ds_read_b64_tr_b16 a[236:237], v40 offset:40960
 ds_read_b64_tr_b16 a[238:239], v40 offset:41984
 s_branch L_cw_87
L_cw_88:
 s_cmp_lg_u32 s46, 1
 s_cbranch_scc1 L_cw_89
 v_add_u32 v40, 0x10000, v33
 ds_read_b64_tr_b16 a[192:193], v40 offset:32768
 ds_read_b64_tr_b16 a[194:195], v40 offset:33792
 ds_read_b64_tr_b16 a[196:197], v40 offset:40960
 ds_read_b64_tr_b16 a[198:199], v40 offset:41984
 v_add_u32 v40, 0x10000, v39
 ds_read_b64_tr_b16 a[200:201], v40 offset:32768
 ds_read_b64_tr_b16 a[202:203], v40 offset:33792
 ds_read_b64_tr_b16 a[204:205], v40 offset:40960
 ds_read_b64_tr_b16 a[206:207], v40 offset:41984
 s_branch L_cw_87
L_cw_89:
 s_cmp_lg_u32 s46, 2
 s_cbranch_scc1 L_cw_90
 v_add_u32 v40, 0x10000, v33
 ds_read_b64_tr_b16 a[160:161], v40 offset:32768
 ds_read_b64_tr_b16 a[162:163], v40 offset:33792
 ds_read_b64_tr_b16 a[164:165], v40 offset:40960
 ds_read_b64_tr_b16 a[166:167], v40 offset:41984
 v_add_u32 v40, 0x10000, v39
 ds_read_b64_tr_b16 a[168:169], v40 offset:32768
 ds_read_b64_tr_b16 a[170:171], v40 offset:33792
 ds_read_b64_tr_b16 a[172:173], v40 offset:40960
 ds_read_b64_tr_b16 a[174:175], v40 offset:41984
 s_branch L_cw_87
L_cw_90:
 v_add_u32 v40, 0x10000, v33
 ds_read_b64_tr_b16 a[128:129], v40 offset:32768
 ds_read_b64_tr_b16 a[130:131], v40 offset:33792
 ds_read_b64_tr_b16 a[132:133], v40 offset:40960
 ds_read_b64_tr_b16 a[134:135], v40 offset:41984
 v_add_u32 v40, 0x10000, v39
 ds_read_b64_tr_b16 a[136:137], v40 offset:32768
 ds_read_b64_tr_b16 a[138:139], v40 offset:33792
 ds_read_b64_tr_b16 a[140:141], v40 offset:40960
 ds_read_b64_tr_b16 a[142:143], v40 offset:41984
L_cw_87:
 s_waitcnt lgkmcnt(0)
 s_waitcnt vmcnt(24)
 s_barrier
 s_add_u32 m0, s72, 98304
 s_xor_b32 s48, s46, 3
 s_lshl_b32 s48, s48, 15
 s_add_u32 s48, s48, s71
 buffer_load_dwordx4 v34, s[36:39], s48 offen offset:0 lds
 s_add_u32 s48, s48, 7168
 buffer_load_dwordx4 v34, s[36:39], s48 offen offset:1024 lds
 s_add_u32 s48, s48, 7168
 buffer_load_dwordx4 v34, s[36:39], s48 offen offset:2048 lds
 s_add_u32 s48, s48, 7168
 buffer_load_dwordx4 v34, s[36:39], s48 offen offset:3072 lds
 s_cmp_lg_u32 s46, 0
 s_cbranch_scc1 L_cw_93
 v_add_u32 v40, 0x10000, v33
 ds_read_b64_tr_b16 a[240:241], v40 offset:49152
 ds_read_b64_tr_b16 a[242:243], v40 offset:50176
 ds_read_b64_tr_b16 a[244:245], v40 offset:57344
 ds_read_b64_tr_b16 a[246:247], v40 offset:58368
 v_add_u32 v40, 0x10000, v39
 ds_read_b64_tr_b16 a[248:249], v40 offset:49152
 ds_read_b64_tr_b16 a[250:251], v40 offset:50176
 ds_read_b64_tr_b16 a[252:253], v40 offset:57344
 ds_read_b64_tr_b16 a[254:255], v40 offset:58368
 s_branch L_cw_92
L_cw_93:
 s_cmp_lg_u32 s46, 1
 s_cbranch_scc1 L_cw_94
 v_add_u32 v40, 0x10000, v33
 ds_read_b64_tr_b16 a[208:209], v40 offset:49152
 ds_read_b64_tr_b16 a[210:211], v40 offset:50176
 ds_read_b64_tr_b16 a[212:213], v40 offset:57344
 ds_read_b64_tr_b16 a[214:215], v40 offset:58368
 v_add_u32 v40, 0x10000, v39
 ds_read_b64_tr_b16 a[216:217], v40 offset:49152
 ds_read_b64_tr_b16 a[218:219], v40 offset:50176
 ds_read_b64_tr_b16 a[220:221], v40 offset:57344
 ds_read_b64_tr_b16 a[222:223], v40 offset:58368
 s_branch L_cw_92
L_cw_94:
 s_cmp_lg_u32 s46, 2
 s_cbranch_scc1 L_cw_95
 v_add_u32 v40, 0x10000, v33
 ds_read_b64_tr_b16 a[176:177], v40 offset:49152
 ds_read_b64_tr_b16 a[178:179], v40 offset:50176
 ds_read_b64_tr_b16 a[180:181], v40 offset:57344
 ds_read_b64_tr_b16 a[182:183], v40 offset:58368
 v_add_u32 v40, 0x10000, v39
 ds_read_b64_tr_b16 a[184:185], v40 offset:49152
 ds_read_b64_tr_b16 a[186:187], v40 offset:50176
 ds_read_b64_tr_b16 a[188:189], v40 offset:57344
 ds_read_b64_tr_b16 a[190:191], v40 offset:58368
 s_branch L_cw_92
L_cw_95:
 v_add_u32 v40, 0x10000, v33
 ds_read_b64_tr_b16 a[144:145], v40 offset:49152
 ds_read_b64_tr_b16 a[146:147], v40 offset:50176
 ds_read_b64_tr_b16 a[148:149], v40 offset:57344
 ds_read_b64_tr_b16 a[150:151], v40 offset:58368
 v_add_u32 v40, 0x10000, v39
 ds_read_b64_tr_b16 a[152:153], v40 offset:49152
 ds_read_b64_tr_b16 a[154:155], v40 offset:50176
 ds_read_b64_tr_b16 a[156:157], v40 offset:57344
 ds_read_b64_tr_b16 a[158:159], v40 offset:58368
L_cw_92:
 s_waitcnt lgkmcnt(0)
 s_waitcnt vmcnt(24)
 s_barrier
 s_add_u32 m0, s72, 114688
 s_xor_b32 s48, s46, 3
 s_lshl_b32 s48, s48, 15
 s_add_u32 s48, s48, s71
 s_add_u32 s48, s48, 128
 buffer_load_dwordx4 v34, s[36:39], s48 offen offset:0 lds
 s_add_u32 s48, s48, 7168
 buffer_load_dwordx4 v34, s[36:39], s48 offen offset:1024 lds
 s_add_u32 s48, s48, 7168
 buffer_load_dwordx4 v34, s[36:39], s48 offen offset:2048 lds
 s_add_u32 s48, s48, 7168
 buffer_load_dwordx4 v34, s[36:39], s48 offen offset:3072 lds
 ds_read_b64_tr_b16 v[128:129], v35 offset:0
 ds_read_b64_tr_b16 v[130:131], v35 offset:256
 ds_read_b64_tr_b16 v[132:133], v35 offset:1024
 ds_read_b64_tr_b16 v[134:135], v35 offset:1280
 ds_read_b64_tr_b16 v[160:161], v35 offset:64
 ds_read_b64_tr_b16 v[162:163], v35 offset:320
 ds_read_b64_tr_b16 v[164:165], v35 offset:1088
 ds_read_b64_tr_b16 v[166:167], v35 offset:1344
 s_waitcnt lgkmcnt(0)
 s_waitcnt vmcnt(24)
 s_barrier
 s_mov_b32 s36, s8
 s_mov_b32 s37, s9
 s_mov_b32 s38, 0x400000
 s_mov_b32 s39, 0x20000
 s_add_u32 m0, s72, 0
 s_add_u32 s48, s70, 0
 buffer_load_dwordx4 v32, s[36:39], s48 offen offset:0 lds
 s_add_u32 s48, s48, 7168
 buffer_load_dwordx4 v32, s[36:39], s48 offen offset:1024 lds
 s_add_u32 s48, s48, 7168
 buffer_load_dwordx4 v38, s[36:39], s48 offen offset:2048 lds
 s_add_u32 s48, s48, 7168
 buffer_load_dwordx4 v38, s[36:39], s48 offen offset:3072 lds
 ds_read_b64_tr_b16 v[192:193], v35 offset:16384
 ds_read_b64_tr_b16 v[194:195], v35 offset:16640
 ds_read_b64_tr_b16 v[196:197], v35 offset:17408
 ds_read_b64_tr_b16 v[198:199], v35 offset:17664
 ds_read_b64_tr_b16 v[224:225], v35 offset:16448
 ds_read_b64_tr_b16 v[226:227], v35 offset:16704
 ds_read_b64_tr_b16 v[228:229], v35 offset:17472
 ds_read_b64_tr_b16 v[230:231], v35 offset:17728
 s_waitcnt lgkmcnt(0)
 s_waitcnt vmcnt(24)
 s_barrier
 s_add_u32 m0, s72, 16384
 s_add_u32 s48, s70, 524288
 buffer_load_dwordx4 v32, s[36:39], s48 offen offset:0 lds
 s_add_u32 s48, s48, 7168
 buffer_load_dwordx4 v32, s[36:39], s48 offen offset:1024 lds
 s_add_u32 s48, s48, 7168
 buffer_load_dwordx4 v38, s[36:39], s48 offen offset:2048 lds
 s_add_u32 s48, s48, 7168
 buffer_load_dwordx4 v38, s[36:39], s48 offen offset:3072 lds
 ds_read_b64_tr_b16 v[136:137], v35 offset:32768
 ds_read_b64_tr_b16 v[138:139], v35 offset:33024
 ds_read_b64_tr_b16 v[140:141], v35 offset:33792
 ds_read_b64_tr_b16 v[142:143], v35 offset:34048
 ds_read_b64_tr_b16 v[168:169], v35 offset:32832
 ds_read_b64_tr_b16 v[170:171], v35 offset:33088
 ds_read_b64_tr_b16 v[172:173], v35 offset:33856
 ds_read_b64_tr_b16 v[174:175], v35 offset:34112
 s_waitcnt lgkmcnt(0)
 s_waitcnt vmcnt(24)
 s_barrier
 s_add_u32 m0, s72, 32768
 s_add_u32 s48, s70, 1048576
 buffer_load_dwordx4 v32, s[36:39], s48 offen offset:0 lds
 s_add_u32 s48, s48, 7168
 buffer_load_dwordx4 v32, s[36:39], s48 offen offset:1024 lds
 s_add_u32 s48, s48, 7168
 buffer_load_dwordx4 v38, s[36:39], s48 offen offset:2048 lds
 s_add_u32 s48, s48, 7168
 buffer_load_dwordx4 v38, s[36:39], s48 offen offset:3072 lds
 ds_read_b64_tr_b16 v[200:201], v35 offset:49152
 ds_read_b64_tr_b16 v[202:203], v35 offset:49408
 ds_read_b64_tr_b16 v[204:205], v35 offset:50176
 ds_read_b64_tr_b16 v[206:207], v35 offset:50432
 ds_read_b64_tr_b16 v[232:233], v35 offset:49216
 ds_read_b64_tr_b16 v[234:235], v35 offset:49472
 ds_read_b64_tr_b16 v[236:237], v35 offset:50240
 ds_read_b64_tr_b16 v[238:239], v35 offset:50496
 s_waitcnt lgkmcnt(0)
 s_waitcnt vmcnt(24)
 s_barrier
 s_add_u32 m0, s72, 49152
 s_add_u32 s48, s70, 1572864
 buffer_load_dwordx4 v32, s[36:39], s48 offen offset:0 lds
 s_add_u32 s48, s48, 7168
 buffer_load_dwordx4 v32, s[36:39], s48 offen offset:1024 lds
 s_add_u32 s48, s48, 7168
 buffer_load_dwordx4 v38, s[36:39], s48 offen offset:2048 lds
 s_add_u32 s48, s48, 7168
 buffer_load_dwordx4 v38, s[36:39], s48 offen offset:3072 lds
 v_add_u32 v40, 0x10000, v35
 ds_read_b64_tr_b16 v[144:145], v40 offset:0
 ds_read_b64_tr_b16 v[146:147], v40 offset:256
 ds_read_b64_tr_b16 v[148:149], v40 offset:1024
 ds_read_b64_tr_b16 v[150:151], v40 offset:1280
 ds_read_b64_tr_b16 v[176:177], v40 offset:64
 ds_read_b64_tr_b16 v[178:179], v40 offset:320
 ds_read_b64_tr_b16 v[180:181], v40 offset:1088
 ds_read_b64_tr_b16 v[182:183], v40 offset:1344
 s_waitcnt lgkmcnt(0)
 s_waitcnt vmcnt(24)
 s_barrier
 s_add_u32 m0, s72, 65536
 s_add_u32 s48, s70, 2097152
 buffer_load_dwordx4 v32, s[36:39], s48 offen offset:0 lds
 s_add_u32 s48, s48, 7168
 buffer_load_dwordx4 v32, s[36:39], s48 offen offset:1024 lds
 s_add_u32 s48, s48, 7168
 buffer_load_dwordx4 v38, s[36:39], s48 offen offset:2048 lds
 s_add_u32 s48, s48, 7168
 buffer_load_dwordx4 v38, s[36:39], s48 offen offset:3072 lds
 v_add_u32 v40, 0x10000, v35
 ds_read_b64_tr_b16 v[208:209], v40 offset:16384
 ds_read_b64_tr_b16 v[210:211], v40 offset:16640
 ds_read_b64_tr_b16 v[212:213], v40 offset:17408
 ds_read_b64_tr_b16 v[214:215], v40 offset:17664
 ds_read_b64_tr_b16 v[240:241], v40 offset:16448
 ds_read_b64_tr_b16 v[242:243], v40 offset:16704
 ds_read_b64_tr_b16 v[244:245], v40 offset:17472
 ds_read_b64_tr_b16 v[246:247], v40 offset:17728
 s_waitcnt lgkmcnt(0)
 s_waitcnt vmcnt(24)
 s_barrier
 s_add_u32 m0, s72, 81920
 s_add_u32 s48, s70, 2621440
 buffer_load_dwordx4 v32, s[36:39], s48 offen offset:0 lds
 s_add_u32 s48, s48, 7168
 buffer_load_dwordx4 v32, s[36:39], s48 offen offset:1024 lds
 s_add_u32 s48, s48, 7168
 buffer_load_dwordx4 v38, s[36:39], s48 offen offset:2048 lds
 s_add_u32 s48, s48, 7168
 buffer_load_dwordx4 v38, s[36:39], s48 offen offset:3072 lds
 v_add_u32 v40, 0x10000, v35
 ds_read_b64_tr_b16 v[152:153], v40 offset:32768
 ds_read_b64_tr_b16 v[154:155], v40 offset:33024
 ds_read_b64_tr_b16 v[156:157], v40 offset:33792
 ds_read_b64_tr_b16 v[158:159], v40 offset:34048
 ds_read_b64_tr_b16 v[184:185], v40 offset:32832
 ds_read_b64_tr_b16 v[186:187], v40 offset:33088
 ds_read_b64_tr_b16 v[188:189], v40 offset:33856
 ds_read_b64_tr_b16 v[190:191], v40 offset:34112
 s_waitcnt lgkmcnt(0)
 s_waitcnt vmcnt(24)
 s_barrier
 s_add_u32 m0, s72, 98304
 s_add_u32 s48, s70, 3145728
 buffer_load_dwordx4 v32, s[36:39], s48 offen offset:0 lds
 s_add_u32 s48, s48, 7168
 buffer_load_dwordx4 v32, s[36:39], s48 offen offset:1024 lds
 s_add_u32 s48, s48, 7168
 buffer_load_dwordx4 v38, s[36:39], s48 offen offset:2048 lds
 s_add_u32 s48, s48, 7168
 buffer_load_dwordx4 v38, s[36:39], s48 offen offset:3072 lds
 v_add_u32 v40, 0x10000, v35
 ds_read_b64_tr_b16 v[216:217], v40 offset:49152
 ds_read_b64_tr_b16 v[218:219], v40 offset:49408
 ds_read_b64_tr_b16 v[220:221], v40 offset:50176
 ds_read_b64_tr_b16 v[222:223], v40 offset:50432
 ds_read_b64_tr_b16 v[248:249], v40 offset:49216
 ds_read_b64_tr_b16 v[250:251], v40 offset:49472
 ds_read_b64_tr_b16 v[252:253], v40 offset:50240
 ds_read_b64_tr_b16 v[254:255], v40 offset:50496
 s_waitcnt lgkmcnt(0)
 s_waitcnt vmcnt(24)
 s_barrier
 s_add_u32 m0, s72, 114688
 s_add_u32 s48, s70, 3670016
 buffer_load_dwordx4 v32, s[36:39], s48 offen offset:0 lds
 s_add_u32 s48, s48, 7168
 buffer_load_dwordx4 v32, s[36:39], s48 offen offset:1024 lds
 s_add_u32 s48, s48, 7168
 buffer_load_dwordx4 v38, s[36:39], s48 offen offset:2048 lds
 s_add_u32 s48, s48, 7168
 buffer_load_dwordx4 v38, s[36:39], s48 offen offset:3072 lds
 ds_read_b64_tr_b16 v[64:65], v33 offset:0
 ds_read_b64_tr_b16 v[66:67], v33 offset:1024
 ds_read_b64_tr_b16 v[68:69], v33 offset:8192
 ds_read_b64_tr_b16 v[70:71], v33 offset:9216
 ds_read_b64_tr_b16 v[72:73], v39 offset:0
 ds_read_b64_tr_b16 v[74:75], v39 offset:1024
 ds_read_b64_tr_b16 v[76:77], v39 offset:8192
 ds_read_b64_tr_b16 v[78:79], v39 offset:9216
 s_waitcnt lgkmcnt(0)
 s_waitcnt vmcnt(24)
 s_barrier
 s_add_u32 s48, s72, 0
 v_add_u32 v40, s48, v1
 ds_write_b128 v40, v[64:67] offset:0
 ds_write_b128 v40, v[68:71] offset:1024
 ds_write_b128 v40, v[72:75] offset:2048
 ds_write_b128 v40, v[76:79] offset:3072
 ds_read_b64_tr_b16 v[80:81], v33 offset:16384
 ds_read_b64_tr_b16 v[82:83], v33 offset:17408
 ds_read_b64_tr_b16 v[84:85], v33 offset:24576
 ds_read_b64_tr_b16 v[86:87], v33 offset:25600
 ds_read_b64_tr_b16 v[88:89], v39 offset:16384
 ds_read_b64_tr_b16 v[90:91], v39 offset:17408
 ds_read_b64_tr_b16 v[92:93], v39 offset:24576
 ds_read_b64_tr_b16 v[94:95], v39 offset:25600
 s_waitcnt lgkmcnt(0)
 v_mov_b32 v124, 0
 global_load_dword v125, v124, s[26:27] offset:192 sc1
 s_waitcnt vmcnt(20)
 s_barrier
 s_add_u32 s48, s72, 16384
 v_add_u32 v40, s48, v1
 ds_write_b128 v40, v[80:83] offset:0
 ds_write_b128 v40, v[84:87] offset:1024
 ds_write_b128 v40, v[88:91] offset:2048
 ds_write_b128 v40, v[92:95] offset:3072
 ds_read_b64_tr_b16 v[64:65], v33 offset:32768
 ds_read_b64_tr_b16 v[66:67], v33 offset:33792
 ds_read_b64_tr_b16 v[68:69], v33 offset:40960
 ds_read_b64_tr_b16 v[70:71], v33 offset:41984
 ds_read_b64_tr_b16 v[72:73], v39 offset:32768
 ds_read_b64_tr_b16 v[74:75], v39 offset:33792
 ds_read_b64_tr_b16 v[76:77], v39 offset:40960
 ds_read_b64_tr_b16 v[78:79], v39 offset:41984
 s_waitcnt lgkmcnt(0)
 s_waitcnt vmcnt(16)
 s_barrier
 s_add_u32 s48, s72, 32768
 v_add_u32 v40, s48, v1
 ds_write_b128 v40, v[64:67] offset:0
 ds_write_b128 v40, v[68:71] offset:1024
 ds_write_b128 v40, v[72:75] offset:2048
 ds_write_b128 v40, v[76:79] offset:3072
 ds_read_b64_tr_b16 v[80:81], v33 offset:49152
 ds_read_b64_tr_b16 v[82:83], v33 offset:50176
 ds_read_b64_tr_b16 v[84:85], v33 offset:57344
 ds_read_b64_tr_b16 v[86:87], v33 offset:58368
 ds_read_b64_tr_b16 v[88:89], v39 offset:49152
 ds_read_b64_tr_b16 v[90:91], v39 offset:50176
 ds_read_b64_tr_b16 v[92:93], v39 offset:57344
 ds_read_b64_tr_b16 v[94:95], v39 offset:58368
 s_waitcnt lgkmcnt(0)
 s_waitcnt vmcnt(12)
 s_barrier
 s_add_u32 s48, s72, 49152
 v_add_u32 v40, s48, v1
 ds_write_b128 v40, v[80:83] offset:0
 ds_write_b128 v40, v[84:87] offset:1024
 ds_write_b128 v40, v[88:91] offset:2048
 ds_write_b128 v40, v[92:95] offset:3072
 v_add_u32 v40, 0x10000, v33
 ds_read_b64_tr_b16 v[64:65], v40 offset:0
 ds_read_b64_tr_b16 v[66:67], v40 offset:1024
 ds_read_b64_tr_b16 v[68:69], v40 offset:8192
 ds_read_b64_tr_b16 v[70:71], v40 offset:9216
 v_add_u32 v40, 0x10000, v39
 ds_read_b64_tr_b16 v[72:73], v40 offset:0
 ds_read_b64_tr_b16 v[74:75], v40 offset:1024
 ds_read_b64_tr_b16 v[76:77], v40 offset:8192
 ds_read_b64_tr_b16 v[78:79], v40 offset:9216
 s_waitcnt lgkmcnt(0)
 s_waitcnt vmcnt(8)
 s_barrier
 s_add_u32 s48, s72, 65536
 v_add_u32 v40, s48, v1
 ds_write_b128 v40, v[64:67] offset:0
 ds_write_b128 v40, v[68:71] offset:1024
 ds_write_b128 v40, v[72:75] offset:2048
 ds_write_b128 v40, v[76:79] offset:3072
 v_add_u32 v40, 0x10000, v33
 ds_read_b64_tr_b16 v[80:81], v40 offset:16384
 ds_read_b64_tr_b16 v[82:83], v40 offset:17408
 ds_read_b64_tr_b16 v[84:85], v40 offset:24576
 ds_read_b64_tr_b16 v[86:87], v40 offset:25600
 v_add_u32 v40, 0x10000, v39
 ds_read_b64_tr_b16 v[88:89], v40 offset:16384
 ds_read_b64_tr_b16 v[90:91], v40 offset:17408
 ds_read_b64_tr_b16 v[92:93], v40 offset:24576
 ds_read_b64_tr_b16 v[94:95], v40 offset:25600
 s_waitcnt lgkmcnt(0)
 s_waitcnt vmcnt(4)
 s_barrier
 s_add_u32 s48, s72, 81920
 v_add_u32 v40, s48, v1
 ds_write_b128 v40, v[80:83] offset:0
 ds_write_b128 v40, v[84:87] offset:1024
 ds_write_b128 v40, v[88:91] offset:2048
 ds_write_b128 v40, v[92:95] offset:3072
 v_add_u32 v40, 0x10000, v33
 ds_read_b64_tr_b16 v[64:65], v40 offset:32768
 ds_read_b64_tr_b16 v[66:67], v40 offset:33792
 ds_read_b64_tr_b16 v[68:69], v40 offset:40960
 ds_read_b64_tr_b16 v[70:71], v40 offset:41984
 v_add_u32 v40, 0x10000, v39
 ds_read_b64_tr_b16 v[72:73], v40 offset:32768
 ds_read_b64_tr_b16 v[74:75], v40 offset:33792
 ds_read_b64_tr_b16 v[76:77], v40 offset:40960
 ds_read_b64_tr_b16 v[78:79], v40 offset:41984
 s_waitcnt lgkmcnt(0)
 s_waitcnt vmcnt(0)
 s_barrier
 s_add_u32 s48, s72, 98304
 v_add_u32 v40, s48, v1
 ds_write_b128 v40, v[64:67] offset:0
 ds_write_b128 v40, v[68:71] offset:1024
 ds_write_b128 v40, v[72:75] offset:2048
 ds_write_b128 v40, v[76:79] offset:3072
 v_add_u32 v40, 0x10000, v33
 ds_read_b64_tr_b16 v[80:81], v40 offset:49152
 ds_read_b64_tr_b16 v[82:83], v40 offset:50176
 ds_read_b64_tr_b16 v[84:85], v40 offset:57344
 ds_read_b64_tr_b16 v[86:87], v40 offset:58368
 v_add_u32 v40, 0x10000, v39
 ds_read_b64_tr_b16 v[88:89], v40 offset:49152
 ds_read_b64_tr_b16 v[90:91], v40 offset:50176
 ds_read_b64_tr_b16 v[92:93], v40 offset:57344
 ds_read_b64_tr_b16 v[94:95], v40 offset:58368
 s_waitcnt lgkmcnt(0)
 s_barrier
 s_add_u32 s48, s72, 114688
 v_add_u32 v40, s48, v1
 ds_write_b128 v40, v[80:83] offset:0
 ds_write_b128 v40, v[84:87] offset:1024
 ds_write_b128 v40, v[88:91] offset:2048
 ds_write_b128 v40, v[92:95] offset:3072
 s_mov_b32 s30, 0
 s_branch L_wchk_99
L_winit_97:
 v_mov_b32 v124, 0
 global_load_dword v125, v124, s[26:27] offset:192 sc1
L_wchk_99:
 s_add_u32 s30, s30, 1
 s_cmp_gt_u32 s30, 524288
 s_cbranch_scc1 L_exit
 s_waitcnt vmcnt(0)
 v_readfirstlane_b32 s54, v125
 s_nop 0
 s_cmp_lg_u32 s54, 0
 s_cbranch_scc1 L_wdone_98
 s_sleep 8
 s_branch L_winit_97
L_wdone_98:
 s_lshr_b32 s3, s54, s44
 s_and_b32 s3, s3, 1
 s_or_b32 s48, s47, s46
 s_or_b32 s48, s48, s45
 s_cbranch_scc1 L_lsig_100
 v_mbcnt_lo_u32_b32 v127, -1, 0
 v_lshlrev_b32 v127, 11, v127
 v_mov_b32 v126, 1
 s_mov_b64 exec, 0xff
 buffer_store_dword v126, v127, s[32:35], 0 offen offset:1792 sc1
 s_mov_b64 exec, -1
L_lsig_100:
 v_lshl_or_b32 v13, v37, 16, v36
 v_min_u32 v13, -2, v13
 ds_read_b128 v[64:67], v3 offset:0
 ds_read_b128 v[68:71], v3 offset:1024
 ds_read_b128 v[72:75], v3 offset:2048
 ds_read_b128 v[76:79], v3 offset:3072
 ds_read_b128 v[80:83], v3 offset:16384
 ds_read_b128 v[84:87], v3 offset:17408
 ds_read_b128 v[88:91], v3 offset:18432
 ds_read_b128 v[92:95], v3 offset:19456
 v_mov_b32 v14, -1
 v_mov_b32 v48, -1
 v_mov_b32 v52, -1
 v_mov_b32 v56, -1
 v_mov_b32 v60, -1
 v_mov_b64 v[20:21], 0
 v_mov_b64 v[22:23], 0
 v_mov_b64 v[24:25], 0
 v_mov_b64 v[26:27], 0
 s_lshl_b32 s94, s46, 12
 s_add_u32 s94, s94, 139264
 s_mov_b32 m0, s94
 v_add_u32 v15, s94, v1
 v_mov_b32 v40, -1
 v_mov_b32 v41, -1
 v_mov_b32 v42, -1
 v_mov_b32 v43, -1
 ds_write_b128 v15, v[40:43] offset:0
 ds_write_b128 v15, v[40:43] offset:1024
 ds_write_b128 v15, v[40:43] offset:2048
 ds_write_b128 v15, v[40:43] offset:3072
 s_waitcnt vmcnt(0) lgkmcnt(0)
 s_cmp_eq_u32 s3, 0
 s_cbranch_scc1 L_chain_entryG
L_chain_entryL:
 v_min_u32 v13, -2, v13
 buffer_store_dword v13, v12, s[32:35], s57 offen
.p2align 6
L_chain_loopL:
 s_cmp_eq_u32 s55, 63
 s_cbranch_scc1 L_chain_lastL
 ds_read_b128 v[64:67], v3 offset:0
 ds_read_b128 v[68:71], v3 offset:1024
 ds_read_b128 v[72:75], v3 offset:2048
 ds_read_b128 v[76:79], v3 offset:3072
 s_waitcnt lgkmcnt(0)
 v_mov_b64 v[32:33], 0
 v_mov_b64 v[34:35], 0
 v_mov_b64 v[36:37], 0
 v_mov_b64 v[38:39], 0
 v_mov_b64 v[40:41], 0
 v_mov_b64 v[42:43], 0
 v_mov_b64 v[44:45], 0
 v_mov_b64_e64 v[46:47], 0
 s_bfe_u32 s95, s55, 0x10002
 v_bitop3_b32 v15, v48, v52, s95 bitop3:0x7e
 v_bitop3_b32 v120, v56, v60, s95 bitop3:0x7e
 v_or_b32 v15, v15, v120
 v_and_b32 v15, 1, v15
 v_cmp_ne_u32 vcc, 0, v15
 s_cbranch_vccnz L_chain_kvwaitL
L_chain_kvokL:
 s_mov_b32 s30, 0
 buffer_load_dwordx4 v[96:99], v1, s[32:35], s92 offen sc1
 buffer_load_dwordx4 v[100:103], v1, s[32:35], s92 offen offset:1024 sc1
 ds_read_b128 v[80:83], v3 offset:16384
 ds_read_b128 v[84:87], v3 offset:17408
 ds_read_b128 v[88:91], v3 offset:18432
 ds_read_b128 v[92:95], v3 offset:19456
 s_waitcnt lgkmcnt(0)
 s_add_u32 s60, s55, 1
 s_and_b32 s60, s60, 3
 s_lshl_b32 s60, s60, 19
 s_add_u32 s60, s60, s93
 buffer_load_dwordx4 v[104:107], v1, s[32:35], s92 offen sc1
 buffer_load_dwordx4 v[108:111], v1, s[32:35], s92 offen offset:1024 sc1
 s_waitcnt vmcnt(3)
 v_smfmac_f32_16x16x64_bf16 v[36:39], v[96:99], a[0:7], v2
 v_max3_u32 v15, v96, v97, v98
 v_smfmac_f32_16x16x64_bf16 v[44:47], v[96:99], a[8:15], v2
 s_waitcnt vmcnt(2)
 v_max3_u32 v15, v15, v99, v100
 ds_write_b128 v0, v[96:99]
 v_max3_u32 v15, v15, v101, v102
 v_max_u32 v15, v15, v103
 v_cmp_eq_u32 vcc, -1, v15
 v_smfmac_f32_16x16x64_bf16 v[36:39], v[100:103], a[16:23], v2
 ds_write_b128 v0, v[100:103] offset:1024
 v_smfmac_f32_16x16x64_bf16 v[44:47], v[100:103], a[24:31], v2
 s_cbranch_vccnz L_chain_x2bL
L_chain_x2okL:
 v_xor_b32 v15, 0x8000, v3
 v_smfmac_f32_16x16x64_bf16 v[32:35], v[96:99], v[64:71], v2
 ds_read_b128 v[64:67], v15 offset:0
 ds_read_b128 v[68:71], v15 offset:1024
 v_smfmac_f32_16x16x64_bf16 v[40:43], v[96:99], v[72:79], v2
 ds_read_b128 v[72:75], v15 offset:2048
 ds_read_b128 v[76:79], v15 offset:3072
 v_smfmac_f32_16x16x64_bf16 v[32:35], v[100:103], v[80:87], v2
 ds_read_b128 v[80:83], v15 offset:16384
 ds_read_b128 v[84:87], v15 offset:17408
 v_smfmac_f32_16x16x64_bf16 v[40:43], v[100:103], v[88:95], v2
 ds_read_b128 v[88:91], v15 offset:18432
 ds_read_b128 v[92:95], v15 offset:19456
 buffer_store_dword v14, v12, s[32:35], s58 offen
 s_waitcnt vmcnt(1) lgkmcnt(8)
 s_barrier
 v_xor_b32 v15, 2048, v0
 ds_read_b128 v[104:107], v15
 ds_read_b128 v[108:111], v15 offset:1024
 v_smfmac_f32_16x16x64_bf16 v[20:23], v[96:99], a[128:135], v2
 v_xor_b32 v15, 4096, v0
 ds_read_b128 v[112:115], v15
 ds_read_b128 v[116:119], v15 offset:1024
 v_smfmac_f32_16x16x64_bf16 v[24:27], v[96:99], a[136:143], v2
 v_xor_b32 v15, 6144, v0
 ds_read_b128 v[120:123], v15
 ds_read_b128 v[124:127], v15 offset:1024
 buffer_store_dword v13, v12, s[32:35], s59 offen sc1
 v_smfmac_f32_16x16x64_bf16 v[20:23], v[100:103], a[144:151], v2
 v_smfmac_f32_16x16x64_bf16 v[24:27], v[100:103], a[152:159], v2
 v_xor_b32 v15, 0x10000, v3
 s_waitcnt lgkmcnt(5)
 v_smfmac_f32_16x16x64_bf16 v[32:35], v[104:107], v[64:71], v2
 ds_read_b128 v[64:67], v15 offset:0
 v_smfmac_f32_16x16x64_bf16 v[36:39], v[104:107], a[32:39], v2
 ds_read_b128 v[68:71], v15 offset:1024
 v_smfmac_f32_16x16x64_bf16 v[40:43], v[104:107], v[72:79], v2
 ds_read_b128 v[72:75], v15 offset:2048
 v_smfmac_f32_16x16x64_bf16 v[44:47], v[104:107], a[40:47], v2
 ds_read_b128 v[76:79], v15 offset:3072
 s_waitcnt lgkmcnt(8)
 v_smfmac_f32_16x16x64_bf16 v[32:35], v[108:111], v[80:87], v2
 ds_read_b128 v[80:83], v15 offset:16384
 v_smfmac_f32_16x16x64_bf16 v[36:39], v[108:111], a[48:55], v2
 ds_read_b128 v[84:87], v15 offset:17408
 v_smfmac_f32_16x16x64_bf16 v[40:43], v[108:111], v[88:95], v2
 ds_read_b128 v[88:91], v15 offset:18432
 v_smfmac_f32_16x16x64_bf16 v[44:47], v[108:111], a[56:63], v2
 ds_read_b128 v[92:95], v15 offset:19456
 buffer_load_dwordx4 v1, s[32:35], s60 offen offset:0 sc1 lds
 v_xor_b32 v15, 0x18000, v3
 s_waitcnt lgkmcnt(4)
 v_smfmac_f32_16x16x64_bf16 v[32:35], v[112:115], v[64:71], v2
 ds_read_b128 v[64:67], v15 offset:0
 v_smfmac_f32_16x16x64_bf16 v[36:39], v[112:115], a[64:71], v2
 ds_read_b128 v[68:71], v15 offset:1024
 v_smfmac_f32_16x16x64_bf16 v[40:43], v[112:115], v[72:79], v2
 ds_read_b128 v[72:75], v15 offset:2048
 v_smfmac_f32_16x16x64_bf16 v[44:47], v[112:115], a[72:79], v2
 ds_read_b128 v[76:79], v15 offset:3072
 s_waitcnt lgkmcnt(4)
 v_smfmac_f32_16x16x64_bf16 v[32:35], v[116:119], v[80:87], v2
 ds_read_b128 v[80:83], v15 offset:16384
 v_smfmac_f32_16x16x64_bf16 v[36:39], v[116:119], a[80:87], v2
 ds_read_b128 v[84:87], v15 offset:17408
 v_smfmac_f32_16x16x64_bf16 v[40:43], v[116:119], v[88:95], v2
 ds_read_b128 v[88:91], v15 offset:18432
 v_smfmac_f32_16x16x64_bf16 v[44:47], v[116:119], a[88:95], v2
 ds_read_b128 v[92:95], v15 offset:19456
 buffer_load_dwordx4 v1, s[32:35], s60 offen offset:1024 sc1 lds
 v_smfmac_f32_16x16x64_bf16 v[36:39], v[120:123], a[96:103], v2
 v_smfmac_f32_16x16x64_bf16 v[36:39], v[124:127], a[112:119], v2
 s_waitcnt lgkmcnt(6)
 v_smfmac_f32_16x16x64_bf16 v[32:35], v[120:123], v[64:71], v2
 s_waitcnt lgkmcnt(2)
 v_smfmac_f32_16x16x64_bf16 v[32:35], v[124:127], v[80:87], v2
 buffer_load_dwordx4 v1, s[32:35], s60 offen offset:2048 sc1 lds
 v_smfmac_f32_16x16x64_bf16 v[40:43], v[120:123], v[72:79], v2
 ds_read_b128 v[64:67], v9 offset:256
 s_waitcnt lgkmcnt(1)
 v_smfmac_f32_16x16x64_bf16 v[40:43], v[124:127], v[88:95], v2
 v_cvt_pk_bf16_f32 v74, v36, v37
 v_smfmac_f32_16x16x64_bf16 v[44:47], v[120:123], a[104:111], v2
 v_cvt_pk_bf16_f32 v75, v38, v39
 v_smfmac_f32_16x16x64_bf16 v[44:47], v[124:127], a[120:127], v2
 v_cvt_pk_bf16_f32 v72, v32, v33
 v_cvt_pk_bf16_f32 v73, v34, v35
 s_nop 0
 s_nop 0
 v_cvt_pk_bf16_f32 v76, v40, v41
 v_cvt_pk_bf16_f32 v77, v42, v43
 v_mfma_f32_16x16x32_bf16 v[80:83], v[72:75], v[16:19], 0
 ds_read_b128 v[68:71], v9 offset:512
 v_cvt_pk_bf16_f32 v78, v44, v45
 v_cvt_pk_bf16_f32 v79, v46, v47
 s_nop 1
 v_mfma_f32_16x16x32_bf16 v[84:87], v[76:79], v[16:19], 0
 s_nop 1
 v_cvt_pk_bf16_f32 v88, v80, v81
 v_cvt_pk_bf16_f32 v89, v82, v83
 s_nop 2
 s_nop 0
 v_cvt_pk_bf16_f32 v90, v84, v85
 v_cvt_pk_bf16_f32 v91, v86, v87
 s_nop 1
 v_mfma_f32_16x16x32_bf16 v[32:35], v[48:51], v[88:91], 0
 v_mfma_f32_16x16x32_bf16 v[36:39], v[52:55], v[88:91], 0
 v_mfma_f32_16x16x32_bf16 v[40:43], v[88:91], v[88:91], 0
 s_nop 5
 v_cvt_pk_bf16_f32 v44, v32, v33
 v_cvt_pk_bf16_f32 v45, v34, v35
 v_cvt_pk_bf16_f32 v46, v36, v37
 v_cvt_pk_bf16_f32 v47, v38, v39
 ds_write2_b64 v4, v[44:45], v[46:47] offset0:0 offset1:16
 v_cvt_pk_bf16_f32 v92, v40, v41
 v_cvt_pk_bf16_f32 v93, v42, v43
 ds_write_b64 v5, v[92:93]
 buffer_load_dwordx4 v1, s[32:35], s60 offen offset:3072 sc1 lds
 v_smfmac_f32_16x16x64_bf16 v[20:23], v[104:107], a[160:167], v2
 v_smfmac_f32_16x16x64_bf16 v[24:27], v[104:107], a[168:175], v2
 v_smfmac_f32_16x16x64_bf16 v[20:23], v[108:111], a[176:183], v2
 v_smfmac_f32_16x16x64_bf16 v[24:27], v[108:111], a[184:191], v2
 v_smfmac_f32_16x16x64_bf16 v[20:23], v[112:115], a[192:199], v2
 s_waitcnt lgkmcnt(0)
 s_barrier
 ds_read_b128 v[72:75], v6
 ds_read_b128 v[80:83], v7
 ds_read_b128 v[76:79], v6 offset:256
 v_smfmac_f32_16x16x64_bf16 v[24:27], v[112:115], a[200:207], v2
 v_smfmac_f32_16x16x64_bf16 v[20:23], v[116:119], a[208:215], v2
 v_smfmac_f32_16x16x64_bf16 v[24:27], v[116:119], a[216:223], v2
 s_waitcnt lgkmcnt(1)
 v_mfma_f32_16x16x32_bf16 v[32:35], v[64:67], v[72:75], 0
 v_mfma_f32_16x16x32_bf16 v[36:39], v[28:31], v[80:83], 0
 s_waitcnt lgkmcnt(0)
 v_mfma_f32_16x16x32_bf16 v[32:35], v[68:71], v[76:79], v[32:35]
 ds_read_b128 v[88:91], v9 offset:768
 ds_read_b64 v[92:93], v9 offset:1024
 v_smfmac_f32_16x16x64_bf16 v[20:23], v[120:123], a[224:231], v2
 v_smfmac_f32_16x16x64_bf16 v[24:27], v[120:123], a[232:239], v2
 s_nop 1
 v_exp_f32 v76, v36
 v_exp_f32 v77, v37
 v_smfmac_f32_16x16x64_bf16 v[20:23], v[124:127], a[240:247], v2
 v_exp_f32 v78, v38
 v_exp_f32 v79, v39
 v_exp_f32 v72, v32
 v_exp_f32 v73, v33
 v_smfmac_f32_16x16x64_bf16 v[24:27], v[124:127], a[248:255], v2
 v_exp_f32 v74, v34
 v_exp_f32_e64 v75, v35
 v_cvt_pk_bf16_f32 v40, v72, v73
 v_cvt_pk_bf16_f32 v41, v74, v75
 v_cvt_pk_bf16_f32 v42, v72, v73
 v_cvt_pk_bf16_f32 v43, v74, v75
 v_cvt_pk_bf16_f32 v44, v76, v77
 v_cvt_pk_bf16_f32 v45, v78, v79
 v_mov_b32_dpp v42, v40 row_ror:8 row_mask:0xf bank_mask:0x3
 v_mov_b32_dpp v43, v41 row_ror:8 row_mask:0xf bank_mask:0x3
 v_mov_b32_dpp v40, v40 row_ror:8 row_mask:0xf bank_mask:0xc
 v_mov_b32_dpp v41, v41 row_ror:8 row_mask:0xf bank_mask:0xc
 s_waitcnt lgkmcnt(0)
 s_nop 0
 v_mfma_f32_16x16x16_bf16 v[80:83], v[92:93], v[44:45], 0
 v_cvt_pk_bf16_f32 v84, v20, v21
 v_cvt_pk_bf16_f32 v85, v22, v23
 v_mfma_f32_16x16x32_bf16 v[72:75], v[56:59], v[40:43], 0
 v_cvt_pk_bf16_f32 v86, v24, v25
 v_cvt_pk_bf16_f32 v87, v26, v27
 v_mfma_f32_16x16x32_bf16 v[80:83], v[88:91], v[40:43], v[80:83]
 v_max3_f32 v46, abs(v32), abs(v33), abs(v34)
 v_max3_f32 v47, abs(v35), abs(v36), abs(v37)
 v_mfma_f32_16x16x32_bf16 v[76:79], v[60:63], v[40:43], 0
 v_max3_f32 v46, v46, abs(v38), abs(v39)
 v_max_f32 v46, v46, v47
 v_mfma_f32_16x16x16_bf16 v[72:75], v[84:85], v[44:45], v[72:75]
 v_cmp_nlt_f32 vcc, v46, s63
 v_mfma_f32_16x16x16_bf16 v[76:79], v[86:87], v[44:45], v[76:79]
 v_rcp_f32 v80, v80
 s_cbranch_vccnz L_chain_bigL
L_chain_bigokL:
 v_mov_b64 v[112:113], 0
 v_mov_b64 v[114:115], 0
 s_nop 2
 v_pk_mul_f32 v[72:73], v[72:73], v[80:81] op_sel_hi:[1,0]
 v_pk_mul_f32 v[74:75], v[74:75], v[80:81] op_sel_hi:[1,0]
 v_pk_mul_f32 v[76:77], v[76:77], v[80:81] op_sel_hi:[1,0]
 v_pk_mul_f32 v[78:79], v[78:79], v[80:81] op_sel_hi:[1,0]
 v_cvt_pk_bf16_f32 v96, v72, v73
 v_cvt_pk_bf16_f32 v98, v76, v77
 v_cvt_pk_bf16_f32 v97, v74, v75
 v_cvt_pk_bf16_f32 v99, v78, v79
 v_cndmask_b32 v80, v96, v98, s[64:65]
 v_cndmask_b32 v81, v97, v99, s[64:65]
 ds_write_b64 v8, v[80:81]
 v_smfmac_f32_16x16x64_bf16 v[112:115], v[96:99], v[128:135], v2
 v_mov_b64 v[116:117], 0
 v_mov_b64 v[118:119], 0
 v_mov_b64 v[120:121], 0
 v_mov_b64 v[122:123], 0
 v_mov_b64 v[124:125], 0
 v_mov_b64 v[126:127], 0
 v_smfmac_f32_16x16x64_bf16 v[116:119], v[96:99], v[160:167], v2
 v_and_b32_e64 v85, -16, v8
 v_xor_b32 v82, 512, v85
 v_xor_b32 v83, 1024, v85
 v_xor_b32 v84, 1536, v85
 s_waitcnt vmcnt(5) lgkmcnt(0)
 s_barrier
 ds_read_b128 v[100:103], v82
 ds_read_b128 v[104:107], v83
 ds_read_b128 v[108:111], v84
 ds_read_b128 v[40:43], v9
 v_smfmac_f32_16x16x64_bf16 v[120:123], v[96:99], v[192:199], v2
 s_add_u32 s55, s55, 1
 s_add_u32 s59, s59, 8192
 s_mov_b32 s30, 0
 v_smfmac_f32_16x16x64_bf16 v[124:127], v[96:99], v[224:231], v2
 s_xor_b32 s57, s57, 8192
 s_xor_b32 s58, s58, 8192
 s_xor_b32 s92, s92, 8192
 s_waitcnt lgkmcnt(3)
 v_smfmac_f32_16x16x64_bf16 v[112:115], v[100:103], v[136:143], v2
 s_waitcnt lgkmcnt(2)
 v_smfmac_f32_16x16x64_bf16 v[112:115], v[104:107], v[144:151], v2
 s_waitcnt lgkmcnt(1)
 v_smfmac_f32_16x16x64_bf16 v[112:115], v[108:111], v[152:159], v2
 v_smfmac_f32_16x16x64_bf16 v[116:119], v[100:103], v[168:175], v2
 v_smfmac_f32_16x16x64_bf16 v[116:119], v[104:107], v[176:183], v2
 v_smfmac_f32_16x16x64_bf16 v[116:119], v[108:111], v[184:191], v2
 v_smfmac_f32_16x16x64_bf16 v[120:123], v[100:103], v[200:207], v2
 v_smfmac_f32_16x16x64_bf16 v[120:123], v[104:107], v[208:215], v2
 s_nop 2
 v_cvt_pk_bf16_f32 v32, v112, v113
 v_cvt_pk_bf16_f32 v33, v114, v115
 v_smfmac_f32_16x16x64_bf16 v[120:123], v[108:111], v[216:223], v2
 v_and_or_b32 v32, v32, -2, s56
 v_smfmac_f32_16x16x64_bf16 v[124:127], v[100:103], v[232:239], v2
 v_cvt_pk_bf16_f32 v34, v116, v117
 v_cvt_pk_bf16_f32 v35, v118, v119
 v_smfmac_f32_16x16x64_bf16 v[124:127], v[104:107], v[240:247], v2
 buffer_store_dwordx4 v[32:35], v10, s[32:35], s61 offen
 v_smfmac_f32_16x16x64_bf16 v[124:127], v[108:111], v[248:255], v2
 v_nop_e64
 v_cvt_pk_bf16_f32 v36, v120, v121
 v_cvt_pk_bf16_f32 v37, v122, v123
 v_and_or_b32 v36, v36, -2, s56
 s_nop 2
 s_nop 0
 v_cvt_pk_bf16_f32 v38, v124, v125
 v_cvt_pk_bf16_f32 v39, v126, v127
 buffer_store_dwordx4 v[36:39], v10, s[32:35], s62 offen
 s_waitcnt vmcnt(1)
 v_mov_b64 v[20:21], 0
 v_mov_b64 v[22:23], 0
 v_mov_b64 v[24:25], 0
 v_mov_b64 v[26:27], 0
 buffer_load_dwordx4 v[96:99], v11, s[32:35], s61 offen sc1
 buffer_load_dwordx4 v[100:103], v11, s[32:35], s61 offen offset:1024 sc1
 s_waitcnt vmcnt(2)
 v_add_u32 v15, s94, v1
 ds_read_b128 v[48:51], v15 offset:0
 ds_read_b128 v[52:55], v15 offset:1024
 ds_read_b128 v[56:59], v15 offset:2048
 ds_read_b128 v[60:63], v15 offset:3072
 s_waitcnt lgkmcnt(0)
 buffer_load_dwordx4 v[112:115], v11, s[32:35], s61 offen sc1
 buffer_load_dwordx4 v[116:119], v11, s[32:35], s61 offen offset:1024 sc1
 s_waitcnt vmcnt(3)
 v_mfma_f32_16x16x32_bf16 v[104:107], v[40:43], v[96:99], 0
 s_waitcnt vmcnt(2)
 v_mfma_f32_16x16x32_bf16 v[104:107], v[40:43], v[100:103], v[104:107]
 v_bitop3_b32 v15, v96, v100, s56 bitop3:0x7e
 v_and_b32 v15, 1, v15
 v_cmp_ne_u32 vcc, 0, v15
 s_cbranch_vccnz L_chain_x1bL
L_chain_x1okL:
 s_nop 3
 v_add_f32_dpp v104, v104, v104 row_ror:4 row_mask:0xf bank_mask:0xf
 v_add_f32_dpp v105, v105, v105 row_ror:4 row_mask:0xf bank_mask:0xf
 s_xor_b32 s56, s56, 1
 v_add_f32_dpp v104, v104, v104 row_ror:8 row_mask:0xf bank_mask:0xf
 v_add_f32_dpp v105, v105, v105 row_ror:8 row_mask:0xf bank_mask:0xf
 v_cvt_pk_bf16_f32 v13, v104, v105
 v_min_u32 v13, -2, v13
 buffer_store_dword v13, v12, s[32:35], s57 offen
 s_branch L_chain_loopL
L_chain_x1bL:
 buffer_load_dwordx4 v[96:99], v11, s[32:35], s61 offen sc1
 buffer_load_dwordx4 v[100:103], v11, s[32:35], s61 offen offset:1024 sc1
 s_add_u32 s30, s30, 1
 s_cmp_gt_u32 s30, 524288
 s_cbranch_scc1 L_exit
 s_waitcnt vmcnt(3)
 v_mfma_f32_16x16x32_bf16 v[104:107], v[40:43], v[112:115], 0
 s_waitcnt vmcnt(2)
 v_mfma_f32_16x16x32_bf16 v[104:107], v[40:43], v[116:119], v[104:107]
 v_bitop3_b32 v15, v112, v116, s56 bitop3:0x7e
 v_and_b32 v15, 1, v15
 v_cmp_ne_u32 vcc, 0, v15
 s_cbranch_vccz L_chain_x1okL
 buffer_load_dwordx4 v[112:115], v11, s[32:35], s61 offen sc1
 buffer_load_dwordx4 v[116:119], v11, s[32:35], s61 offen offset:1024 sc1
 s_add_u32 s30, s30, 1
 s_cmp_gt_u32 s30, 524288
 s_cbranch_scc1 L_exit
 s_waitcnt vmcnt(3)
 v_mfma_f32_16x16x32_bf16 v[104:107], v[40:43], v[96:99], 0
 s_waitcnt vmcnt(2)
 v_mfma_f32_16x16x32_bf16 v[104:107], v[40:43], v[100:103], v[104:107]
 v_bitop3_b32 v15, v96, v100, s56 bitop3:0x7e
 v_and_b32 v15, 1, v15
 v_cmp_ne_u32 vcc, 0, v15
 s_cbranch_vccz L_chain_x1okL
 s_branch L_chain_x1bL
L_chain_x2bL:
 buffer_load_dwordx4 v[96:99], v1, s[32:35], s92 offen sc1
 buffer_load_dwordx4 v[100:103], v1, s[32:35], s92 offen offset:1024 sc1
 s_add_u32 s30, s30, 1
 s_cmp_gt_u32 s30, 524288
 s_cbranch_scc1 L_exit
 v_mov_b64 v[36:37], 0
 v_mov_b64 v[38:39], 0
 v_mov_b64 v[44:45], 0
 v_mov_b64 v[46:47], 0
 s_waitcnt vmcnt(3)
 v_smfmac_f32_16x16x64_bf16 v[36:39], v[104:107], a[0:7], v2
 v_max3_u32 v15, v104, v105, v106
 v_smfmac_f32_16x16x64_bf16 v[44:47], v[104:107], a[8:15], v2
 s_waitcnt vmcnt(2)
 v_max3_u32 v15, v15, v107, v108
 ds_write_b128 v0, v[104:107]
 v_max3_u32 v15, v15, v109, v110
 v_max_u32 v15, v15, v111
 v_cmp_eq_u32 vcc, -1, v15
 v_smfmac_f32_16x16x64_bf16 v[36:39], v[108:111], a[16:23], v2
 ds_write_b128 v0, v[108:111] offset:1024
 v_smfmac_f32_16x16x64_bf16 v[44:47], v[108:111], a[24:31], v2
 s_cbranch_vccz L_chain_x2cL
 buffer_load_dwordx4 v[104:107], v1, s[32:35], s92 offen sc1
 buffer_load_dwordx4 v[108:111], v1, s[32:35], s92 offen offset:1024 sc1
 s_add_u32 s30, s30, 1
 s_cmp_gt_u32 s30, 524288
 s_cbranch_scc1 L_exit
 v_mov_b64 v[36:37], 0
 v_mov_b64 v[38:39], 0
 v_mov_b64 v[44:45], 0
 v_mov_b64 v[46:47], 0
 s_waitcnt vmcnt(3)
 v_smfmac_f32_16x16x64_bf16 v[36:39], v[96:99], a[0:7], v2
 v_max3_u32 v15, v96, v97, v98
 v_smfmac_f32_16x16x64_bf16 v[44:47], v[96:99], a[8:15], v2
 s_waitcnt vmcnt(2)
 v_max3_u32 v15, v15, v99, v100
 ds_write_b128 v0, v[96:99]
 v_max3_u32 v15, v15, v101, v102
 v_max_u32 v15, v15, v103
 v_cmp_eq_u32 vcc, -1, v15
 v_smfmac_f32_16x16x64_bf16 v[36:39], v[100:103], a[16:23], v2
 ds_write_b128 v0, v[100:103] offset:1024
 v_smfmac_f32_16x16x64_bf16 v[44:47], v[100:103], a[24:31], v2
 s_cbranch_vccz L_chain_x2okL
 s_branch L_chain_x2bL
L_chain_x2cL:
 v_mov_b64 v[96:97], v[104:105]
 v_mov_b64 v[98:99], v[106:107]
 v_mov_b64 v[100:101], v[108:109]
 v_mov_b64 v[102:103], v[110:111]
 s_branch L_chain_x2okL
L_chain_bigL:
 v_max3_f32 v46, v36, v37, v38
 v_max3_f32 v47, v32, v33, v34
 v_max3_f32 v46, v46, v39, v35
 v_max_f32 v46, v46, v47
 s_nop 1
 v_max_f32_dpp v46, v46, v46 row_ror:8 row_mask:0xf bank_mask:0xf
 v_mov_b32 v47, v46
 s_nop 1
 v_permlane16_swap_b32 v46, v47
 v_max_f32 v46, v46, v47
 v_mov_b32 v47, v46
 s_nop 1
 v_permlane32_swap_b32 v46, v47
 v_max_f32 v46, v46, v47
 v_mul_f32_e64 v46, s96, v46
 v_fma_f32 v72, v32, s96, -v46
 v_fma_f32 v73, v33, s96, -v46
 v_fma_f32 v74, v34, s96, -v46
 v_fma_f32 v75, v35, s96, -v46
 v_fma_f32 v76, v36, s96, -v46
 v_fma_f32 v77, v37, s96, -v46
 v_fma_f32 v78, v38, s96, -v46
 v_fma_f32 v79, v39, s96, -v46
 v_exp_f32 v72, v72
 v_exp_f32 v73, v73
 v_exp_f32 v74, v74
 v_exp_f32 v75, v75
 v_exp_f32 v76, v76
 v_exp_f32 v77, v77
 v_exp_f32 v78, v78
 v_exp_f32 v79, v79
 v_cvt_pk_bf16_f32 v40, v72, v73
 v_cvt_pk_bf16_f32 v41, v74, v75
 v_cvt_pk_bf16_f32 v42, v72, v73
 v_cvt_pk_bf16_f32 v43, v74, v75
 v_cvt_pk_bf16_f32 v44, v76, v77
 v_cvt_pk_bf16_f32 v45, v78, v79
 v_mov_b32_dpp v42, v40 row_ror:8 row_mask:0xf bank_mask:0x3
 v_mov_b32_dpp v43, v41 row_ror:8 row_mask:0xf bank_mask:0x3
 v_mov_b32_dpp v40, v40 row_ror:8 row_mask:0xf bank_mask:0xc
 v_mov_b32_dpp v41, v41 row_ror:8 row_mask:0xf bank_mask:0xc
 v_mfma_f32_16x16x16_bf16 v[80:83], v[92:93], v[44:45], 0
 s_nop 0
 v_mfma_f32_16x16x32_bf16 v[72:75], v[56:59], v[40:43], 0
 v_mfma_f32_16x16x32_bf16 v[80:83], v[88:91], v[40:43], v[80:83]
 v_mfma_f32_16x16x32_bf16 v[76:79], v[60:63], v[40:43], 0
 v_mfma_f32_16x16x16_bf16 v[72:75], v[84:85], v[44:45], v[72:75]
 v_mfma_f32_16x16x16_bf16 v[76:79], v[86:87], v[44:45], v[76:79]
 s_nop 4
 v_rcp_f32 v80, v80
 s_branch L_chain_bigokL
L_chain_lastL:
 buffer_store_dword v13, v12, s[32:35], s59 offen sc1
 s_waitcnt vmcnt(0) lgkmcnt(0)
 s_branch L_done
L_chain_kvwaitL:
 s_mov_b32 s30, 0
L_kvspin_101:
 buffer_load_dwordx4 v[48:51], v1, s[32:35], s60 offen offset:0 sc1
 buffer_load_dwordx4 v[52:55], v1, s[32:35], s60 offen offset:1024 sc1
 buffer_load_dwordx4 v[56:59], v1, s[32:35], s60 offen offset:2048 sc1
 buffer_load_dwordx4 v[60:63], v1, s[32:35], s60 offen offset:3072 sc1
 s_add_u32 s30, s30, 1
 s_cmp_gt_u32 s30, 524288
 s_cbranch_scc1 L_exit
 s_waitcnt vmcnt(0)
 v_bitop3_b32 v15, v48, v52, s95 bitop3:0x7e
 v_bitop3_b32 v120, v56, v60, s95 bitop3:0x7e
 v_or_b32 v15, v15, v120
 v_and_b32 v15, 1, v15
 v_cmp_ne_u32 vcc, 0, v15
 s_cbranch_vccz L_chain_kvokL
 s_sleep 1
 s_branch L_kvspin_101
L_chain_entryG:
 v_min_u32 v13, -2, v13
 buffer_store_dword v13, v12, s[32:35], s57 offen sc1
.p2align 6
L_chain_loopG:
 s_cmp_eq_u32 s55, 63
 s_cbranch_scc1 L_chain_lastG
 ds_read_b128 v[64:67], v3 offset:0
 ds_read_b128 v[68:71], v3 offset:1024
 ds_read_b128 v[72:75], v3 offset:2048
 ds_read_b128 v[76:79], v3 offset:3072
 s_waitcnt lgkmcnt(0)
 v_mov_b64 v[32:33], 0
 v_mov_b64 v[34:35], 0
 v_mov_b64 v[36:37], 0
 v_mov_b64 v[38:39], 0
 v_mov_b64 v[40:41], 0
 v_mov_b64 v[42:43], 0
 v_mov_b64 v[44:45], 0
 v_mov_b64_e64 v[46:47], 0
 s_bfe_u32 s95, s55, 0x10002
 v_bitop3_b32 v15, v48, v52, s95 bitop3:0x7e
 v_bitop3_b32 v120, v56, v60, s95 bitop3:0x7e
 v_or_b32 v15, v15, v120
 v_and_b32 v15, 1, v15
 v_cmp_ne_u32 vcc, 0, v15
 s_cbranch_vccnz L_chain_kvwaitG
L_chain_kvokG:
 s_mov_b32 s30, 0
 buffer_load_dwordx4 v[96:99], v1, s[32:35], s92 offen sc1
 buffer_load_dwordx4 v[100:103], v1, s[32:35], s92 offen offset:1024 sc1
 ds_read_b128 v[80:83], v3 offset:16384
 ds_read_b128 v[84:87], v3 offset:17408
 ds_read_b128 v[88:91], v3 offset:18432
 ds_read_b128 v[92:95], v3 offset:19456
 s_waitcnt lgkmcnt(0)
 s_add_u32 s60, s55, 1
 s_and_b32 s60, s60, 3
 s_lshl_b32 s60, s60, 19
 s_add_u32 s60, s60, s93
 buffer_load_dwordx4 v[104:107], v1, s[32:35], s92 offen sc1
 buffer_load_dwordx4 v[108:111], v1, s[32:35], s92 offen offset:1024 sc1
 s_waitcnt vmcnt(3)
 v_smfmac_f32_16x16x64_bf16 v[36:39], v[96:99], a[0:7], v2
 v_max3_u32 v15, v96, v97, v98
 v_smfmac_f32_16x16x64_bf16 v[44:47], v[96:99], a[8:15], v2
 s_waitcnt vmcnt(2)
 v_max3_u32 v15, v15, v99, v100
 ds_write_b128 v0, v[96:99]
 v_max3_u32 v15, v15, v101, v102
 v_max_u32 v15, v15, v103
 v_cmp_eq_u32 vcc, -1, v15
 v_smfmac_f32_16x16x64_bf16 v[36:39], v[100:103], a[16:23], v2
 ds_write_b128 v0, v[100:103] offset:1024
 v_smfmac_f32_16x16x64_bf16 v[44:47], v[100:103], a[24:31], v2
 s_cbranch_vccnz L_chain_x2bG
L_chain_x2okG:
 v_xor_b32 v15, 0x8000, v3
 v_smfmac_f32_16x16x64_bf16 v[32:35], v[96:99], v[64:71], v2
 ds_read_b128 v[64:67], v15 offset:0
 ds_read_b128 v[68:71], v15 offset:1024
 v_smfmac_f32_16x16x64_bf16 v[40:43], v[96:99], v[72:79], v2
 ds_read_b128 v[72:75], v15 offset:2048
 ds_read_b128 v[76:79], v15 offset:3072
 v_smfmac_f32_16x16x64_bf16 v[32:35], v[100:103], v[80:87], v2
 ds_read_b128 v[80:83], v15 offset:16384
 ds_read_b128 v[84:87], v15 offset:17408
 v_smfmac_f32_16x16x64_bf16 v[40:43], v[100:103], v[88:95], v2
 ds_read_b128 v[88:91], v15 offset:18432
 ds_read_b128 v[92:95], v15 offset:19456
 buffer_store_dword v14, v12, s[32:35], s58 offen sc1
 s_waitcnt vmcnt(1) lgkmcnt(8)
 s_barrier
 v_xor_b32 v15, 2048, v0
 ds_read_b128 v[104:107], v15
 ds_read_b128 v[108:111], v15 offset:1024
 v_smfmac_f32_16x16x64_bf16 v[20:23], v[96:99], a[128:135], v2
 v_xor_b32 v15, 4096, v0
 ds_read_b128 v[112:115], v15
 ds_read_b128 v[116:119], v15 offset:1024
 v_smfmac_f32_16x16x64_bf16 v[24:27], v[96:99], a[136:143], v2
 v_xor_b32 v15, 6144, v0
 ds_read_b128 v[120:123], v15
 ds_read_b128 v[124:127], v15 offset:1024
 buffer_store_dword v13, v12, s[32:35], s59 offen sc1
 v_smfmac_f32_16x16x64_bf16 v[20:23], v[100:103], a[144:151], v2
 v_smfmac_f32_16x16x64_bf16 v[24:27], v[100:103], a[152:159], v2
 v_xor_b32 v15, 0x10000, v3
 s_waitcnt lgkmcnt(5)
 v_smfmac_f32_16x16x64_bf16 v[32:35], v[104:107], v[64:71], v2
 ds_read_b128 v[64:67], v15 offset:0
 v_smfmac_f32_16x16x64_bf16 v[36:39], v[104:107], a[32:39], v2
 ds_read_b128 v[68:71], v15 offset:1024
 v_smfmac_f32_16x16x64_bf16 v[40:43], v[104:107], v[72:79], v2
 ds_read_b128 v[72:75], v15 offset:2048
 v_smfmac_f32_16x16x64_bf16 v[44:47], v[104:107], a[40:47], v2
 ds_read_b128 v[76:79], v15 offset:3072
 s_waitcnt lgkmcnt(8)
 v_smfmac_f32_16x16x64_bf16 v[32:35], v[108:111], v[80:87], v2
 ds_read_b128 v[80:83], v15 offset:16384
 v_smfmac_f32_16x16x64_bf16 v[36:39], v[108:111], a[48:55], v2
 ds_read_b128 v[84:87], v15 offset:17408
 v_smfmac_f32_16x16x64_bf16 v[40:43], v[108:111], v[88:95], v2
 ds_read_b128 v[88:91], v15 offset:18432
 v_smfmac_f32_16x16x64_bf16 v[44:47], v[108:111], a[56:63], v2
 ds_read_b128 v[92:95], v15 offset:19456
 buffer_load_dwordx4 v1, s[32:35], s60 offen offset:0 sc1 lds
 v_xor_b32 v15, 0x18000, v3
 s_waitcnt lgkmcnt(4)
 v_smfmac_f32_16x16x64_bf16 v[32:35], v[112:115], v[64:71], v2
 ds_read_b128 v[64:67], v15 offset:0
 v_smfmac_f32_16x16x64_bf16 v[36:39], v[112:115], a[64:71], v2
 ds_read_b128 v[68:71], v15 offset:1024
 v_smfmac_f32_16x16x64_bf16 v[40:43], v[112:115], v[72:79], v2
 ds_read_b128 v[72:75], v15 offset:2048
 v_smfmac_f32_16x16x64_bf16 v[44:47], v[112:115], a[72:79], v2
 ds_read_b128 v[76:79], v15 offset:3072
 s_waitcnt lgkmcnt(4)
 v_smfmac_f32_16x16x64_bf16 v[32:35], v[116:119], v[80:87], v2
 ds_read_b128 v[80:83], v15 offset:16384
 v_smfmac_f32_16x16x64_bf16 v[36:39], v[116:119], a[80:87], v2
 ds_read_b128 v[84:87], v15 offset:17408
 v_smfmac_f32_16x16x64_bf16 v[40:43], v[116:119], v[88:95], v2
 ds_read_b128 v[88:91], v15 offset:18432
 v_smfmac_f32_16x16x64_bf16 v[44:47], v[116:119], a[88:95], v2
 ds_read_b128 v[92:95], v15 offset:19456
 buffer_load_dwordx4 v1, s[32:35], s60 offen offset:1024 sc1 lds
 v_smfmac_f32_16x16x64_bf16 v[36:39], v[120:123], a[96:103], v2
 v_smfmac_f32_16x16x64_bf16 v[36:39], v[124:127], a[112:119], v2
 s_waitcnt lgkmcnt(6)
 v_smfmac_f32_16x16x64_bf16 v[32:35], v[120:123], v[64:71], v2
 s_waitcnt lgkmcnt(2)
 v_smfmac_f32_16x16x64_bf16 v[32:35], v[124:127], v[80:87], v2
 buffer_load_dwordx4 v1, s[32:35], s60 offen offset:2048 sc1 lds
 v_smfmac_f32_16x16x64_bf16 v[40:43], v[120:123], v[72:79], v2
 ds_read_b128 v[64:67], v9 offset:256
 s_waitcnt lgkmcnt(1)
 v_smfmac_f32_16x16x64_bf16 v[40:43], v[124:127], v[88:95], v2
 v_cvt_pk_bf16_f32 v74, v36, v37
 v_smfmac_f32_16x16x64_bf16 v[44:47], v[120:123], a[104:111], v2
 v_cvt_pk_bf16_f32 v75, v38, v39
 v_smfmac_f32_16x16x64_bf16 v[44:47], v[124:127], a[120:127], v2
 v_cvt_pk_bf16_f32 v72, v32, v33
 v_cvt_pk_bf16_f32 v73, v34, v35
 s_nop 0
 s_nop 0
 v_cvt_pk_bf16_f32 v76, v40, v41
 v_cvt_pk_bf16_f32 v77, v42, v43
 v_mfma_f32_16x16x32_bf16 v[80:83], v[72:75], v[16:19], 0
 ds_read_b128 v[68:71], v9 offset:512
 v_cvt_pk_bf16_f32 v78, v44, v45
 v_cvt_pk_bf16_f32 v79, v46, v47
 s_nop 1
 v_mfma_f32_16x16x32_bf16 v[84:87], v[76:79], v[16:19], 0
 s_nop 1
 v_cvt_pk_bf16_f32 v88, v80, v81
 v_cvt_pk_bf16_f32 v89, v82, v83
 s_nop 2
 s_nop 0
 v_cvt_pk_bf16_f32 v90, v84, v85
 v_cvt_pk_bf16_f32 v91, v86, v87
 s_nop 1
 v_mfma_f32_16x16x32_bf16 v[32:35], v[48:51], v[88:91], 0
 v_mfma_f32_16x16x32_bf16 v[36:39], v[52:55], v[88:91], 0
 v_mfma_f32_16x16x32_bf16 v[40:43], v[88:91], v[88:91], 0
 s_nop 5
 v_cvt_pk_bf16_f32 v44, v32, v33
 v_cvt_pk_bf16_f32 v45, v34, v35
 v_cvt_pk_bf16_f32 v46, v36, v37
 v_cvt_pk_bf16_f32 v47, v38, v39
 ds_write2_b64 v4, v[44:45], v[46:47] offset0:0 offset1:16
 v_cvt_pk_bf16_f32 v92, v40, v41
 v_cvt_pk_bf16_f32 v93, v42, v43
 ds_write_b64 v5, v[92:93]
 buffer_load_dwordx4 v1, s[32:35], s60 offen offset:3072 sc1 lds
 v_smfmac_f32_16x16x64_bf16 v[20:23], v[104:107], a[160:167], v2
 v_smfmac_f32_16x16x64_bf16 v[24:27], v[104:107], a[168:175], v2
 v_smfmac_f32_16x16x64_bf16 v[20:23], v[108:111], a[176:183], v2
 v_smfmac_f32_16x16x64_bf16 v[24:27], v[108:111], a[184:191], v2
 v_smfmac_f32_16x16x64_bf16 v[20:23], v[112:115], a[192:199], v2
 s_waitcnt lgkmcnt(0)
 s_barrier
 ds_read_b128 v[72:75], v6
 ds_read_b128 v[80:83], v7
 ds_read_b128 v[76:79], v6 offset:256
 v_smfmac_f32_16x16x64_bf16 v[24:27], v[112:115], a[200:207], v2
 v_smfmac_f32_16x16x64_bf16 v[20:23], v[116:119], a[208:215], v2
 v_smfmac_f32_16x16x64_bf16 v[24:27], v[116:119], a[216:223], v2
 s_waitcnt lgkmcnt(1)
 v_mfma_f32_16x16x32_bf16 v[32:35], v[64:67], v[72:75], 0
 v_mfma_f32_16x16x32_bf16 v[36:39], v[28:31], v[80:83], 0
 s_waitcnt lgkmcnt(0)
 v_mfma_f32_16x16x32_bf16 v[32:35], v[68:71], v[76:79], v[32:35]
 ds_read_b128 v[88:91], v9 offset:768
 ds_read_b64 v[92:93], v9 offset:1024
 v_smfmac_f32_16x16x64_bf16 v[20:23], v[120:123], a[224:231], v2
 v_smfmac_f32_16x16x64_bf16 v[24:27], v[120:123], a[232:239], v2
 s_nop 1
 v_exp_f32 v76, v36
 v_exp_f32 v77, v37
 v_smfmac_f32_16x16x64_bf16 v[20:23], v[124:127], a[240:247], v2
 v_exp_f32 v78, v38
 v_exp_f32 v79, v39
 v_exp_f32 v72, v32
 v_exp_f32 v73, v33
 v_smfmac_f32_16x16x64_bf16 v[24:27], v[124:127], a[248:255], v2
 v_exp_f32 v74, v34
 v_exp_f32_e64 v75, v35
 v_cvt_pk_bf16_f32 v40, v72, v73
 v_cvt_pk_bf16_f32 v41, v74, v75
 v_cvt_pk_bf16_f32 v42, v72, v73
 v_cvt_pk_bf16_f32 v43, v74, v75
 v_cvt_pk_bf16_f32 v44, v76, v77
 v_cvt_pk_bf16_f32 v45, v78, v79
 v_mov_b32_dpp v42, v40 row_ror:8 row_mask:0xf bank_mask:0x3
 v_mov_b32_dpp v43, v41 row_ror:8 row_mask:0xf bank_mask:0x3
 v_mov_b32_dpp v40, v40 row_ror:8 row_mask:0xf bank_mask:0xc
 v_mov_b32_dpp v41, v41 row_ror:8 row_mask:0xf bank_mask:0xc
 s_waitcnt lgkmcnt(0)
 s_nop 0
 v_mfma_f32_16x16x16_bf16 v[80:83], v[92:93], v[44:45], 0
 v_cvt_pk_bf16_f32 v84, v20, v21
 v_cvt_pk_bf16_f32 v85, v22, v23
 v_mfma_f32_16x16x32_bf16 v[72:75], v[56:59], v[40:43], 0
 v_cvt_pk_bf16_f32 v86, v24, v25
 v_cvt_pk_bf16_f32 v87, v26, v27
 v_mfma_f32_16x16x32_bf16 v[80:83], v[88:91], v[40:43], v[80:83]
 v_max3_f32 v46, abs(v32), abs(v33), abs(v34)
 v_max3_f32 v47, abs(v35), abs(v36), abs(v37)
 v_mfma_f32_16x16x32_bf16 v[76:79], v[60:63], v[40:43], 0
 v_max3_f32 v46, v46, abs(v38), abs(v39)
 v_max_f32 v46, v46, v47
 v_mfma_f32_16x16x16_bf16 v[72:75], v[84:85], v[44:45], v[72:75]
 v_cmp_nlt_f32 vcc, v46, s63
 v_mfma_f32_16x16x16_bf16 v[76:79], v[86:87], v[44:45], v[76:79]
 v_rcp_f32 v80, v80
 s_cbranch_vccnz L_chain_bigG
L_chain_bigokG:
 v_mov_b64 v[112:113], 0
 v_mov_b64 v[114:115], 0
 s_nop 2
 v_pk_mul_f32 v[72:73], v[72:73], v[80:81] op_sel_hi:[1,0]
 v_pk_mul_f32 v[74:75], v[74:75], v[80:81] op_sel_hi:[1,0]
 v_pk_mul_f32 v[76:77], v[76:77], v[80:81] op_sel_hi:[1,0]
 v_pk_mul_f32 v[78:79], v[78:79], v[80:81] op_sel_hi:[1,0]
 v_cvt_pk_bf16_f32 v96, v72, v73
 v_cvt_pk_bf16_f32 v98, v76, v77
 v_cvt_pk_bf16_f32 v97, v74, v75
 v_cvt_pk_bf16_f32 v99, v78, v79
 v_cndmask_b32 v80, v96, v98, s[64:65]
 v_cndmask_b32 v81, v97, v99, s[64:65]
 ds_write_b64 v8, v[80:81]
 v_smfmac_f32_16x16x64_bf16 v[112:115], v[96:99], v[128:135], v2
 v_mov_b64 v[116:117], 0
 v_mov_b64 v[118:119], 0
 v_mov_b64 v[120:121], 0
 v_mov_b64 v[122:123], 0
 v_mov_b64 v[124:125], 0
 v_mov_b64 v[126:127], 0
 v_smfmac_f32_16x16x64_bf16 v[116:119], v[96:99], v[160:167], v2
 v_and_b32_e64 v85, -16, v8
 v_xor_b32 v82, 512, v85
 v_xor_b32 v83, 1024, v85
 v_xor_b32 v84, 1536, v85
 s_waitcnt vmcnt(5) lgkmcnt(0)
 s_barrier
 ds_read_b128 v[100:103], v82
 ds_read_b128 v[104:107], v83
 ds_read_b128 v[108:111], v84
 ds_read_b128 v[40:43], v9
 v_smfmac_f32_16x16x64_bf16 v[120:123], v[96:99], v[192:199], v2
 s_add_u32 s55, s55, 1
 s_add_u32 s59, s59, 8192
 s_mov_b32 s30, 0
 v_smfmac_f32_16x16x64_bf16 v[124:127], v[96:99], v[224:231], v2
 s_xor_b32 s57, s57, 8192
 s_xor_b32 s58, s58, 8192
 s_xor_b32 s92, s92, 8192
 s_waitcnt lgkmcnt(3)
 v_smfmac_f32_16x16x64_bf16 v[112:115], v[100:103], v[136:143], v2
 s_waitcnt lgkmcnt(2)
 v_smfmac_f32_16x16x64_bf16 v[112:115], v[104:107], v[144:151], v2
 s_waitcnt lgkmcnt(1)
 v_smfmac_f32_16x16x64_bf16 v[112:115], v[108:111], v[152:159], v2
 v_smfmac_f32_16x16x64_bf16 v[116:119], v[100:103], v[168:175], v2
 v_smfmac_f32_16x16x64_bf16 v[116:119], v[104:107], v[176:183], v2
 v_smfmac_f32_16x16x64_bf16 v[116:119], v[108:111], v[184:191], v2
 v_smfmac_f32_16x16x64_bf16 v[120:123], v[100:103], v[200:207], v2
 v_smfmac_f32_16x16x64_bf16 v[120:123], v[104:107], v[208:215], v2
 s_nop 2
 v_cvt_pk_bf16_f32 v32, v112, v113
 v_cvt_pk_bf16_f32 v33, v114, v115
 v_smfmac_f32_16x16x64_bf16 v[120:123], v[108:111], v[216:223], v2
 v_and_or_b32 v32, v32, -2, s56
 v_smfmac_f32_16x16x64_bf16 v[124:127], v[100:103], v[232:239], v2
 v_cvt_pk_bf16_f32 v34, v116, v117
 v_cvt_pk_bf16_f32 v35, v118, v119
 v_smfmac_f32_16x16x64_bf16 v[124:127], v[104:107], v[240:247], v2
 buffer_store_dwordx4 v[32:35], v10, s[32:35], s61 offen sc1
 v_smfmac_f32_16x16x64_bf16 v[124:127], v[108:111], v[248:255], v2
 v_nop_e64
 v_cvt_pk_bf16_f32 v36, v120, v121
 v_cvt_pk_bf16_f32 v37, v122, v123
 v_and_or_b32 v36, v36, -2, s56
 s_nop 2
 s_nop 0
 v_cvt_pk_bf16_f32 v38, v124, v125
 v_cvt_pk_bf16_f32 v39, v126, v127
 buffer_store_dwordx4 v[36:39], v10, s[32:35], s62 offen sc1
 s_waitcnt vmcnt(1)
 v_mov_b64 v[20:21], 0
 v_mov_b64 v[22:23], 0
 v_mov_b64 v[24:25], 0
 v_mov_b64 v[26:27], 0
 buffer_load_dwordx4 v[96:99], v11, s[32:35], s61 offen sc1
 buffer_load_dwordx4 v[100:103], v11, s[32:35], s61 offen offset:1024 sc1
 s_waitcnt vmcnt(2)
 v_add_u32 v15, s94, v1
 ds_read_b128 v[48:51], v15 offset:0
 ds_read_b128 v[52:55], v15 offset:1024
 ds_read_b128 v[56:59], v15 offset:2048
 ds_read_b128 v[60:63], v15 offset:3072
 s_waitcnt lgkmcnt(0)
 buffer_load_dwordx4 v[112:115], v11, s[32:35], s61 offen sc1
 buffer_load_dwordx4 v[116:119], v11, s[32:35], s61 offen offset:1024 sc1
 s_waitcnt vmcnt(3)
 v_mfma_f32_16x16x32_bf16 v[104:107], v[40:43], v[96:99], 0
 s_waitcnt vmcnt(2)
 v_mfma_f32_16x16x32_bf16 v[104:107], v[40:43], v[100:103], v[104:107]
 v_bitop3_b32 v15, v96, v100, s56 bitop3:0x7e
 v_and_b32 v15, 1, v15
 v_cmp_ne_u32 vcc, 0, v15
 s_cbranch_vccnz L_chain_x1bG
L_chain_x1okG:
 s_nop 3
 v_add_f32_dpp v104, v104, v104 row_ror:4 row_mask:0xf bank_mask:0xf
 v_add_f32_dpp v105, v105, v105 row_ror:4 row_mask:0xf bank_mask:0xf
 s_xor_b32 s56, s56, 1
 v_add_f32_dpp v104, v104, v104 row_ror:8 row_mask:0xf bank_mask:0xf
 v_add_f32_dpp v105, v105, v105 row_ror:8 row_mask:0xf bank_mask:0xf
 v_cvt_pk_bf16_f32 v13, v104, v105
 v_min_u32 v13, -2, v13
 buffer_store_dword v13, v12, s[32:35], s57 offen sc1
 s_branch L_chain_loopG
L_chain_x1bG:
 buffer_load_dwordx4 v[96:99], v11, s[32:35], s61 offen sc1
 buffer_load_dwordx4 v[100:103], v11, s[32:35], s61 offen offset:1024 sc1
 s_add_u32 s30, s30, 1
 s_cmp_gt_u32 s30, 524288
 s_cbranch_scc1 L_exit
 s_waitcnt vmcnt(3)
 v_mfma_f32_16x16x32_bf16 v[104:107], v[40:43], v[112:115], 0
 s_waitcnt vmcnt(2)
 v_mfma_f32_16x16x32_bf16 v[104:107], v[40:43], v[116:119], v[104:107]
 v_bitop3_b32 v15, v112, v116, s56 bitop3:0x7e
 v_and_b32 v15, 1, v15
 v_cmp_ne_u32 vcc, 0, v15
 s_cbranch_vccz L_chain_x1okG
 buffer_load_dwordx4 v[112:115], v11, s[32:35], s61 offen sc1
 buffer_load_dwordx4 v[116:119], v11, s[32:35], s61 offen offset:1024 sc1
 s_add_u32 s30, s30, 1
 s_cmp_gt_u32 s30, 524288
 s_cbranch_scc1 L_exit
 s_waitcnt vmcnt(3)
 v_mfma_f32_16x16x32_bf16 v[104:107], v[40:43], v[96:99], 0
 s_waitcnt vmcnt(2)
 v_mfma_f32_16x16x32_bf16 v[104:107], v[40:43], v[100:103], v[104:107]
 v_bitop3_b32 v15, v96, v100, s56 bitop3:0x7e
 v_and_b32 v15, 1, v15
 v_cmp_ne_u32 vcc, 0, v15
 s_cbranch_vccz L_chain_x1okG
 s_branch L_chain_x1bG
L_chain_x2bG:
 buffer_load_dwordx4 v[96:99], v1, s[32:35], s92 offen sc1
 buffer_load_dwordx4 v[100:103], v1, s[32:35], s92 offen offset:1024 sc1
 s_add_u32 s30, s30, 1
 s_cmp_gt_u32 s30, 524288
 s_cbranch_scc1 L_exit
 v_mov_b64 v[36:37], 0
 v_mov_b64 v[38:39], 0
 v_mov_b64 v[44:45], 0
 v_mov_b64 v[46:47], 0
 s_waitcnt vmcnt(3)
 v_smfmac_f32_16x16x64_bf16 v[36:39], v[104:107], a[0:7], v2
 v_max3_u32 v15, v104, v105, v106
 v_smfmac_f32_16x16x64_bf16 v[44:47], v[104:107], a[8:15], v2
 s_waitcnt vmcnt(2)
 v_max3_u32 v15, v15, v107, v108
 ds_write_b128 v0, v[104:107]
 v_max3_u32 v15, v15, v109, v110
 v_max_u32 v15, v15, v111
 v_cmp_eq_u32 vcc, -1, v15
 v_smfmac_f32_16x16x64_bf16 v[36:39], v[108:111], a[16:23], v2
 ds_write_b128 v0, v[108:111] offset:1024
 v_smfmac_f32_16x16x64_bf16 v[44:47], v[108:111], a[24:31], v2
 s_cbranch_vccz L_chain_x2cG
 buffer_load_dwordx4 v[104:107], v1, s[32:35], s92 offen sc1
 buffer_load_dwordx4 v[108:111], v1, s[32:35], s92 offen offset:1024 sc1
 s_add_u32 s30, s30, 1
 s_cmp_gt_u32 s30, 524288
 s_cbranch_scc1 L_exit
 v_mov_b64 v[36:37], 0
 v_mov_b64 v[38:39], 0
 v_mov_b64 v[44:45], 0
 v_mov_b64 v[46:47], 0
 s_waitcnt vmcnt(3)
 v_smfmac_f32_16x16x64_bf16 v[36:39], v[96:99], a[0:7], v2
 v_max3_u32 v15, v96, v97, v98
 v_smfmac_f32_16x16x64_bf16 v[44:47], v[96:99], a[8:15], v2
 s_waitcnt vmcnt(2)
 v_max3_u32 v15, v15, v99, v100
 ds_write_b128 v0, v[96:99]
 v_max3_u32 v15, v15, v101, v102
 v_max_u32 v15, v15, v103
 v_cmp_eq_u32 vcc, -1, v15
 v_smfmac_f32_16x16x64_bf16 v[36:39], v[100:103], a[16:23], v2
 ds_write_b128 v0, v[100:103] offset:1024
 v_smfmac_f32_16x16x64_bf16 v[44:47], v[100:103], a[24:31], v2
 s_cbranch_vccz L_chain_x2okG
 s_branch L_chain_x2bG
L_chain_x2cG:
 v_mov_b64 v[96:97], v[104:105]
 v_mov_b64 v[98:99], v[106:107]
 v_mov_b64 v[100:101], v[108:109]
 v_mov_b64 v[102:103], v[110:111]
 s_branch L_chain_x2okG
L_chain_bigG:
 v_max3_f32 v46, v36, v37, v38
 v_max3_f32 v47, v32, v33, v34
 v_max3_f32 v46, v46, v39, v35
 v_max_f32 v46, v46, v47
 s_nop 1
 v_max_f32_dpp v46, v46, v46 row_ror:8 row_mask:0xf bank_mask:0xf
 v_mov_b32 v47, v46
 s_nop 1
 v_permlane16_swap_b32 v46, v47
 v_max_f32 v46, v46, v47
 v_mov_b32 v47, v46
 s_nop 1
 v_permlane32_swap_b32 v46, v47
 v_max_f32 v46, v46, v47
 v_mul_f32_e64 v46, s96, v46
 v_fma_f32 v72, v32, s96, -v46
 v_fma_f32 v73, v33, s96, -v46
 v_fma_f32 v74, v34, s96, -v46
 v_fma_f32 v75, v35, s96, -v46
 v_fma_f32 v76, v36, s96, -v46
 v_fma_f32 v77, v37, s96, -v46
 v_fma_f32 v78, v38, s96, -v46
 v_fma_f32 v79, v39, s96, -v46
 v_exp_f32 v72, v72
 v_exp_f32 v73, v73
 v_exp_f32 v74, v74
 v_exp_f32 v75, v75
 v_exp_f32 v76, v76
 v_exp_f32 v77, v77
 v_exp_f32 v78, v78
 v_exp_f32 v79, v79
 v_cvt_pk_bf16_f32 v40, v72, v73
 v_cvt_pk_bf16_f32 v41, v74, v75
 v_cvt_pk_bf16_f32 v42, v72, v73
 v_cvt_pk_bf16_f32 v43, v74, v75
 v_cvt_pk_bf16_f32 v44, v76, v77
 v_cvt_pk_bf16_f32 v45, v78, v79
 v_mov_b32_dpp v42, v40 row_ror:8 row_mask:0xf bank_mask:0x3
 v_mov_b32_dpp v43, v41 row_ror:8 row_mask:0xf bank_mask:0x3
 v_mov_b32_dpp v40, v40 row_ror:8 row_mask:0xf bank_mask:0xc
 v_mov_b32_dpp v41, v41 row_ror:8 row_mask:0xf bank_mask:0xc
 v_mfma_f32_16x16x16_bf16 v[80:83], v[92:93], v[44:45], 0
 s_nop 0
 v_mfma_f32_16x16x32_bf16 v[72:75], v[56:59], v[40:43], 0
 v_mfma_f32_16x16x32_bf16 v[80:83], v[88:91], v[40:43], v[80:83]
 v_mfma_f32_16x16x32_bf16 v[76:79], v[60:63], v[40:43], 0
 v_mfma_f32_16x16x16_bf16 v[72:75], v[84:85], v[44:45], v[72:75]
 v_mfma_f32_16x16x16_bf16 v[76:79], v[86:87], v[44:45], v[76:79]
 s_nop 4
 v_rcp_f32 v80, v80
 s_branch L_chain_bigokG
L_chain_lastG:
 buffer_store_dword v13, v12, s[32:35], s59 offen sc1
 s_waitcnt vmcnt(0) lgkmcnt(0)
 s_branch L_done
L_chain_kvwaitG:
 s_mov_b32 s30, 0
L_kvspin_102:
 buffer_load_dwordx4 v[48:51], v1, s[32:35], s60 offen offset:0 sc1
 buffer_load_dwordx4 v[52:55], v1, s[32:35], s60 offen offset:1024 sc1
 buffer_load_dwordx4 v[56:59], v1, s[32:35], s60 offen offset:2048 sc1
 buffer_load_dwordx4 v[60:63], v1, s[32:35], s60 offen offset:3072 sc1
 s_add_u32 s30, s30, 1
 s_cmp_gt_u32 s30, 524288
 s_cbranch_scc1 L_exit
 s_waitcnt vmcnt(0)
 v_bitop3_b32 v15, v48, v52, s95 bitop3:0x7e
 v_bitop3_b32 v120, v56, v60, s95 bitop3:0x7e
 v_or_b32 v15, v15, v120
 v_and_b32 v15, 1, v15
 v_cmp_ne_u32 vcc, 0, v15
 s_cbranch_vccz L_chain_kvokG
 s_sleep 1
 s_branch L_kvspin_102
L_wa:
 s_mov_b32 s67, s51
 v_and_b32 v0, 63, v0
 v_lshlrev_b32 v1, 4, v0
 s_lshl_b32 s66, s46, 15
 v_bfe_u32 v7, v0, 4, 1
 v_lshlrev_b32_e64 v116, 18, v7
 v_bfe_u32 v7, v0, 5, 1
 v_lshl_add_u32 v116, v7, 17, v116
 v_lshrrev_b32 v7, 4, v0
 v_lshlrev_b32 v7, 1, v7
 v_and_b32 v118, 15, v0
 v_xor_b32 v7, v7, v118
 v_lshl_add_u32 v116, v7, 4, v116
 v_xor_b32 v118, 128, v116
 v_lshrrev_b32 v7, 4, v0
 v_lshlrev_b32 v117, 11, v7
 v_bfe_u32 v7, v0, 2, 2
 v_lshl_add_u32 v117, v7, 8, v117
 v_bfe_u32 v119, v0, 2, 3
 v_lshlrev_b32 v119, 1, v119
 v_bfe_u32 v7, v0, 1, 1
 s_lshl_b32 s48, s46, 2
 v_add_u32 v7, s48, v7
 v_xor_b32 v7, v7, v119
 v_lshl_add_u32 v117, v7, 4, v117
 v_and_b32 v7, 1, v0
 v_lshl_add_u32 v117, v7, 3, v117
 v_xor_b32 v119, 32, v117
 s_lshl_b32 s70, s45, 8
 s_lshl_b32 s49, s46, 15
 s_add_u32 s70, s70, s49
 s_lshl_b32 s71, s46, 12
 s_add_u32 s71, s71, 0x8000
 v_add_u32 v117, 0x8000, v117
 v_add_u32 v119, 0x8000, v119
 s_lshr_b32 s54, 166, s44
 s_and_b32 s54, s54, 1
 s_cbranch_scc0 L_nolate_103
 s_cmp_lg_u32 s46, 0
 s_cbranch_scc1 L_lated_105
 s_mov_b32 s30, 0
L_winit_106:
 v_mov_b32 v124, 0
 global_load_dword v125, v124, s[26:27] offset:192 sc1
L_wchk_108:
 s_add_u32 s30, s30, 1
 s_cmp_gt_u32 s30, 524288
 s_cbranch_scc1 L_exit
 s_waitcnt vmcnt(0)
 v_readfirstlane_b32 s54, v125
 s_nop 0
 s_cmp_lg_u32 s54, 0
 s_cbranch_scc1 L_wdone_107
 s_sleep 8
 s_branch L_winit_106
L_wdone_107:
 s_lshr_b32 s3, s54, s44
 s_and_b32 s3, s3, 1
 s_lshl_b32 s52, s44, 11
 s_mov_b32 s30, 0
L_late_104:
 buffer_load_dword v125, off, s[32:35], s52 offset:1792 sc1
 s_add_u32 s30, s30, 1
 s_waitcnt vmcnt(0)
 s_cmp_gt_u32 s30, 200
 s_cbranch_scc1 L_lated_105
 v_readfirstlane_b32 s54, v125
 s_nop 0
 s_cmp_ge_u32 s54, 1
 s_cbranch_scc1 L_lated_105
 s_sleep 8
 s_branch L_late_104
L_lated_105:
 s_barrier
L_nolate_103:
 s_mov_b32 s36, s10
 s_mov_b32 s37, s11
 s_mov_b32 s38, 0x400000
 s_mov_b32 s39, 0x20000
 s_add_u32 m0, s71, 0
 s_add_u32 s48, s70, 0
 buffer_load_dwordx4 v116, s[36:39], s48 offen offset:0 lds
 s_add_u32 s48, s48, 7168
 buffer_load_dwordx4 v116, s[36:39], s48 offen offset:1024 lds
 s_add_u32 s48, s48, 7168
 buffer_load_dwordx4 v118, s[36:39], s48 offen offset:2048 lds
 s_add_u32 s48, s48, 7168
 buffer_load_dwordx4 v118, s[36:39], s48 offen offset:3072 lds
 s_add_u32 m0, s71, 16384
 s_add_u32 s48, s70, 524288
 buffer_load_dwordx4 v116, s[36:39], s48 offen offset:0 lds
 s_add_u32 s48, s48, 7168
 buffer_load_dwordx4 v116, s[36:39], s48 offen offset:1024 lds
 s_add_u32 s48, s48, 7168
 buffer_load_dwordx4 v118, s[36:39], s48 offen offset:2048 lds
 s_add_u32 s48, s48, 7168
 buffer_load_dwordx4 v118, s[36:39], s48 offen offset:3072 lds
 s_add_u32 m0, s71, 32768
 s_add_u32 s48, s70, 1048576
 buffer_load_dwordx4 v116, s[36:39], s48 offen offset:0 lds
 s_add_u32 s48, s48, 7168
 buffer_load_dwordx4 v116, s[36:39], s48 offen offset:1024 lds
 s_add_u32 s48, s48, 7168
 buffer_load_dwordx4 v118, s[36:39], s48 offen offset:2048 lds
 s_add_u32 s48, s48, 7168
 buffer_load_dwordx4 v118, s[36:39], s48 offen offset:3072 lds
 s_add_u32 m0, s71, 49152
 s_add_u32 s48, s70, 1572864
 buffer_load_dwordx4 v116, s[36:39], s48 offen offset:0 lds
 s_add_u32 s48, s48, 7168
 buffer_load_dwordx4 v116, s[36:39], s48 offen offset:1024 lds
 s_add_u32 s48, s48, 7168
 buffer_load_dwordx4 v118, s[36:39], s48 offen offset:2048 lds
 s_add_u32 s48, s48, 7168
 buffer_load_dwordx4 v118, s[36:39], s48 offen offset:3072 lds
 s_add_u32 m0, s71, 65536
 s_add_u32 s48, s70, 2097152
 buffer_load_dwordx4 v116, s[36:39], s48 offen offset:0 lds
 s_add_u32 s48, s48, 7168
 buffer_load_dwordx4 v116, s[36:39], s48 offen offset:1024 lds
 s_add_u32 s48, s48, 7168
 buffer_load_dwordx4 v118, s[36:39], s48 offen offset:2048 lds
 s_add_u32 s48, s48, 7168
 buffer_load_dwordx4 v118, s[36:39], s48 offen offset:3072 lds
 s_add_u32 m0, s71, 81920
 s_add_u32 s48, s70, 2621440
 buffer_load_dwordx4 v116, s[36:39], s48 offen offset:0 lds
 s_add_u32 s48, s48, 7168
 buffer_load_dwordx4 v116, s[36:39], s48 offen offset:1024 lds
 s_add_u32 s48, s48, 7168
 buffer_load_dwordx4 v118, s[36:39], s48 offen offset:2048 lds
 s_add_u32 s48, s48, 7168
 buffer_load_dwordx4 v118, s[36:39], s48 offen offset:3072 lds
 s_add_u32 m0, s71, 98304
 s_add_u32 s48, s70, 3145728
 buffer_load_dwordx4 v116, s[36:39], s48 offen offset:0 lds
 s_add_u32 s48, s48, 7168
 buffer_load_dwordx4 v116, s[36:39], s48 offen offset:1024 lds
 s_add_u32 s48, s48, 7168
 buffer_load_dwordx4 v118, s[36:39], s48 offen offset:2048 lds
 s_add_u32 s48, s48, 7168
 buffer_load_dwordx4 v118, s[36:39], s48 offen offset:3072 lds
 s_add_u32 m0, s71, 114688
 s_add_u32 s48, s70, 3670016
 buffer_load_dwordx4 v116, s[36:39], s48 offen offset:0 lds
 s_add_u32 s48, s48, 7168
 buffer_load_dwordx4 v116, s[36:39], s48 offen offset:1024 lds
 s_add_u32 s48, s48, 7168
 buffer_load_dwordx4 v118, s[36:39], s48 offen offset:2048 lds
 s_add_u32 s48, s48, 7168
 buffer_load_dwordx4 v118, s[36:39], s48 offen offset:3072 lds
 s_mov_b32 s92, 0
 s_mov_b32 s93, 0
 s_mov_b32 s66, 0
 s_lshl_b32 s48, s45, 2
 s_add_u32 s48, s48, s46
 s_lshl_b32 s6, s48, 2
 s_lshl_b32 s4, s48, 12
 s_lshl_b32 s49, s47, 21
 s_add_u32 s4, s4, s49
 s_add_u32 s4, s4, 0x200000
 s_lshl_b32 s5, s45, 13
 s_lshr_b32 s49, s46, 1
 s_lshl_b32 s49, s49, 12
 s_add_u32 s5, s5, s49
 s_and_b32 s49, s46, 1
 s_lshl_b32 s49, s49, 10
 s_add_u32 s5, s5, s49
 s_add_u32 s5, s5, 0x3f80000
 s_lshl_b32 s7, s46, 11
 s_add_u32 s7, s7, 0x3c000
 s_lshl_b32 s72, s46, 13
 v_mov_b32 v2, 0x44444444
 v_mov_b32 v96, 0xeeeeeeee
 v_and_b32 v97, 8, v0
 v_cmp_ne_u32 vcc, 0, v97
 s_nop 1
 v_cndmask_b32 v2, v2, v96, vcc
 v_and_b32 v3, 7, v0
 v_lshlrev_b32 v3, 2, v3
 v_mov_b32 v4, 1
 v_mov_b32 v11, 0xd028965f
 v_and_b32 v96, 1, v0
 v_lshlrev_b32 v96, 4, v96
 v_mov_b32 v97, 0x3f80
 v_lshlrev_b32_e64 v96, v96, v97
 v_bfe_u32 v97, v0, 2, 1
 v_bfe_u32 v98, v0, 4, 1
 v_cmp_eq_u32 vcc, v97, v98
 s_nop 1
 v_cndmask_b32 v96, 0, v96, vcc
 v_bfe_u32 v97, v0, 1, 1
 v_cmp_eq_u32 vcc, 0, v97
 s_nop 1
 v_cndmask_b32 v12, 0, v96, vcc
 v_cmp_eq_u32 vcc, 1, v97
 s_nop 1
 v_cndmask_b32 v13, 0, v96, vcc
 s_and_b32 s48, s46, 1
 v_and_b32 v96, 15, v0
 v_lshl_add_u32 v96, v96, 1, s48
 v_lshrrev_b32 v97, 4, v0
 v_lshlrev_b32 v97, 3, v97
 v_add_u32 v98, 0, v97
 v_cmp_le_u32 s[76:77], v98, v96
 v_add_u32 v98, 2, v97
 v_cmp_le_u32 s[78:79], v98, v96
 v_add_u32 v98, 4, v97
 v_cmp_le_u32 s[80:81], v98, v96
 v_add_u32 v98, 6, v97
 v_cmp_le_u32 s[82:83], v98, v96
 v_add_u32 v98, 1, v97
 v_cmp_le_u32 s[84:85], v98, v96
 v_add_u32 v98, 3, v97
 v_cmp_le_u32 s[86:87], v98, v96
 v_add_u32 v98, 5, v97
 v_cmp_le_u32 s[88:89], v98, v96
 v_add_u32 v98, 7, v97
 v_cmp_le_u32 s[90:91], v98, v96
 s_lshl_b32 s49, s46, 11
 s_add_u32 s49, s49, 65536
 v_add_u32 v5, s49, v1
 s_lshl_b32 s49, s48, 10
 s_add_u32 s49, s49, 90112
 v_add_u32 v6, s49, v1
 s_lshl_b32 s49, s46, 10
 s_add_u32 s49, s49, 114688
 v_add_u32 v9, s49, v1
 s_mov_b32 s63, 0x6000
 s_mov_b32 s55, 0
 s_lshl_b32 s48, s47, 6
 s_add_u32 s56, s48, s67
 s_mov_b32 s96, 0x3e0293ee
 s_mov_b32 s97, s96
 s_waitcnt vmcnt(28)
 s_barrier
 ds_read_b64_tr_b16 a[0:1], v117 offset:0
 ds_read_b64_tr_b16 a[2:3], v117 offset:1024
 ds_read_b64_tr_b16 a[4:5], v117 offset:8192
 ds_read_b64_tr_b16 a[6:7], v117 offset:9216
 ds_read_b64_tr_b16 a[8:9], v119 offset:0
 ds_read_b64_tr_b16 a[10:11], v119 offset:1024
 ds_read_b64_tr_b16 a[12:13], v119 offset:8192
 ds_read_b64_tr_b16 a[14:15], v119 offset:9216
 s_waitcnt lgkmcnt(0)
 s_waitcnt vmcnt(24)
 s_barrier
 s_mov_b32 s36, s12
 s_mov_b32 s37, s13
 s_mov_b32 s38, 0x400000
 s_mov_b32 s39, 0x20000
 s_add_u32 m0, s71, 0
 s_add_u32 s48, s70, 0
 buffer_load_dwordx4 v116, s[36:39], s48 offen offset:0 lds
 s_add_u32 s48, s48, 7168
 buffer_load_dwordx4 v116, s[36:39], s48 offen offset:1024 lds
 s_add_u32 s48, s48, 7168
 buffer_load_dwordx4 v118, s[36:39], s48 offen offset:2048 lds
 s_add_u32 s48, s48, 7168
 buffer_load_dwordx4 v118, s[36:39], s48 offen offset:3072 lds
 ds_read_b64_tr_b16 a[16:17], v117 offset:16384
 ds_read_b64_tr_b16 a[18:19], v117 offset:17408
 ds_read_b64_tr_b16 a[20:21], v117 offset:24576
 ds_read_b64_tr_b16 a[22:23], v117 offset:25600
 ds_read_b64_tr_b16 a[24:25], v119 offset:16384
 ds_read_b64_tr_b16 a[26:27], v119 offset:17408
 ds_read_b64_tr_b16 a[28:29], v119 offset:24576
 ds_read_b64_tr_b16 a[30:31], v119 offset:25600
 s_waitcnt lgkmcnt(0)
 s_waitcnt vmcnt(24)
 s_barrier
 s_add_u32 m0, s71, 16384
 s_add_u32 s48, s70, 524288
 buffer_load_dwordx4 v116, s[36:39], s48 offen offset:0 lds
 s_add_u32 s48, s48, 7168
 buffer_load_dwordx4 v116, s[36:39], s48 offen offset:1024 lds
 s_add_u32 s48, s48, 7168
 buffer_load_dwordx4 v118, s[36:39], s48 offen offset:2048 lds
 s_add_u32 s48, s48, 7168
 buffer_load_dwordx4 v118, s[36:39], s48 offen offset:3072 lds
 ds_read_b64_tr_b16 a[32:33], v117 offset:32768
 ds_read_b64_tr_b16 a[34:35], v117 offset:33792
 ds_read_b64_tr_b16 a[36:37], v117 offset:40960
 ds_read_b64_tr_b16 a[38:39], v117 offset:41984
 ds_read_b64_tr_b16 a[40:41], v119 offset:32768
 ds_read_b64_tr_b16 a[42:43], v119 offset:33792
 ds_read_b64_tr_b16 a[44:45], v119 offset:40960
 ds_read_b64_tr_b16 a[46:47], v119 offset:41984
 s_waitcnt lgkmcnt(0)
 s_waitcnt vmcnt(24)
 s_barrier
 s_add_u32 m0, s71, 32768
 s_add_u32 s48, s70, 1048576
 buffer_load_dwordx4 v116, s[36:39], s48 offen offset:0 lds
 s_add_u32 s48, s48, 7168
 buffer_load_dwordx4 v116, s[36:39], s48 offen offset:1024 lds
 s_add_u32 s48, s48, 7168
 buffer_load_dwordx4 v118, s[36:39], s48 offen offset:2048 lds
 s_add_u32 s48, s48, 7168
 buffer_load_dwordx4 v118, s[36:39], s48 offen offset:3072 lds
 ds_read_b64_tr_b16 a[48:49], v117 offset:49152
 ds_read_b64_tr_b16 a[50:51], v117 offset:50176
 ds_read_b64_tr_b16 a[52:53], v117 offset:57344
 ds_read_b64_tr_b16 a[54:55], v117 offset:58368
 ds_read_b64_tr_b16 a[56:57], v119 offset:49152
 ds_read_b64_tr_b16 a[58:59], v119 offset:50176
 ds_read_b64_tr_b16 a[60:61], v119 offset:57344
 ds_read_b64_tr_b16 a[62:63], v119 offset:58368
 s_waitcnt lgkmcnt(0)
 s_waitcnt vmcnt(24)
 s_barrier
 s_add_u32 m0, s71, 49152
 s_add_u32 s48, s70, 1572864
 buffer_load_dwordx4 v116, s[36:39], s48 offen offset:0 lds
 s_add_u32 s48, s48, 7168
 buffer_load_dwordx4 v116, s[36:39], s48 offen offset:1024 lds
 s_add_u32 s48, s48, 7168
 buffer_load_dwordx4 v118, s[36:39], s48 offen offset:2048 lds
 s_add_u32 s48, s48, 7168
 buffer_load_dwordx4 v118, s[36:39], s48 offen offset:3072 lds
 v_add_u32 v120, 0x10000, v117
 ds_read_b64_tr_b16 a[64:65], v120 offset:0
 ds_read_b64_tr_b16 a[66:67], v120 offset:1024
 ds_read_b64_tr_b16 a[68:69], v120 offset:8192
 ds_read_b64_tr_b16 a[70:71], v120 offset:9216
 v_add_u32 v120, 0x10000, v119
 ds_read_b64_tr_b16 a[72:73], v120 offset:0
 ds_read_b64_tr_b16 a[74:75], v120 offset:1024
 ds_read_b64_tr_b16 a[76:77], v120 offset:8192
 ds_read_b64_tr_b16 a[78:79], v120 offset:9216
 s_waitcnt lgkmcnt(0)
 s_waitcnt vmcnt(24)
 s_barrier
 s_add_u32 m0, s71, 65536
 s_add_u32 s48, s70, 2097152
 buffer_load_dwordx4 v116, s[36:39], s48 offen offset:0 lds
 s_add_u32 s48, s48, 7168
 buffer_load_dwordx4 v116, s[36:39], s48 offen offset:1024 lds
 s_add_u32 s48, s48, 7168
 buffer_load_dwordx4 v118, s[36:39], s48 offen offset:2048 lds
 s_add_u32 s48, s48, 7168
 buffer_load_dwordx4 v118, s[36:39], s48 offen offset:3072 lds
 v_add_u32 v120, 0x10000, v117
 ds_read_b64_tr_b16 a[80:81], v120 offset:16384
 ds_read_b64_tr_b16 a[82:83], v120 offset:17408
 ds_read_b64_tr_b16 a[84:85], v120 offset:24576
 ds_read_b64_tr_b16 a[86:87], v120 offset:25600
 v_add_u32 v120, 0x10000, v119
 ds_read_b64_tr_b16 a[88:89], v120 offset:16384
 ds_read_b64_tr_b16 a[90:91], v120 offset:17408
 ds_read_b64_tr_b16 a[92:93], v120 offset:24576
 ds_read_b64_tr_b16 a[94:95], v120 offset:25600
 s_waitcnt lgkmcnt(0)
 s_waitcnt vmcnt(24)
 s_barrier
 s_add_u32 m0, s71, 81920
 s_add_u32 s48, s70, 2621440
 buffer_load_dwordx4 v116, s[36:39], s48 offen offset:0 lds
 s_add_u32 s48, s48, 7168
 buffer_load_dwordx4 v116, s[36:39], s48 offen offset:1024 lds
 s_add_u32 s48, s48, 7168
 buffer_load_dwordx4 v118, s[36:39], s48 offen offset:2048 lds
 s_add_u32 s48, s48, 7168
 buffer_load_dwordx4 v118, s[36:39], s48 offen offset:3072 lds
 v_add_u32 v120, 0x10000, v117
 ds_read_b64_tr_b16 a[96:97], v120 offset:32768
 ds_read_b64_tr_b16 a[98:99], v120 offset:33792
 ds_read_b64_tr_b16 a[100:101], v120 offset:40960
 ds_read_b64_tr_b16 a[102:103], v120 offset:41984
 v_add_u32 v120, 0x10000, v119
 ds_read_b64_tr_b16 a[104:105], v120 offset:32768
 ds_read_b64_tr_b16 a[106:107], v120 offset:33792
 ds_read_b64_tr_b16 a[108:109], v120 offset:40960
 ds_read_b64_tr_b16 a[110:111], v120 offset:41984
 s_waitcnt lgkmcnt(0)
 s_waitcnt vmcnt(24)
 s_barrier
 s_add_u32 m0, s71, 98304
 s_add_u32 s48, s70, 3145728
 buffer_load_dwordx4 v116, s[36:39], s48 offen offset:0 lds
 s_add_u32 s48, s48, 7168
 buffer_load_dwordx4 v116, s[36:39], s48 offen offset:1024 lds
 s_add_u32 s48, s48, 7168
 buffer_load_dwordx4 v118, s[36:39], s48 offen offset:2048 lds
 s_add_u32 s48, s48, 7168
 buffer_load_dwordx4 v118, s[36:39], s48 offen offset:3072 lds
 v_add_u32 v120, 0x10000, v117
 ds_read_b64_tr_b16 a[112:113], v120 offset:49152
 ds_read_b64_tr_b16 a[114:115], v120 offset:50176
 ds_read_b64_tr_b16 a[116:117], v120 offset:57344
 ds_read_b64_tr_b16 a[118:119], v120 offset:58368
 v_add_u32 v120, 0x10000, v119
 ds_read_b64_tr_b16 a[120:121], v120 offset:49152
 ds_read_b64_tr_b16 a[122:123], v120 offset:50176
 ds_read_b64_tr_b16 a[124:125], v120 offset:57344
 ds_read_b64_tr_b16 a[126:127], v120 offset:58368
 s_waitcnt lgkmcnt(0)
 s_waitcnt vmcnt(24)
 s_barrier
 s_add_u32 m0, s71, 114688
 s_add_u32 s48, s70, 3670016
 buffer_load_dwordx4 v116, s[36:39], s48 offen offset:0 lds
 s_add_u32 s48, s48, 7168
 buffer_load_dwordx4 v116, s[36:39], s48 offen offset:1024 lds
 s_add_u32 s48, s48, 7168
 buffer_load_dwordx4 v118, s[36:39], s48 offen offset:2048 lds
 s_add_u32 s48, s48, 7168
 buffer_load_dwordx4 v118, s[36:39], s48 offen offset:3072 lds
 ds_read_b64_tr_b16 a[128:129], v117 offset:0
 ds_read_b64_tr_b16 a[130:131], v117 offset:1024
 ds_read_b64_tr_b16 a[132:133], v117 offset:8192
 ds_read_b64_tr_b16 a[134:135], v117 offset:9216
 ds_read_b64_tr_b16 a[136:137], v119 offset:0
 ds_read_b64_tr_b16 a[138:139], v119 offset:1024
 ds_read_b64_tr_b16 a[140:141], v119 offset:8192
 ds_read_b64_tr_b16 a[142:143], v119 offset:9216
 s_waitcnt lgkmcnt(0)
 s_waitcnt vmcnt(24)
 s_barrier
 s_mov_b32 s36, s8
 s_mov_b32 s37, s9
 s_mov_b32 s38, 0x400000
 s_mov_b32 s39, 0x20000
 s_add_u32 m0, s71, 0
 s_add_u32 s48, s70, 0
 buffer_load_dwordx4 v116, s[36:39], s48 offen offset:0 lds
 s_add_u32 s48, s48, 7168
 buffer_load_dwordx4 v116, s[36:39], s48 offen offset:1024 lds
 s_add_u32 s48, s48, 7168
 buffer_load_dwordx4 v118, s[36:39], s48 offen offset:2048 lds
 s_add_u32 s48, s48, 7168
 buffer_load_dwordx4 v118, s[36:39], s48 offen offset:3072 lds
 ds_read_b64_tr_b16 a[144:145], v117 offset:16384
 ds_read_b64_tr_b16 a[146:147], v117 offset:17408
 ds_read_b64_tr_b16 a[148:149], v117 offset:24576
 ds_read_b64_tr_b16 a[150:151], v117 offset:25600
 ds_read_b64_tr_b16 a[152:153], v119 offset:16384
 ds_read_b64_tr_b16 a[154:155], v119 offset:17408
 ds_read_b64_tr_b16 a[156:157], v119 offset:24576
 ds_read_b64_tr_b16 a[158:159], v119 offset:25600
 s_waitcnt lgkmcnt(0)
 s_waitcnt vmcnt(24)
 s_barrier
 s_add_u32 m0, s71, 16384
 s_add_u32 s48, s70, 524288
 buffer_load_dwordx4 v116, s[36:39], s48 offen offset:0 lds
 s_add_u32 s48, s48, 7168
 buffer_load_dwordx4 v116, s[36:39], s48 offen offset:1024 lds
 s_add_u32 s48, s48, 7168
 buffer_load_dwordx4 v118, s[36:39], s48 offen offset:2048 lds
 s_add_u32 s48, s48, 7168
 buffer_load_dwordx4 v118, s[36:39], s48 offen offset:3072 lds
 ds_read_b64_tr_b16 a[160:161], v117 offset:32768
 ds_read_b64_tr_b16 a[162:163], v117 offset:33792
 ds_read_b64_tr_b16 a[164:165], v117 offset:40960
 ds_read_b64_tr_b16 a[166:167], v117 offset:41984
 ds_read_b64_tr_b16 a[168:169], v119 offset:32768
 ds_read_b64_tr_b16 a[170:171], v119 offset:33792
 ds_read_b64_tr_b16 a[172:173], v119 offset:40960
 ds_read_b64_tr_b16 a[174:175], v119 offset:41984
 s_waitcnt lgkmcnt(0)
 s_waitcnt vmcnt(24)
 s_barrier
 s_add_u32 m0, s71, 32768
 s_add_u32 s48, s70, 1048576
 buffer_load_dwordx4 v116, s[36:39], s48 offen offset:0 lds
 s_add_u32 s48, s48, 7168
 buffer_load_dwordx4 v116, s[36:39], s48 offen offset:1024 lds
 s_add_u32 s48, s48, 7168
 buffer_load_dwordx4 v118, s[36:39], s48 offen offset:2048 lds
 s_add_u32 s48, s48, 7168
 buffer_load_dwordx4 v118, s[36:39], s48 offen offset:3072 lds
 ds_read_b64_tr_b16 a[176:177], v117 offset:49152
 ds_read_b64_tr_b16 a[178:179], v117 offset:50176
 ds_read_b64_tr_b16 a[180:181], v117 offset:57344
 ds_read_b64_tr_b16 a[182:183], v117 offset:58368
 ds_read_b64_tr_b16 a[184:185], v119 offset:49152
 ds_read_b64_tr_b16 a[186:187], v119 offset:50176
 ds_read_b64_tr_b16 a[188:189], v119 offset:57344
 ds_read_b64_tr_b16 a[190:191], v119 offset:58368
 s_waitcnt lgkmcnt(0)
 s_waitcnt vmcnt(24)
 s_barrier
 s_add_u32 m0, s71, 49152
 s_add_u32 s48, s70, 1572864
 buffer_load_dwordx4 v116, s[36:39], s48 offen offset:0 lds
 s_add_u32 s48, s48, 7168
 buffer_load_dwordx4 v116, s[36:39], s48 offen offset:1024 lds
 s_add_u32 s48, s48, 7168
 buffer_load_dwordx4 v118, s[36:39], s48 offen offset:2048 lds
 s_add_u32 s48, s48, 7168
 buffer_load_dwordx4 v118, s[36:39], s48 offen offset:3072 lds
 v_add_u32 v120, 0x10000, v117
 ds_read_b64_tr_b16 a[192:193], v120 offset:0
 ds_read_b64_tr_b16 a[194:195], v120 offset:1024
 ds_read_b64_tr_b16 a[196:197], v120 offset:8192
 ds_read_b64_tr_b16 a[198:199], v120 offset:9216
 v_add_u32 v120, 0x10000, v119
 ds_read_b64_tr_b16 a[200:201], v120 offset:0
 ds_read_b64_tr_b16 a[202:203], v120 offset:1024
 ds_read_b64_tr_b16 a[204:205], v120 offset:8192
 ds_read_b64_tr_b16 a[206:207], v120 offset:9216
 s_waitcnt lgkmcnt(0)
 s_waitcnt vmcnt(24)
 s_barrier
 s_add_u32 m0, s71, 65536
 s_add_u32 s48, s70, 2097152
 buffer_load_dwordx4 v116, s[36:39], s48 offen offset:0 lds
 s_add_u32 s48, s48, 7168
 buffer_load_dwordx4 v116, s[36:39], s48 offen offset:1024 lds
 s_add_u32 s48, s48, 7168
 buffer_load_dwordx4 v118, s[36:39], s48 offen offset:2048 lds
 s_add_u32 s48, s48, 7168
 buffer_load_dwordx4 v118, s[36:39], s48 offen offset:3072 lds
 v_add_u32 v120, 0x10000, v117
 ds_read_b64_tr_b16 a[208:209], v120 offset:16384
 ds_read_b64_tr_b16 a[210:211], v120 offset:17408
 ds_read_b64_tr_b16 a[212:213], v120 offset:24576
 ds_read_b64_tr_b16 a[214:215], v120 offset:25600
 v_add_u32 v120, 0x10000, v119
 ds_read_b64_tr_b16 a[216:217], v120 offset:16384
 ds_read_b64_tr_b16 a[218:219], v120 offset:17408
 ds_read_b64_tr_b16 a[220:221], v120 offset:24576
 ds_read_b64_tr_b16 a[222:223], v120 offset:25600
 s_waitcnt lgkmcnt(0)
 s_waitcnt vmcnt(24)
 s_barrier
 s_add_u32 m0, s71, 81920
 s_add_u32 s48, s70, 2621440
 buffer_load_dwordx4 v116, s[36:39], s48 offen offset:0 lds
 s_add_u32 s48, s48, 7168
 buffer_load_dwordx4 v116, s[36:39], s48 offen offset:1024 lds
 s_add_u32 s48, s48, 7168
 buffer_load_dwordx4 v118, s[36:39], s48 offen offset:2048 lds
 s_add_u32 s48, s48, 7168
 buffer_load_dwordx4 v118, s[36:39], s48 offen offset:3072 lds
 v_add_u32 v120, 0x10000, v117
 ds_read_b64_tr_b16 a[224:225], v120 offset:32768
 ds_read_b64_tr_b16 a[226:227], v120 offset:33792
 ds_read_b64_tr_b16 a[228:229], v120 offset:40960
 ds_read_b64_tr_b16 a[230:231], v120 offset:41984
 v_add_u32 v120, 0x10000, v119
 ds_read_b64_tr_b16 a[232:233], v120 offset:32768
 ds_read_b64_tr_b16 a[234:235], v120 offset:33792
 ds_read_b64_tr_b16 a[236:237], v120 offset:40960
 ds_read_b64_tr_b16 a[238:239], v120 offset:41984
 s_waitcnt lgkmcnt(0)
 s_waitcnt vmcnt(24)
 s_barrier
 s_add_u32 m0, s71, 98304
 s_add_u32 s48, s70, 3145728
 buffer_load_dwordx4 v116, s[36:39], s48 offen offset:0 lds
 s_add_u32 s48, s48, 7168
 buffer_load_dwordx4 v116, s[36:39], s48 offen offset:1024 lds
 s_add_u32 s48, s48, 7168
 buffer_load_dwordx4 v118, s[36:39], s48 offen offset:2048 lds
 s_add_u32 s48, s48, 7168
 buffer_load_dwordx4 v118, s[36:39], s48 offen offset:3072 lds
 v_add_u32 v120, 0x10000, v117
 ds_read_b64_tr_b16 a[240:241], v120 offset:49152
 ds_read_b64_tr_b16 a[242:243], v120 offset:50176
 ds_read_b64_tr_b16 a[244:245], v120 offset:57344
 ds_read_b64_tr_b16 a[246:247], v120 offset:58368
 v_add_u32 v120, 0x10000, v119
 ds_read_b64_tr_b16 a[248:249], v120 offset:49152
 ds_read_b64_tr_b16 a[250:251], v120 offset:50176
 ds_read_b64_tr_b16 a[252:253], v120 offset:57344
 ds_read_b64_tr_b16 a[254:255], v120 offset:58368
 s_waitcnt lgkmcnt(0)
 s_waitcnt vmcnt(24)
 s_barrier
 s_add_u32 m0, s71, 114688
 s_add_u32 s48, s70, 3670016
 buffer_load_dwordx4 v116, s[36:39], s48 offen offset:0 lds
 s_add_u32 s48, s48, 7168
 buffer_load_dwordx4 v116, s[36:39], s48 offen offset:1024 lds
 s_add_u32 s48, s48, 7168
 buffer_load_dwordx4 v118, s[36:39], s48 offen offset:2048 lds
 s_add_u32 s48, s48, 7168
 buffer_load_dwordx4 v118, s[36:39], s48 offen offset:3072 lds
 ds_read_b64_tr_b16 v[128:129], v117 offset:0
 ds_read_b64_tr_b16 v[130:131], v117 offset:1024
 ds_read_b64_tr_b16 v[132:133], v117 offset:8192
 ds_read_b64_tr_b16 v[134:135], v117 offset:9216
 ds_read_b64_tr_b16 v[136:137], v119 offset:0
 ds_read_b64_tr_b16 v[138:139], v119 offset:1024
 ds_read_b64_tr_b16 v[140:141], v119 offset:8192
 ds_read_b64_tr_b16 v[142:143], v119 offset:9216
 s_waitcnt lgkmcnt(0)
 s_waitcnt vmcnt(24)
 s_barrier
 ds_read_b64_tr_b16 v[144:145], v117 offset:16384
 ds_read_b64_tr_b16 v[146:147], v117 offset:17408
 ds_read_b64_tr_b16 v[148:149], v117 offset:24576
 ds_read_b64_tr_b16 v[150:151], v117 offset:25600
 ds_read_b64_tr_b16 v[152:153], v119 offset:16384
 ds_read_b64_tr_b16 v[154:155], v119 offset:17408
 ds_read_b64_tr_b16 v[156:157], v119 offset:24576
 ds_read_b64_tr_b16 v[158:159], v119 offset:25600
 s_waitcnt lgkmcnt(0)
 v_mov_b32 v124, 0
 global_load_dword v125, v124, s[26:27] offset:192 sc1
 s_waitcnt vmcnt(20)
 s_barrier
 ds_read_b64_tr_b16 v[160:161], v117 offset:32768
 ds_read_b64_tr_b16 v[162:163], v117 offset:33792
 ds_read_b64_tr_b16 v[164:165], v117 offset:40960
 ds_read_b64_tr_b16 v[166:167], v117 offset:41984
 ds_read_b64_tr_b16 v[168:169], v119 offset:32768
 ds_read_b64_tr_b16 v[170:171], v119 offset:33792
 ds_read_b64_tr_b16 v[172:173], v119 offset:40960
 ds_read_b64_tr_b16 v[174:175], v119 offset:41984
 s_waitcnt lgkmcnt(0)
 s_waitcnt vmcnt(16)
 s_barrier
 ds_read_b64_tr_b16 v[176:177], v117 offset:49152
 ds_read_b64_tr_b16 v[178:179], v117 offset:50176
 ds_read_b64_tr_b16 v[180:181], v117 offset:57344
 ds_read_b64_tr_b16 v[182:183], v117 offset:58368
 ds_read_b64_tr_b16 v[184:185], v119 offset:49152
 ds_read_b64_tr_b16 v[186:187], v119 offset:50176
 ds_read_b64_tr_b16 v[188:189], v119 offset:57344
 ds_read_b64_tr_b16 v[190:191], v119 offset:58368
 s_waitcnt lgkmcnt(0)
 s_waitcnt vmcnt(12)
 s_barrier
 v_add_u32 v120, 0x10000, v117
 ds_read_b64_tr_b16 v[192:193], v120 offset:0
 ds_read_b64_tr_b16 v[194:195], v120 offset:1024
 ds_read_b64_tr_b16 v[196:197], v120 offset:8192
 ds_read_b64_tr_b16 v[198:199], v120 offset:9216
 v_add_u32 v120, 0x10000, v119
 ds_read_b64_tr_b16 v[200:201], v120 offset:0
 ds_read_b64_tr_b16 v[202:203], v120 offset:1024
 ds_read_b64_tr_b16 v[204:205], v120 offset:8192
 ds_read_b64_tr_b16 v[206:207], v120 offset:9216
 s_waitcnt lgkmcnt(0)
 s_waitcnt vmcnt(8)
 s_barrier
 v_add_u32 v120, 0x10000, v117
 ds_read_b64_tr_b16 v[208:209], v120 offset:16384
 ds_read_b64_tr_b16 v[210:211], v120 offset:17408
 ds_read_b64_tr_b16 v[212:213], v120 offset:24576
 ds_read_b64_tr_b16 v[214:215], v120 offset:25600
 v_add_u32 v120, 0x10000, v119
 ds_read_b64_tr_b16 v[216:217], v120 offset:16384
 ds_read_b64_tr_b16 v[218:219], v120 offset:17408
 ds_read_b64_tr_b16 v[220:221], v120 offset:24576
 ds_read_b64_tr_b16 v[222:223], v120 offset:25600
 s_waitcnt lgkmcnt(0)
 s_cmp_lg_u32 s47, 0
 s_cbranch_scc1 L_nofi_109
 s_mov_b32 s30, 0
 s_branch L_wchk_112
L_winit_110:
 v_mov_b32 v124, 0
 global_load_dword v125, v124, s[26:27] offset:192 sc1
L_wchk_112:
 s_add_u32 s30, s30, 1
 s_cmp_gt_u32 s30, 524288
 s_cbranch_scc1 L_exit
 s_waitcnt vmcnt(0)
 v_readfirstlane_b32 s54, v125
 s_nop 0
 s_cmp_lg_u32 s54, 0
 s_cbranch_scc1 L_wdone_111
 s_sleep 8
 s_branch L_winit_110
L_wdone_111:
 s_lshr_b32 s3, s54, s44
 s_and_b32 s3, s3, 1
 s_lshl_b32 s58, s56, 11
 s_mov_b32 s30, 0
L_pf_113:
 buffer_load_dword v7, v3, s[32:35], s58 offen sc1
 s_add_u32 s30, s30, 1
 s_cmp_gt_u32 s30, 524288
 s_cbranch_scc1 L_exit
 s_waitcnt vmcnt(0)
 v_cmp_eq_u32 vcc, 0, v7
 s_cbranch_vccz L_pfd_114
 s_sleep 1
 s_branch L_pf_113
L_pfd_114:
 s_lshl_b32 s57, s56, 15
 s_add_u32 s57, s57, s72
 s_add_u32 s57, s57, 0x1400000
 s_add_u32 s94, s72, s66
 s_mov_b32 m0, s94
 s_nop 0
 buffer_load_dwordx4 v1, s[32:35], s57 offen offset:0 sc1 lds
 buffer_load_dwordx4 v1, s[32:35], s57 offen offset:1024 sc1 lds
 buffer_load_dwordx4 v1, s[32:35], s57 offen offset:2048 sc1 lds
 buffer_load_dwordx4 v1, s[32:35], s57 offen offset:3072 sc1 lds
 s_add_u32 m0, s94, 4096
 s_add_u32 s57, s57, 4096
 buffer_load_dwordx4 v1, s[32:35], s57 offen offset:0 sc1 lds
 buffer_load_dwordx4 v1, s[32:35], s57 offen offset:1024 sc1 lds
 buffer_load_dwordx4 v1, s[32:35], s57 offen offset:2048 sc1 lds
 buffer_load_dwordx4 v1, s[32:35], s57 offen offset:3072 sc1 lds
 s_mov_b32 s92, 1
L_nofi_109:
 s_waitcnt vmcnt(4)
 s_barrier
 v_add_u32 v120, 0x10000, v117
 ds_read_b64_tr_b16 v[224:225], v120 offset:32768
 ds_read_b64_tr_b16 v[226:227], v120 offset:33792
 ds_read_b64_tr_b16 v[228:229], v120 offset:40960
 ds_read_b64_tr_b16 v[230:231], v120 offset:41984
 v_add_u32 v120, 0x10000, v119
 ds_read_b64_tr_b16 v[232:233], v120 offset:32768
 ds_read_b64_tr_b16 v[234:235], v120 offset:33792
 ds_read_b64_tr_b16 v[236:237], v120 offset:40960
 ds_read_b64_tr_b16 v[238:239], v120 offset:41984
 s_waitcnt lgkmcnt(0)
 s_waitcnt vmcnt(0)
 s_barrier
 v_add_u32 v120, 0x10000, v117
 ds_read_b64_tr_b16 v[240:241], v120 offset:49152
 ds_read_b64_tr_b16 v[242:243], v120 offset:50176
 ds_read_b64_tr_b16 v[244:245], v120 offset:57344
 ds_read_b64_tr_b16 v[246:247], v120 offset:58368
 v_add_u32 v120, 0x10000, v119
 ds_read_b64_tr_b16 v[248:249], v120 offset:49152
 ds_read_b64_tr_b16 v[250:251], v120 offset:50176
 ds_read_b64_tr_b16 v[252:253], v120 offset:57344
 ds_read_b64_tr_b16 v[254:255], v120 offset:58368
 s_waitcnt lgkmcnt(0)
 s_barrier
 s_mov_b32 s30, 0
 s_branch L_wchk_117
L_winit_115:
 v_mov_b32 v124, 0
 global_load_dword v125, v124, s[26:27] offset:192 sc1
L_wchk_117:
 s_add_u32 s30, s30, 1
 s_cmp_gt_u32 s30, 524288
 s_cbranch_scc1 L_exit
 s_waitcnt vmcnt(0)
 v_readfirstlane_b32 s54, v125
 s_nop 0
 s_cmp_lg_u32 s54, 0
 s_cbranch_scc1 L_wdone_116
 s_sleep 8
 s_branch L_winit_115
L_wdone_116:
 s_lshr_b32 s3, s54, s44
 s_and_b32 s3, s3, 1
 s_barrier
L_wa_loop:
 s_lshl_b32 s58, s56, 11
 s_add_u32 s95, s58, 4096
 s_cmp_eq_u32 s92, 1
 s_cbranch_scc1 L_wa_pre
 s_cmp_eq_u32 s55, 32
 s_cbranch_scc1 L_wa_noqkv
 s_cmp_eq_u32 s92, 2
 s_cbranch_scc1 L_wa_E
 s_mov_b32 s30, 0
L_pf_118:
 buffer_load_dword v7, v3, s[32:35], s58 offen sc1
 s_add_u32 s30, s30, 1
 s_cmp_gt_u32 s30, 524288
 s_cbranch_scc1 L_exit
 s_waitcnt vmcnt(0)
 v_cmp_eq_u32 vcc, 0, v7
 s_cbranch_vccz L_pfd_119
 s_sleep 1
 s_branch L_pf_118
L_pfd_119:
 s_lshl_b32 s57, s56, 15
 s_add_u32 s57, s57, s72
 s_add_u32 s57, s57, 0x1400000
 s_add_u32 s94, s72, s66
 s_mov_b32 m0, s94
 s_nop 0
 buffer_load_dwordx4 v1, s[32:35], s57 offen offset:0 sc1 lds
 buffer_load_dwordx4 v1, s[32:35], s57 offen offset:1024 sc1 lds
 buffer_load_dwordx4 v1, s[32:35], s57 offen offset:2048 sc1 lds
 buffer_load_dwordx4 v1, s[32:35], s57 offen offset:3072 sc1 lds
 s_add_u32 m0, s94, 4096
 s_add_u32 s57, s57, 4096
 buffer_load_dwordx4 v1, s[32:35], s57 offen offset:0 sc1 lds
 buffer_load_dwordx4 v1, s[32:35], s57 offen offset:1024 sc1 lds
 buffer_load_dwordx4 v1, s[32:35], s57 offen offset:2048 sc1 lds
 buffer_load_dwordx4 v1, s[32:35], s57 offen offset:3072 sc1 lds
 s_waitcnt vmcnt(0)
L_wa_E:
 s_waitcnt vmcnt(1)
L_wa_pre:
 v_add_u32 v15, s66, v1
 s_barrier
 ds_read_b128 v[16:19], v15 offset:0
 ds_read_b128 v[20:23], v15 offset:1024
 ds_read_b128 v[24:27], v15 offset:2048
 ds_read_b128 v[28:31], v15 offset:3072
 buffer_load_dword v14, v3, s[32:35], s95 offen sc1
 s_xor_b32 s66, s66, 0x8000
 s_waitcnt lgkmcnt(2)
 v_mfma_f32_16x16x32_bf16 v[40:43], a[0:3], v[16:19], 0
 ds_read_b128 v[32:35], v15 offset:4096
 v_mfma_f32_16x16x32_bf16 v[48:51], a[8:11], v[16:19], 0
 ds_read_b128 v[36:39], v15 offset:5120
 v_mfma_f32_16x16x32_bf16 v[56:59], v[16:19], a[128:131], 0
 s_and_b32 s59, s56, 3
 v_mfma_f32_16x16x32_bf16 v[60:63], v[16:19], a[136:139], 0
 s_lshl_b32 s59, s59, 19
 v_mfma_f32_16x16x32_bf16 v[44:47], a[0:3], v[20:23], 0
 s_add_u32 s59, s59, s4
 v_mfma_f32_16x16x32_bf16 v[52:55], a[8:11], v[20:23], 0
 s_bfe_u32 s65, s56, 0x10002
 v_mfma_f32_16x16x32_bf16 v[64:67], v[20:23], a[128:131], 0
 s_lshl_b32 s60, s56, 13
 v_mfma_f32_16x16x32_bf16 v[68:71], v[20:23], a[136:139], 0
 s_add_u32 s60, s60, s7
 s_waitcnt lgkmcnt(2)
 v_mfma_f32_16x16x32_bf16 v[40:43], a[4:7], v[24:27], v[40:43]
 ds_read_b128 v[16:19], v15 offset:6144
 v_mfma_f32_16x16x32_bf16 v[48:51], a[12:15], v[24:27], v[48:51]
 ds_read_b128 v[20:23], v15 offset:7168
 v_mfma_f32_16x16x32_bf16 v[56:59], v[24:27], a[132:135], v[56:59]
 s_lshl_b32 s57, s56, 15
 v_mfma_f32_16x16x32_bf16 v[60:63], v[24:27], a[140:143], v[60:63]
 s_add_u32 s57, s57, s72
 v_mfma_f32_16x16x32_bf16 v[44:47], a[4:7], v[28:31], v[44:47]
 s_add_u32 s57, s57, 0x1410000
 v_mfma_f32_16x16x32_bf16 v[52:55], a[12:15], v[28:31], v[52:55]
 s_add_u32 s94, s72, s66
 v_mfma_f32_16x16x32_bf16 v[64:67], v[28:31], a[132:135], v[64:67]
 s_mov_b32 m0, s94
 v_mfma_f32_16x16x32_bf16 v[68:71], v[28:31], a[140:143], v[68:71]
 s_waitcnt lgkmcnt(2)
 v_mfma_f32_16x16x32_bf16 v[40:43], a[16:19], v[32:35], v[40:43]
 ds_read_b128 v[24:27], v15 offset:8192
 v_mfma_f32_16x16x32_bf16 v[48:51], a[24:27], v[32:35], v[48:51]
 ds_read_b128 v[28:31], v15 offset:9216
 v_mfma_f32_16x16x32_bf16 v[56:59], v[32:35], a[144:147], v[56:59]
 v_mfma_f32_16x16x32_bf16 v[60:63], v[32:35], a[152:155], v[60:63]
 v_mfma_f32_16x16x32_bf16 v[44:47], a[16:19], v[36:39], v[44:47]
 v_mfma_f32_16x16x32_bf16 v[52:55], a[24:27], v[36:39], v[52:55]
 v_mfma_f32_16x16x32_bf16 v[64:67], v[36:39], a[144:147], v[64:67]
 v_mfma_f32_16x16x32_bf16 v[68:71], v[36:39], a[152:155], v[68:71]
 s_waitcnt lgkmcnt(2)
 v_mfma_f32_16x16x32_bf16 v[40:43], a[20:23], v[16:19], v[40:43]
 ds_read_b128 v[32:35], v15 offset:10240
 v_mfma_f32_16x16x32_bf16 v[48:51], a[28:31], v[16:19], v[48:51]
 ds_read_b128 v[36:39], v15 offset:11264
 v_mfma_f32_16x16x32_bf16 v[56:59], v[16:19], a[148:151], v[56:59]
 v_mfma_f32_16x16x32_bf16 v[60:63], v[16:19], a[156:159], v[60:63]
 v_mfma_f32_16x16x32_bf16 v[44:47], a[20:23], v[20:23], v[44:47]
 v_mfma_f32_16x16x32_bf16 v[52:55], a[28:31], v[20:23], v[52:55]
 v_mfma_f32_16x16x32_bf16 v[64:67], v[20:23], a[148:151], v[64:67]
 v_mfma_f32_16x16x32_bf16 v[68:71], v[20:23], a[156:159], v[68:71]
 s_waitcnt lgkmcnt(2)
 v_mfma_f32_16x16x32_bf16 v[40:43], a[32:35], v[24:27], v[40:43]
 ds_read_b128 v[16:19], v15 offset:12288
 v_mfma_f32_16x16x32_bf16 v[48:51], a[40:43], v[24:27], v[48:51]
 ds_read_b128 v[20:23], v15 offset:13312
 v_mfma_f32_16x16x32_bf16 v[56:59], v[24:27], a[160:163], v[56:59]
 v_mfma_f32_16x16x32_bf16 v[60:63], v[24:27], a[168:171], v[60:63]
 v_mfma_f32_16x16x32_bf16 v[44:47], a[32:35], v[28:31], v[44:47]
 v_mfma_f32_16x16x32_bf16 v[52:55], a[40:43], v[28:31], v[52:55]
 v_mfma_f32_16x16x32_bf16 v[64:67], v[28:31], a[160:163], v[64:67]
 v_mfma_f32_16x16x32_bf16 v[68:71], v[28:31], a[168:171], v[68:71]
 s_waitcnt vmcnt(0)
 v_cmp_eq_u32 vcc, 0, v14
 s_cmp_eq_u32 s93, 0
 s_cbranch_scc1 L_nopend_120
 s_mov_b64 exec, 1
 buffer_store_dword v4, off, s[32:35], s62 offset:1024 sc1
 s_mov_b64 exec, -1
 s_mov_b32 s93, 0
L_nopend_120:
 s_waitcnt lgkmcnt(2)
 v_mfma_f32_16x16x32_bf16 v[40:43], a[36:39], v[32:35], v[40:43]
 ds_read_b128 v[24:27], v15 offset:14336
 v_mfma_f32_16x16x32_bf16 v[48:51], a[44:47], v[32:35], v[48:51]
 ds_read_b128 v[28:31], v15 offset:15360
 v_mfma_f32_16x16x32_bf16 v[56:59], v[32:35], a[164:167], v[56:59]
 s_cmp_eq_u64 vcc, 0
 s_cselect_b32 s92, 1, 0
 v_mfma_f32_16x16x32_bf16 v[60:63], v[32:35], a[172:175], v[60:63]
 s_cmp_ge_u32 s55, 31
 s_cselect_b32 s92, 0, s92
 v_mfma_f32_16x16x32_bf16 v[44:47], a[36:39], v[36:39], v[44:47]
 s_cmp_eq_u32 s92, 1
 s_cselect_b32 s57, s57, 0x40000000
 v_mfma_f32_16x16x32_bf16 v[52:55], a[44:47], v[36:39], v[52:55]
 v_mfma_f32_16x16x32_bf16 v[64:67], v[36:39], a[164:167], v[64:67]
 v_mfma_f32_16x16x32_bf16 v[68:71], v[36:39], a[172:175], v[68:71]
 s_waitcnt lgkmcnt(2)
 v_mfma_f32_16x16x32_bf16 v[40:43], a[48:51], v[16:19], v[40:43]
 ds_read_b128 v[32:35], v15 offset:16384
 v_mfma_f32_16x16x32_bf16 v[48:51], a[56:59], v[16:19], v[48:51]
 ds_read_b128 v[36:39], v15 offset:17408
 v_mfma_f32_16x16x32_bf16 v[56:59], v[16:19], a[176:179], v[56:59]
 buffer_load_dwordx4 v1, s[32:35], s57 offen offset:0 sc1 lds
 v_mfma_f32_16x16x32_bf16 v[60:63], v[16:19], a[184:187], v[60:63]
 v_mfma_f32_16x16x32_bf16 v[44:47], a[48:51], v[20:23], v[44:47]
 v_mfma_f32_16x16x32_bf16 v[52:55], a[56:59], v[20:23], v[52:55]
 v_mfma_f32_16x16x32_bf16 v[64:67], v[20:23], a[176:179], v[64:67]
 v_mfma_f32_16x16x32_bf16 v[68:71], v[20:23], a[184:187], v[68:71]
 s_waitcnt lgkmcnt(2)
 v_mfma_f32_16x16x32_bf16 v[40:43], a[52:55], v[24:27], v[40:43]
 ds_read_b128 v[16:19], v15 offset:18432
 v_mfma_f32_16x16x32_bf16 v[48:51], a[60:63], v[24:27], v[48:51]
 ds_read_b128 v[20:23], v15 offset:19456
 v_mfma_f32_16x16x32_bf16 v[56:59], v[24:27], a[180:183], v[56:59]
 buffer_load_dwordx4 v1, s[32:35], s57 offen offset:1024 sc1 lds
 v_mfma_f32_16x16x32_bf16 v[60:63], v[24:27], a[188:191], v[60:63]
 v_mfma_f32_16x16x32_bf16 v[44:47], a[52:55], v[28:31], v[44:47]
 v_mfma_f32_16x16x32_bf16 v[52:55], a[60:63], v[28:31], v[52:55]
 v_mfma_f32_16x16x32_bf16 v[64:67], v[28:31], a[180:183], v[64:67]
 v_mfma_f32_16x16x32_bf16 v[68:71], v[28:31], a[188:191], v[68:71]
 s_waitcnt lgkmcnt(2)
 v_mfma_f32_16x16x32_bf16 v[40:43], a[64:67], v[32:35], v[40:43]
 ds_read_b128 v[24:27], v15 offset:20480
 v_mfma_f32_16x16x32_bf16 v[48:51], a[72:75], v[32:35], v[48:51]
 ds_read_b128 v[28:31], v15 offset:21504
 v_mfma_f32_16x16x32_bf16 v[56:59], v[32:35], a[192:195], v[56:59]
 buffer_load_dwordx4 v1, s[32:35], s57 offen offset:2048 sc1 lds
 v_mfma_f32_16x16x32_bf16 v[60:63], v[32:35], a[200:203], v[60:63]
 v_mfma_f32_16x16x32_bf16 v[44:47], a[64:67], v[36:39], v[44:47]
 v_mfma_f32_16x16x32_bf16 v[52:55], a[72:75], v[36:39], v[52:55]
 v_mfma_f32_16x16x32_bf16 v[64:67], v[36:39], a[192:195], v[64:67]
 v_mfma_f32_16x16x32_bf16 v[68:71], v[36:39], a[200:203], v[68:71]
 s_waitcnt lgkmcnt(2)
 v_mfma_f32_16x16x32_bf16 v[40:43], a[68:71], v[16:19], v[40:43]
 ds_read_b128 v[32:35], v15 offset:22528
 v_mfma_f32_16x16x32_bf16 v[48:51], a[76:79], v[16:19], v[48:51]
 ds_read_b128 v[36:39], v15 offset:23552
 v_mfma_f32_16x16x32_bf16 v[56:59], v[16:19], a[196:199], v[56:59]
 buffer_load_dwordx4 v1, s[32:35], s57 offen offset:3072 sc1 lds
 v_mfma_f32_16x16x32_bf16 v[60:63], v[16:19], a[204:207], v[60:63]
 v_mfma_f32_16x16x32_bf16 v[44:47], a[68:71], v[20:23], v[44:47]
 v_mfma_f32_16x16x32_bf16 v[52:55], a[76:79], v[20:23], v[52:55]
 v_mfma_f32_16x16x32_bf16 v[64:67], v[20:23], a[196:199], v[64:67]
 v_mfma_f32_16x16x32_bf16 v[68:71], v[20:23], a[204:207], v[68:71]
 s_waitcnt lgkmcnt(2)
 v_mfma_f32_16x16x32_bf16 v[40:43], a[80:83], v[24:27], v[40:43]
 ds_read_b128 v[16:19], v15 offset:24576
 v_mfma_f32_16x16x32_bf16 v[48:51], a[88:91], v[24:27], v[48:51]
 ds_read_b128 v[20:23], v15 offset:25600
 v_mfma_f32_16x16x32_bf16 v[56:59], v[24:27], a[208:211], v[56:59]
 s_add_u32 m0, s94, 4096
 s_add_u32 s57, s57, 4096
 buffer_load_dwordx4 v1, s[32:35], s57 offen offset:0 sc1 lds
 v_mfma_f32_16x16x32_bf16 v[60:63], v[24:27], a[216:219], v[60:63]
 v_mfma_f32_16x16x32_bf16 v[44:47], a[80:83], v[28:31], v[44:47]
 v_mfma_f32_16x16x32_bf16 v[52:55], a[88:91], v[28:31], v[52:55]
 v_mfma_f32_16x16x32_bf16 v[64:67], v[28:31], a[208:211], v[64:67]
 v_mfma_f32_16x16x32_bf16 v[68:71], v[28:31], a[216:219], v[68:71]
 s_waitcnt lgkmcnt(2)
 v_mfma_f32_16x16x32_bf16 v[40:43], a[84:87], v[32:35], v[40:43]
 ds_read_b128 v[24:27], v15 offset:26624
 v_mfma_f32_16x16x32_bf16 v[48:51], a[92:95], v[32:35], v[48:51]
 ds_read_b128 v[28:31], v15 offset:27648
 v_mfma_f32_16x16x32_bf16 v[56:59], v[32:35], a[212:215], v[56:59]
 buffer_load_dwordx4 v1, s[32:35], s57 offen offset:1024 sc1 lds
 v_mfma_f32_16x16x32_bf16 v[60:63], v[32:35], a[220:223], v[60:63]
 v_mfma_f32_16x16x32_bf16 v[44:47], a[84:87], v[36:39], v[44:47]
 v_mfma_f32_16x16x32_bf16 v[52:55], a[92:95], v[36:39], v[52:55]
 v_mfma_f32_16x16x32_bf16 v[64:67], v[36:39], a[212:215], v[64:67]
 v_mfma_f32_16x16x32_bf16 v[68:71], v[36:39], a[220:223], v[68:71]
 s_waitcnt lgkmcnt(2)
 v_mfma_f32_16x16x32_bf16 v[40:43], a[96:99], v[16:19], v[40:43]
 ds_read_b128 v[32:35], v15 offset:28672
 v_mfma_f32_16x16x32_bf16 v[48:51], a[104:107], v[16:19], v[48:51]
 ds_read_b128 v[36:39], v15 offset:29696
 v_mfma_f32_16x16x32_bf16 v[56:59], v[16:19], a[224:227], v[56:59]
 buffer_load_dwordx4 v1, s[32:35], s57 offen offset:2048 sc1 lds
 v_mfma_f32_16x16x32_bf16 v[60:63], v[16:19], a[232:235], v[60:63]
 v_mfma_f32_16x16x32_bf16 v[44:47], a[96:99], v[20:23], v[44:47]
 v_mfma_f32_16x16x32_bf16 v[52:55], a[104:107], v[20:23], v[52:55]
 v_mfma_f32_16x16x32_bf16 v[64:67], v[20:23], a[224:227], v[64:67]
 v_mfma_f32_16x16x32_bf16 v[68:71], v[20:23], a[232:235], v[68:71]
 s_waitcnt lgkmcnt(2)
 v_mfma_f32_16x16x32_bf16 v[40:43], a[100:103], v[24:27], v[40:43]
 ds_read_b128 v[16:19], v15 offset:30720
 v_mfma_f32_16x16x32_bf16 v[48:51], a[108:111], v[24:27], v[48:51]
 ds_read_b128 v[20:23], v15 offset:31744
 v_mfma_f32_16x16x32_bf16 v[56:59], v[24:27], a[228:231], v[56:59]
 buffer_load_dwordx4 v1, s[32:35], s57 offen offset:3072 sc1 lds
 v_mfma_f32_16x16x32_bf16 v[60:63], v[24:27], a[236:239], v[60:63]
 v_mfma_f32_16x16x32_bf16 v[44:47], a[100:103], v[28:31], v[44:47]
 v_mfma_f32_16x16x32_bf16 v[52:55], a[108:111], v[28:31], v[52:55]
 v_mfma_f32_16x16x32_bf16 v[64:67], v[28:31], a[228:231], v[64:67]
 v_mfma_f32_16x16x32_bf16 v[68:71], v[28:31], a[236:239], v[68:71]
 s_waitcnt lgkmcnt(2)
 v_mfma_f32_16x16x32_bf16 v[40:43], a[112:115], v[32:35], v[40:43]
 ds_read_b128 v[24:27], v15 offset:0
 v_mfma_f32_16x16x32_bf16 v[48:51], a[120:123], v[32:35], v[48:51]
 ds_read_b128 v[28:31], v15 offset:1024
 v_mfma_f32_16x16x32_bf16 v[56:59], v[32:35], a[240:243], v[56:59]
 v_mfma_f32_16x16x32_bf16 v[60:63], v[32:35], a[248:251], v[60:63]
 v_mfma_f32_16x16x32_bf16 v[44:47], a[112:115], v[36:39], v[44:47]
 v_mfma_f32_16x16x32_bf16 v[52:55], a[120:123], v[36:39], v[52:55]
 v_mfma_f32_16x16x32_bf16 v[64:67], v[36:39], a[240:243], v[64:67]
 v_mfma_f32_16x16x32_bf16 v[68:71], v[36:39], a[248:251], v[68:71]
 s_waitcnt lgkmcnt(2)
 v_mfma_f32_16x16x32_bf16 v[40:43], a[116:119], v[16:19], v[40:43]
 ds_read_b128 v[32:35], v15 offset:2048
 v_mfma_f32_16x16x32_bf16 v[48:51], a[124:127], v[16:19], v[48:51]
 ds_read_b128 v[36:39], v15 offset:3072
 v_mfma_f32_16x16x32_bf16 v[56:59], v[16:19], a[244:247], v[56:59]
 v_mfma_f32_16x16x32_bf16 v[60:63], v[16:19], a[252:255], v[60:63]
 v_mfma_f32_16x16x32_bf16 v[44:47], a[116:119], v[20:23], v[44:47]
 v_mfma_f32_16x16x32_bf16 v[52:55], a[124:127], v[20:23], v[52:55]
 v_mfma_f32_16x16x32_bf16 v[64:67], v[20:23], a[244:247], v[64:67]
 v_mfma_f32_16x16x32_bf16 v[68:71], v[20:23], a[252:255], v[68:71]
L_wa_gotq:
 s_waitcnt lgkmcnt(2)
 v_mfma_f32_16x16x32_bf16 v[72:75], v[128:131], v[24:27], 0
 ds_read_b128 v[16:19], v15 offset:4096
 v_mfma_f32_16x16x32_bf16 v[80:83], v[136:139], v[24:27], 0
 ds_read_b128 v[20:23], v15 offset:5120
 v_mfma_f32_16x16x32_bf16 v[76:79], v[128:131], v[28:31], 0
 buffer_load_dwordx4 v[116:119], v1, s[32:35], s60 offen offset:0 sc1
 v_mfma_f32_16x16x32_bf16 v[84:87], v[136:139], v[28:31], 0
 buffer_load_dwordx4 v[120:123], v1, s[32:35], s60 offen offset:1024 sc1
 buffer_load_dword v14, v3, s[32:35], s95 offen sc1
 s_waitcnt lgkmcnt(2)
 v_mfma_f32_16x16x32_bf16 v[72:75], v[132:135], v[32:35], v[72:75]
 ds_read_b128 v[24:27], v15 offset:6144
 v_cvt_pk_bf16_f32 v88, v40, v41
 v_mfma_f32_16x16x32_bf16 v[80:83], v[140:143], v[32:35], v[80:83]
 ds_read_b128 v[28:31], v15 offset:7168
 v_cvt_pk_bf16_f32 v89, v42, v43
 v_mfma_f32_16x16x32_bf16 v[76:79], v[132:135], v[36:39], v[76:79]
 v_cvt_pk_bf16_f32 v90, v48, v49
 v_mfma_f32_16x16x32_bf16 v[84:87], v[140:143], v[36:39], v[84:87]
 v_cvt_pk_bf16_f32 v91, v50, v51
 v_mov_b32 v112, v88
 s_waitcnt lgkmcnt(2)
 v_mfma_f32_16x16x32_bf16 v[72:75], v[144:147], v[16:19], v[72:75]
 ds_read_b128 v[32:35], v15 offset:8192
 v_and_or_b32 v88, v88, -2, s65
 v_mfma_f32_16x16x32_bf16 v[80:83], v[152:155], v[16:19], v[80:83]
 ds_read_b128 v[36:39], v15 offset:9216
 buffer_store_dwordx4 v[88:91], v1, s[32:35], s59 offen offset:0 sc1
 v_mfma_f32_16x16x32_bf16 v[76:79], v[144:147], v[20:23], v[76:79]
 v_cvt_pk_bf16_f32 v92, v44, v45
 v_mfma_f32_16x16x32_bf16 v[84:87], v[152:155], v[20:23], v[84:87]
 v_cvt_pk_bf16_f32 v93, v46, v47
 v_cvt_pk_bf16_f32 v94, v52, v53
 s_waitcnt lgkmcnt(2)
 v_mfma_f32_16x16x32_bf16 v[72:75], v[148:151], v[24:27], v[72:75]
 ds_read_b128 v[16:19], v15 offset:10240
 v_cvt_pk_bf16_f32 v95, v54, v55
 v_mfma_f32_16x16x32_bf16 v[80:83], v[156:159], v[24:27], v[80:83]
 ds_read_b128 v[20:23], v15 offset:11264
 v_mov_b32_e64 v113, v92
 v_mfma_f32_16x16x32_bf16 v[76:79], v[148:151], v[28:31], v[76:79]
 v_and_or_b32 v92, v92, -2, s65
 v_mfma_f32_16x16x32_bf16 v[84:87], v[156:159], v[28:31], v[84:87]
 buffer_store_dwordx4 v[92:95], v1, s[32:35], s59 offen offset:1024 sc1
 v_cvt_pk_bf16_f32 v96, v56, v57
 s_waitcnt lgkmcnt(2)
 v_mfma_f32_16x16x32_bf16 v[72:75], v[160:163], v[32:35], v[72:75]
 ds_read_b128 v[24:27], v15 offset:12288
 v_cvt_pk_bf16_f32 v97, v58, v59
 v_mfma_f32_16x16x32_bf16 v[80:83], v[168:171], v[32:35], v[80:83]
 ds_read_b128 v[28:31], v15 offset:13312
 v_cvt_pk_bf16_f32 v98, v64, v65
 v_mfma_f32_16x16x32_bf16 v[76:79], v[160:163], v[36:39], v[76:79]
 v_cvt_pk_bf16_f32 v99, v66, v67
 v_mfma_f32_16x16x32_bf16 v[84:87], v[168:171], v[36:39], v[84:87]
 v_mov_b32 v114, v96
 v_and_or_b32 v96, v96, -2, s65
 s_waitcnt lgkmcnt(2)
 v_mfma_f32_16x16x32_bf16 v[72:75], v[164:167], v[16:19], v[72:75]
 ds_read_b128 v[32:35], v15 offset:14336
 buffer_store_dwordx4 v[96:99], v1, s[32:35], s59 offen offset:2048 sc1
 v_mfma_f32_16x16x32_bf16 v[80:83], v[172:175], v[16:19], v[80:83]
 ds_read_b128 v[36:39], v15 offset:15360
 v_cvt_pk_bf16_f32 v100, v60, v61
 v_mfma_f32_16x16x32_bf16 v[76:79], v[164:167], v[20:23], v[76:79]
 v_cvt_pk_bf16_f32 v101, v62, v63
 v_mfma_f32_16x16x32_bf16 v[84:87], v[172:175], v[20:23], v[84:87]
 v_cvt_pk_bf16_f32 v102, v68, v69
 v_cvt_pk_bf16_f32 v103, v70, v71
 s_waitcnt lgkmcnt(2)
 v_mfma_f32_16x16x32_bf16 v[72:75], v[176:179], v[24:27], v[72:75]
 ds_read_b128 v[16:19], v15 offset:16384
 v_mov_b32 v115, v100
 v_mfma_f32_16x16x32_bf16 v[80:83], v[184:187], v[24:27], v[80:83]
 ds_read_b128 v[20:23], v15 offset:17408
 v_and_or_b32 v100, v100, -2, s65
 v_mfma_f32_16x16x32_bf16 v[76:79], v[176:179], v[28:31], v[76:79]
 buffer_store_dwordx4 v[100:103], v1, s[32:35], s59 offen offset:3072 sc1
 v_mfma_f32_16x16x32_bf16 v[84:87], v[184:187], v[28:31], v[84:87]
 v_mov_b32 v88, v112
 v_mov_b32 v92, v113
 s_waitcnt lgkmcnt(2)
 v_mfma_f32_16x16x32_bf16 v[72:75], v[180:183], v[32:35], v[72:75]
 ds_read_b128 v[24:27], v15 offset:18432
 v_mov_b32 v96, v114
 v_mfma_f32_16x16x32_bf16 v[80:83], v[188:191], v[32:35], v[80:83]
 ds_read_b128 v[28:31], v15 offset:19456
 v_mov_b32 v100, v115
 v_mfma_f32_16x16x32_bf16 v[76:79], v[180:183], v[36:39], v[76:79]
 s_lshl_b32 s49, s46, 11
 v_mfma_f32_16x16x32_bf16 v[84:87], v[188:191], v[36:39], v[84:87]
 s_add_u32 s49, s49, 122880
 v_add_u32 v124, s49, v1
 s_waitcnt lgkmcnt(2)
 v_mfma_f32_16x16x32_bf16 v[72:75], v[192:195], v[16:19], v[72:75]
 ds_read_b128 v[32:35], v15 offset:20480
 v_add_u32 v8, 122880, v1
 v_mfma_f32_16x16x32_bf16 v[80:83], v[200:203], v[16:19], v[80:83]
 ds_read_b128 v[36:39], v15 offset:21504
 s_and_b32 s48, s46, 1
 v_mfma_f32_16x16x32_bf16 v[76:79], v[192:195], v[20:23], v[76:79]
 s_lshl_b32 s48, s48, 10
 v_mfma_f32_16x16x32_bf16 v[84:87], v[200:203], v[20:23], v[84:87]
 v_subrev_u32 v126, s48, v6
 s_waitcnt vmcnt(4)
 s_waitcnt lgkmcnt(2)
 v_mfma_f32_16x16x32_bf16 v[72:75], v[196:199], v[24:27], v[72:75]
 ds_read_b128 v[16:19], v15 offset:22528
 v_max3_u32 v7, v116, v117, v118
 v_mfma_f32_16x16x32_bf16 v[80:83], v[204:207], v[24:27], v[80:83]
 ds_read_b128 v[20:23], v15 offset:23552
 v_max3_u32 v7, v7, v119, v120
 v_mfma_f32_16x16x32_bf16 v[76:79], v[196:199], v[28:31], v[76:79]
 v_max3_u32 v7, v7, v121, v122
 v_mfma_f32_16x16x32_bf16 v[84:87], v[204:207], v[28:31], v[84:87]
 v_max_u32 v7, v7, v123
 v_cmp_eq_u32 vcc, -1, v7
 s_waitcnt lgkmcnt(2)
 v_mfma_f32_16x16x32_bf16 v[72:75], v[208:211], v[32:35], v[72:75]
 ds_read_b128 v[24:27], v15 offset:24576
 v_cmp_eq_u32 s[98:99], 0, v14
 v_mfma_f32_16x16x32_bf16 v[80:83], v[216:219], v[32:35], v[80:83]
 ds_read_b128 v[28:31], v15 offset:25600
 v_mfma_f32_16x16x32_bf16 v[76:79], v[208:211], v[36:39], v[76:79]
 ds_write_b128 v124, v[116:119]
 v_mfma_f32_16x16x32_bf16 v[84:87], v[216:219], v[36:39], v[84:87]
 s_waitcnt lgkmcnt(3)
 v_mfma_f32_16x16x32_bf16 v[72:75], v[212:215], v[16:19], v[72:75]
 ds_read_b128 v[32:35], v15 offset:26624
 v_mfma_f32_16x16x32_bf16 v[80:83], v[220:223], v[16:19], v[80:83]
 ds_read_b128 v[36:39], v15 offset:27648
 v_mfma_f32_16x16x32_bf16 v[76:79], v[212:215], v[20:23], v[76:79]
 ds_write_b128 v124, v[120:123] offset:1024
 v_mfma_f32_16x16x32_bf16 v[84:87], v[220:223], v[20:23], v[84:87]
 s_waitcnt lgkmcnt(3)
 v_mfma_f32_16x16x32_bf16 v[72:75], v[224:227], v[24:27], v[72:75]
 ds_read_b128 v[16:19], v15 offset:28672
 v_mfma_f32_16x16x32_bf16 v[80:83], v[232:235], v[24:27], v[80:83]
 ds_read_b128 v[20:23], v15 offset:29696
 v_mfma_f32_16x16x32_bf16 v[76:79], v[224:227], v[28:31], v[76:79]
 ds_write_b128 v5, v[88:91] offset:8192
 v_mfma_f32_16x16x32_bf16 v[84:87], v[232:235], v[28:31], v[84:87]
 s_waitcnt lgkmcnt(3)
 v_mfma_f32_16x16x32_bf16 v[72:75], v[228:231], v[32:35], v[72:75]
 ds_read_b128 v[24:27], v15 offset:30720
 v_mfma_f32_16x16x32_bf16 v[80:83], v[236:239], v[32:35], v[80:83]
 ds_read_b128 v[28:31], v15 offset:31744
 v_mfma_f32_16x16x32_bf16 v[76:79], v[228:231], v[36:39], v[76:79]
 ds_write_b128 v5, v[92:95] offset:9216
 v_mfma_f32_16x16x32_bf16 v[84:87], v[236:239], v[36:39], v[84:87]
 s_waitcnt lgkmcnt(3)
 v_mfma_f32_16x16x32_bf16 v[72:75], v[240:243], v[16:19], v[72:75]
 v_mfma_f32_16x16x32_bf16 v[80:83], v[248:251], v[16:19], v[80:83]
 v_mfma_f32_16x16x32_bf16 v[76:79], v[240:243], v[20:23], v[76:79]
 ds_write_b128 v5, v[96:99] offset:16384
 v_mfma_f32_16x16x32_bf16 v[84:87], v[248:251], v[20:23], v[84:87]
 s_waitcnt lgkmcnt(1)
 v_mfma_f32_16x16x32_bf16 v[72:75], v[244:247], v[24:27], v[72:75]
 v_mfma_f32_16x16x32_bf16 v[80:83], v[252:255], v[24:27], v[80:83]
 v_mfma_f32_16x16x32_bf16 v[76:79], v[244:247], v[28:31], v[76:79]
 ds_write_b128 v5, v[100:103] offset:17408
 v_mfma_f32_16x16x32_bf16 v[84:87], v[252:255], v[28:31], v[84:87]
 s_cmp_eq_u32 s55, 0
 s_cbranch_scc1 L_wa_first
 s_cbranch_vccnz L_wa_mem1
L_wa_memok:
 v_mov_b64 v[16:17], 0
 v_mov_b64 v[18:19], 0
 v_mov_b64 v[20:21], 0
 v_mov_b64 v[22:23], 0
 v_mov_b64 v[24:25], 0
 v_mov_b64 v[26:27], 0
 v_mov_b64 v[28:29], 0
 v_mov_b64 v[30:31], 0
 s_sub_u32 s48, s56, 2
 s_waitcnt lgkmcnt(0)
 s_barrier
 buffer_load_dword v14, v3, s[32:35], s95 offen sc1
 ds_read_b128 v[40:43], v8 offset:0
 ds_read_b128 v[44:47], v8 offset:1024
 ds_read_b128 v[48:51], v8 offset:2048
 ds_read_b128 v[52:55], v8 offset:3072
 ds_read_b128 v[56:59], v8 offset:4096
 ds_read_b128 v[60:63], v8 offset:5120
 ds_read_b128 v[64:67], v8 offset:6144
 ds_read_b128 v[68:71], v8 offset:7168
 s_cmp_eq_u32 s55, 32
 s_cbranch_scc1 L_noq_121
 v_cvt_pk_bf16_f32 v104, v72, v73
 v_cvt_pk_bf16_f32 v105, v74, v75
 v_cvt_pk_bf16_f32 v106, v80, v81
 v_cvt_pk_bf16_f32 v107, v82, v83
 ds_write_b128 v5, v[104:107] offset:0
 v_cvt_pk_bf16_f32 v108, v76, v77
 v_cvt_pk_bf16_f32 v109, v78, v79
 v_cvt_pk_bf16_f32 v110, v84, v85
 v_cvt_pk_bf16_f32 v111, v86, v87
 ds_write_b128 v5, v[108:111] offset:1024
L_noq_121:
 s_lshl_b32 s61, s56, 18
 s_add_u32 s61, s61, s5
 s_waitcnt lgkmcnt(7)
 v_smfmac_f32_16x16x64_bf16 v[16:19], v[40:43], a[0:7], v2
 ds_read_b128 v[88:91], v6 offset:0
 v_smfmac_f32_16x16x64_bf16 v[20:23], v[40:43], a[8:15], v2
 ds_read_b128 v[32:35], v126 offset:8192
 s_waitcnt lgkmcnt(8)
 v_smfmac_f32_16x16x64_bf16 v[16:19], v[44:47], a[16:23], v2
 ds_read_b128 v[36:39], v126 offset:9216
 v_smfmac_f32_16x16x64_bf16 v[20:23], v[44:47], a[24:31], v2
 ds_read_b128 v[92:95], v6 offset:2048
 s_waitcnt lgkmcnt(9)
 v_smfmac_f32_16x16x64_bf16 v[16:19], v[48:51], a[32:39], v2
 ds_read_b128 v[84:87], v126 offset:10240
 v_smfmac_f32_16x16x64_bf16 v[20:23], v[48:51], a[40:47], v2
 ds_read_b128 v[112:115], v126 offset:11264
 s_waitcnt lgkmcnt(10)
 v_smfmac_f32_16x16x64_bf16 v[16:19], v[52:55], a[48:55], v2
 ds_read_b128 v[96:99], v6 offset:4096
 v_smfmac_f32_16x16x64_bf16 v[20:23], v[52:55], a[56:63], v2
 ds_read_b128 v[116:119], v126 offset:12288
 s_waitcnt lgkmcnt(11)
 v_smfmac_f32_16x16x64_bf16 v[16:19], v[56:59], a[64:71], v2
 ds_read_b128 v[120:123], v126 offset:13312
 v_smfmac_f32_16x16x64_bf16 v[20:23], v[56:59], a[72:79], v2
 ds_read_b128 v[100:103], v6 offset:6144
 s_waitcnt lgkmcnt(12)
 v_smfmac_f32_16x16x64_bf16 v[16:19], v[60:63], a[80:87], v2
 ds_read_b128 v[104:107], v126 offset:14336
 v_smfmac_f32_16x16x64_bf16 v[20:23], v[60:63], a[88:95], v2
 ds_read_b128 v[108:111], v126 offset:15360
 s_waitcnt lgkmcnt(13)
 v_smfmac_f32_16x16x64_bf16 v[16:19], v[64:67], a[96:103], v2
 v_smfmac_f32_16x16x64_bf16 v[20:23], v[64:67], a[104:111], v2
 s_waitcnt lgkmcnt(12)
 v_smfmac_f32_16x16x64_bf16 v[16:19], v[68:71], a[112:119], v2
 v_smfmac_f32_16x16x64_bf16 v[20:23], v[68:71], a[120:127], v2
 v_smfmac_f32_16x16x64_bf16 v[24:27], v[40:43], a[128:135], v2
 s_lshl_b32 s62, s48, 11
 v_smfmac_f32_16x16x64_bf16 v[28:31], v[40:43], a[136:143], v2
 s_add_u32 s62, s62, s6
 v_smfmac_f32_16x16x64_bf16 v[24:27], v[44:47], a[144:151], v2
 v_smfmac_f32_16x16x64_bf16 v[28:31], v[44:47], a[152:159], v2
 v_nop_e64
 v_cvt_pk_bf16_f32 v72, v16, v17
 v_cvt_pk_bf16_f32 v73, v18, v19
 v_cvt_pk_bf16_f32 v74, v20, v21
 v_cvt_pk_bf16_f32 v75, v22, v23
 v_smfmac_f32_16x16x64_bf16 v[24:27], v[48:51], a[160:167], v2
 s_lshr_b32 s48, s46, 1
 v_smfmac_f32_16x16x64_bf16 v[28:31], v[48:51], a[168:175], v2
 s_lshl_b32 s49, s48, 12
 v_mfma_f32_16x16x16_bf16 v[76:79], v[72:73], v[12:13], 0
 v_mfma_f32_16x16x16_bf16 v[80:83], v[74:75], v[12:13], 0
 s_waitcnt lgkmcnt(0)
 v_smfmac_f32_16x16x64_bf16 v[24:27], v[52:55], a[176:183], v2
 v_add_u32 v7, s49, v126
 v_smfmac_f32_16x16x64_bf16 v[28:31], v[52:55], a[184:191], v2
 s_lshl_b32 s49, s48, 11
 v_smfmac_f32_16x16x64_bf16 v[24:27], v[56:59], a[192:199], v2
 v_smfmac_f32_16x16x64_bf16 v[28:31], v[56:59], a[200:207], v2
 v_cvt_pk_bf16_f32 v72, v76, v77
 v_cvt_pk_bf16_f32 v73, v78, v79
 v_cvt_pk_bf16_f32 v74, v80, v81
 v_cvt_pk_bf16_f32 v75, v82, v83
 ds_write_b128 v9, v[72:75]
 v_smfmac_f32_16x16x64_bf16 v[24:27], v[60:63], a[208:215], v2
 s_add_u32 s49, s49, 118784
 v_smfmac_f32_16x16x64_bf16 v[28:31], v[60:63], a[216:223], v2
 v_smfmac_f32_16x16x64_bf16 v[24:27], v[64:67], a[224:231], v2
 v_smfmac_f32_16x16x64_bf16 v[28:31], v[64:67], a[232:239], v2
 v_smfmac_f32_16x16x64_bf16 v[24:27], v[68:71], a[240:247], v2
 v_smfmac_f32_16x16x64_bf16 v[28:31], v[68:71], a[248:255], v2
 ds_read_b128 v[56:59], v7 offset:16384
 ds_read_b128 v[60:63], v7 offset:17408
 ds_read_b128 v[64:67], v7 offset:18432
 ds_read_b128 v[68:71], v7 offset:19456
 v_mfma_f32_16x16x32_bf16 v[16:19], v[32:35], v[88:91], 0
 v_mfma_f32_16x16x32_bf16 v[20:23], v[36:39], v[88:91], 0
 s_nop 0
 v_cvt_pk_bf16_f32 v76, v24, v25
 v_cvt_pk_bf16_f32 v77, v26, v27
 v_cvt_pk_bf16_f32 v78, v28, v29
 v_cvt_pk_bf16_f32 v79, v30, v31
 ds_write_b128 v9, v[76:79] offset:4096
 v_add_u32 v8, 114688, v1
 v_add_u32 v7, s49, v1
 v_mfma_f32_16x16x32_bf16 v[16:19], v[84:87], v[92:95], v[16:19]
 v_mfma_f32_16x16x32_bf16 v[20:23], v[112:115], v[92:95], v[20:23]
 v_mfma_f32_16x16x32_bf16 v[16:19], v[116:119], v[96:99], v[16:19]
 v_mfma_f32_16x16x32_bf16 v[20:23], v[120:123], v[96:99], v[20:23]
 s_waitcnt lgkmcnt(0)
 s_barrier
 s_cmp_eq_u32 s92, 0
 s_cbranch_scc1 L_wa_s3
L_wa_nos3:
 buffer_load_dword v14, v3, s[32:35], s95 offen sc1
 ds_read_b128 v[40:43], v8 offset:0
 ds_read_b128 v[44:47], v8 offset:1024
 ds_read_b128 v[48:51], v8 offset:2048
 ds_read_b128 v[52:55], v8 offset:3072
 ds_read_b128 v[72:75], v7 offset:0
 ds_read_b128 v[76:79], v7 offset:1024
 v_mfma_f32_16x16x32_bf16 v[16:19], v[104:107], v[100:103], v[16:19]
 v_mfma_f32_16x16x32_bf16 v[20:23], v[108:111], v[100:103], v[20:23]
 s_waitcnt lgkmcnt(5)
 v_mfma_f32_16x16x32_bf16 v[80:83], v[40:43], v[88:91], 0
 s_waitcnt lgkmcnt(4)
 v_mfma_f32_16x16x32_bf16 v[80:83], v[44:47], v[92:95], v[80:83]
 s_waitcnt lgkmcnt(3)
 v_mfma_f32_16x16x32_bf16 v[80:83], v[48:51], v[96:99], v[80:83]
 s_waitcnt lgkmcnt(2)
 s_nop 0
 v_mfma_f32_16x16x32_bf16 v[80:83], v[52:55], v[100:103], v[80:83]
 v_cndmask_b32 v16, v11, v16, s[76:77]
 v_cndmask_b32 v17, v11, v17, s[78:79]
 v_cndmask_b32 v18, v11, v18, s[80:81]
 v_cndmask_b32 v19, v11, v19, s[82:83]
 v_cndmask_b32 v20, v11, v20, s[84:85]
 v_cndmask_b32 v21, v11, v21, s[86:87]
 v_cndmask_b32 v22, v11, v22, s[88:89]
 v_cndmask_b32 v23, v11, v23, s[90:91]
 v_max3_f32 v84, v16, v17, v18
 v_max3_f32 v84, v84, v19, v20
 v_max3_f32 v84, v84, v21, v22
 v_max3_f32 v84, v84, v23, v80
 v_max3_f32 v84, v84, v81, v82
 v_max_f32 v84, v84, v83
 v_mov_b32 v85, v84
 s_nop 1
 v_permlane16_swap_b32 v84, v85
 v_max_f32 v84, v84, v85
 v_mov_b32 v85, v84
 s_nop 1
 v_permlane32_swap_b32 v84, v85
 v_max_f32 v84, v84, v85
 v_mul_f32 v84, s96, v84
 v_pk_fma_f32 v[16:17], v[16:17], s[96:97], v[84:85] op_sel_hi:[1,1,0] neg_lo:[0,0,1] neg_hi:[0,0,1]
 v_pk_fma_f32 v[18:19], v[18:19], s[96:97], v[84:85] op_sel_hi:[1,1,0] neg_lo:[0,0,1] neg_hi:[0,0,1]
 v_pk_fma_f32 v[20:21], v[20:21], s[96:97], v[84:85] op_sel_hi:[1,1,0] neg_lo:[0,0,1] neg_hi:[0,0,1]
 v_pk_fma_f32 v[22:23], v[22:23], s[96:97], v[84:85] op_sel_hi:[1,1,0] neg_lo:[0,0,1] neg_hi:[0,0,1]
 v_pk_fma_f32 v[80:81], v[80:81], s[96:97], v[84:85] op_sel_hi:[1,1,0] neg_lo:[0,0,1] neg_hi:[0,0,1]
 v_pk_fma_f32 v[82:83], v[82:83], s[96:97], v[84:85] op_sel_hi:[1,1,0] neg_lo:[0,0,1] neg_hi:[0,0,1]
 v_exp_f32 v16, v16
 v_exp_f32 v17, v17
 v_exp_f32 v18, v18
 v_exp_f32 v19, v19
 v_exp_f32 v20, v20
 v_exp_f32 v21, v21
 v_exp_f32 v22, v22
 v_exp_f32 v23, v23
 v_exp_f32 v80, v80
 v_exp_f32 v81, v81
 v_exp_f32 v82, v82
 v_exp_f32 v83, v83
 v_cvt_pk_bf16_f32 v24, v16, v17
 v_cvt_pk_bf16_f32 v25, v18, v19
 v_cvt_pk_bf16_f32 v26, v20, v21
 v_cvt_pk_bf16_f32 v27, v22, v23
 v_cvt_pk_bf16_f32 v28, v80, v81
 v_cvt_pk_bf16_f32 v29, v82, v83
 s_waitcnt lgkmcnt(0)
 v_mfma_f32_16x16x32_bf16 v[88:91], v[56:59], v[24:27], 0
 v_add_f32 v16, v16, v20
 v_add_f32 v17, v17, v21
 v_mfma_f32_16x16x32_bf16 v[92:95], v[60:63], v[24:27], 0
 v_add_f32 v18, v18, v22
 v_add_f32 v19, v19, v23
 v_mfma_f32_16x16x32_bf16 v[96:99], v[64:67], v[24:27], 0
 v_add_f32 v80, v80, v82
 v_add_f32 v81, v81, v83
 v_mfma_f32_16x16x32_bf16 v[100:103], v[68:71], v[24:27], 0
 v_add_f32 v16, v16, v18
 v_add_f32 v17, v17, v19
 v_mfma_f32_16x16x16_bf16 v[88:91], v[72:73], v[28:29], v[88:91]
 v_add_f32 v80, v80, v81
 v_add_f32 v16, v16, v17
 v_mfma_f32_16x16x16_bf16 v[92:95], v[74:75], v[28:29], v[92:95]
 v_fmac_f32 v16, 0.5, v80
 v_mov_b32 v17, v16
 v_mfma_f32_16x16x16_bf16 v[96:99], v[76:77], v[28:29], v[96:99]
 s_nop 0
 v_permlane16_swap_b32 v16, v17
 v_add_f32 v16, v16, v17
 v_mfma_f32_16x16x16_bf16 v[100:103], v[78:79], v[28:29], v[100:103]
 v_mov_b32 v17, v16
 s_nop 1
 v_permlane32_swap_b32 v16, v17
 v_add_f32 v16, v16, v17
 v_rcp_f32 v16, v16
 s_nop 0
 v_pk_mul_f32 v[88:89], v[88:89], v[16:17] op_sel_hi:[1,0]
 v_pk_mul_f32 v[90:91], v[90:91], v[16:17] op_sel_hi:[1,0]
 v_pk_mul_f32 v[92:93], v[92:93], v[16:17] op_sel_hi:[1,0]
 v_pk_mul_f32 v[94:95], v[94:95], v[16:17] op_sel_hi:[1,0]
 v_cvt_pk_bf16_f32 v104, v88, v89
 v_cvt_pk_bf16_f32 v105, v90, v91
 v_cvt_pk_bf16_f32 v106, v92, v93
 v_cvt_pk_bf16_f32 v107, v94, v95
 buffer_store_dwordx4 v[104:107], v1, s[32:35], s61 offen offset:0 sc1
 v_pk_mul_f32 v[96:97], v[96:97], v[16:17] op_sel_hi:[1,0]
 v_pk_mul_f32 v[98:99], v[98:99], v[16:17] op_sel_hi:[1,0]
 v_pk_mul_f32 v[100:101], v[100:101], v[16:17] op_sel_hi:[1,0]
 v_pk_mul_f32 v[102:103], v[102:103], v[16:17] op_sel_hi:[1,0]
 v_cvt_pk_bf16_f32 v108, v96, v97
 v_cvt_pk_bf16_f32 v109, v98, v99
 v_cvt_pk_bf16_f32 v110, v100, v101
 v_cvt_pk_bf16_f32 v111, v102, v103
 buffer_store_dwordx4 v[108:111], v1, s[32:35], s61 offen offset:2048 sc1
L_wa_attd:
 s_cmp_lg_u32 s92, 3
 s_cbranch_scc1 L_m3_122
 s_waitcnt vmcnt(2)
 s_mov_b32 s92, 1
L_m3_122:
 s_mov_b32 s93, s92
 s_cmp_eq_u32 s92, 1
 s_cbranch_scc1 L_wa_next
 s_waitcnt vmcnt(2)
 v_cmp_eq_u32 vcc, 0, v14
 s_cmp_ge_u32 s55, 31
 s_cbranch_scc1 L_wa_noE
 s_cbranch_vccnz L_wa_noE
 s_lshl_b32 s57, s56, 15
 s_add_u32 s57, s57, s72
 s_add_u32 s57, s57, 0x1410000
 s_add_u32 s94, s72, s66
 s_mov_b32 m0, s94
 s_nop 0
 buffer_load_dwordx4 v1, s[32:35], s57 offen offset:0 sc1 lds
 buffer_load_dwordx4 v1, s[32:35], s57 offen offset:1024 sc1 lds
 buffer_load_dwordx4 v1, s[32:35], s57 offen offset:2048 sc1 lds
 buffer_load_dwordx4 v1, s[32:35], s57 offen offset:3072 sc1 lds
 s_add_u32 m0, s94, 4096
 s_add_u32 s57, s57, 4096
 buffer_load_dwordx4 v1, s[32:35], s57 offen offset:0 sc1 lds
 buffer_load_dwordx4 v1, s[32:35], s57 offen offset:1024 sc1 lds
 buffer_load_dwordx4 v1, s[32:35], s57 offen offset:2048 sc1 lds
 buffer_load_dwordx4 v1, s[32:35], s57 offen offset:3072 sc1 lds
 s_mov_b32 s92, 2
 s_waitcnt vmcnt(8)
 s_branch L_wa_goE
L_wa_noE:
 s_waitcnt vmcnt(0)
L_wa_goE:
 s_mov_b64 exec, 1
 buffer_store_dword v4, off, s[32:35], s62 offset:1024 sc1
 s_mov_b64 exec, -1
 s_sub_u32 s48, s56, 2
L_wa_next:
 v_add_u32 v5, s63, v5
 v_subrev_u32 v6, s63, v6
 s_sub_u32 s63, 0, s63
 s_add_u32 s56, s56, 2
 s_add_u32 s55, s55, 1
 s_cmp_le_u32 s55, 32
 s_cbranch_scc1 L_wa_loop
 s_waitcnt vmcnt(0)
 s_branch L_done
L_wa_first:
 s_nop 1
 v_cvt_pk_bf16_f32 v104, v72, v73
 v_cvt_pk_bf16_f32 v105, v74, v75
 v_cvt_pk_bf16_f32 v106, v80, v81
 v_cvt_pk_bf16_f32 v107, v82, v83
 ds_write_b128 v5, v[104:107] offset:0
 v_cvt_pk_bf16_f32 v108, v76, v77
 v_cvt_pk_bf16_f32 v109, v78, v79
 v_cvt_pk_bf16_f32 v110, v84, v85
 v_cvt_pk_bf16_f32 v111, v86, v87
 ds_write_b128 v5, v[108:111] offset:1024
 s_waitcnt lgkmcnt(0)
 s_branch L_wa_next
L_wa_noqkv:
 s_lshl_b32 s60, s56, 13
 s_add_u32 s60, s60, s7
 s_lshl_b32 s49, s46, 11
 s_add_u32 s49, s49, 122880
 v_add_u32 v124, s49, v1
 v_add_u32 v8, 122880, v1
 s_and_b32 s48, s46, 1
 s_lshl_b32 s48, s48, 10
 v_subrev_u32 v126, s48, v6
 s_mov_b64 s[98:99], -1
 s_barrier
L_wa_mem1:
 s_mov_b32 s30, 0
L_wa_mem:
 buffer_load_dwordx4 v[116:119], v1, s[32:35], s60 offen offset:0 sc1
 buffer_load_dwordx4 v[120:123], v1, s[32:35], s60 offen offset:1024 sc1
 s_add_u32 s30, s30, 1
 s_cmp_gt_u32 s30, 524288
 s_cbranch_scc1 L_exit
 s_waitcnt vmcnt(0)
 v_max3_u32 v7, v116, v117, v118
 v_max3_u32 v7, v7, v119, v120
 v_max3_u32 v7, v7, v121, v122
 v_max_u32 v7, v7, v123
 v_cmp_eq_u32 vcc, -1, v7
 ds_write_b128 v124, v[116:119]
 ds_write_b128 v124, v[120:123] offset:1024
 s_cbranch_vccz L_wa_memok
 s_sleep 2
 s_branch L_wa_mem
L_wa_s3:
 s_waitcnt vmcnt(0)
 v_cmp_eq_u32 vcc, 0, v14
 s_cmp_ge_u32 s55, 31
 s_cbranch_scc1 L_wa_nos3
 s_cbranch_vccnz L_wa_nos3
 s_mov_b32 s92, 3
 ds_read_b128 v[40:43], v8 offset:0
 ds_read_b128 v[44:47], v8 offset:1024
 ds_read_b128 v[48:51], v8 offset:2048
 ds_read_b128 v[52:55], v8 offset:3072
 ds_read_b128 v[72:75], v7 offset:0
 ds_read_b128 v[76:79], v7 offset:1024
 s_lshl_b32 s57, s56, 15
 s_add_u32 s57, s57, s72
 s_add_u32 s57, s57, 0x1410000
 s_add_u32 s94, s72, s66
 s_mov_b32 m0, s94
 v_mfma_f32_16x16x32_bf16 v[16:19], v[104:107], v[100:103], v[16:19]
 buffer_load_dwordx4 v1, s[32:35], s57 offen offset:0 sc1 lds
 v_mfma_f32_16x16x32_bf16 v[20:23], v[108:111], v[100:103], v[20:23]
 buffer_load_dwordx4 v1, s[32:35], s57 offen offset:1024 sc1 lds
 s_waitcnt lgkmcnt(5)
 v_mfma_f32_16x16x32_bf16 v[80:83], v[40:43], v[88:91], 0
 s_waitcnt lgkmcnt(4)
 v_mfma_f32_16x16x32_bf16 v[80:83], v[44:47], v[92:95], v[80:83]
 buffer_load_dwordx4 v1, s[32:35], s57 offen offset:2048 sc1 lds
 s_waitcnt lgkmcnt(3)
 v_mfma_f32_16x16x32_bf16 v[80:83], v[48:51], v[96:99], v[80:83]
 s_waitcnt lgkmcnt(2)
 v_mfma_f32_16x16x32_bf16 v[80:83], v[52:55], v[100:103], v[80:83]
 buffer_load_dwordx4 v1, s[32:35], s57 offen offset:3072 sc1 lds
 v_cndmask_b32 v16, v11, v16, s[76:77]
 v_cndmask_b32 v17, v11, v17, s[78:79]
 v_cndmask_b32 v18, v11, v18, s[80:81]
 v_cndmask_b32 v19, v11, v19, s[82:83]
 v_cndmask_b32 v20, v11, v20, s[84:85]
 v_cndmask_b32 v21, v11, v21, s[86:87]
 v_cndmask_b32 v22, v11, v22, s[88:89]
 v_cndmask_b32 v23, v11, v23, s[90:91]
 s_add_u32 m0, s94, 4096
 s_add_u32 s57, s57, 4096
 buffer_load_dwordx4 v1, s[32:35], s57 offen offset:0 sc1 lds
 v_max3_f32 v84, v16, v17, v18
 v_max3_f32 v84, v84, v19, v20
 v_max3_f32 v84, v84, v21, v22
 v_max3_f32 v84, v84, v23, v80
 v_max3_f32 v84, v84, v81, v82
 v_max_f32 v84, v84, v83
 v_mov_b32 v85, v84
 buffer_load_dwordx4 v1, s[32:35], s57 offen offset:1024 sc1 lds
 s_nop 0
 v_permlane16_swap_b32 v84, v85
 v_max_f32 v84, v84, v85
 v_mov_b32 v85, v84
 buffer_load_dwordx4 v1, s[32:35], s57 offen offset:2048 sc1 lds
 s_nop 0
 v_permlane32_swap_b32 v84, v85
 v_max_f32 v84, v84, v85
 v_mul_f32 v84, s96, v84
 v_pk_fma_f32 v[16:17], v[16:17], s[96:97], v[84:85] op_sel_hi:[1,1,0] neg_lo:[0,0,1] neg_hi:[0,0,1]
 v_pk_fma_f32 v[18:19], v[18:19], s[96:97], v[84:85] op_sel_hi:[1,1,0] neg_lo:[0,0,1] neg_hi:[0,0,1]
 v_pk_fma_f32 v[20:21], v[20:21], s[96:97], v[84:85] op_sel_hi:[1,1,0] neg_lo:[0,0,1] neg_hi:[0,0,1]
 v_pk_fma_f32 v[22:23], v[22:23], s[96:97], v[84:85] op_sel_hi:[1,1,0] neg_lo:[0,0,1] neg_hi:[0,0,1]
 v_pk_fma_f32 v[80:81], v[80:81], s[96:97], v[84:85] op_sel_hi:[1,1,0] neg_lo:[0,0,1] neg_hi:[0,0,1]
 v_pk_fma_f32 v[82:83], v[82:83], s[96:97], v[84:85] op_sel_hi:[1,1,0] neg_lo:[0,0,1] neg_hi:[0,0,1]
 buffer_load_dwordx4 v1, s[32:35], s57 offen offset:3072 sc1 lds
 v_exp_f32 v16, v16
 v_exp_f32 v17, v17
 v_exp_f32 v18, v18
 v_exp_f32 v19, v19
 v_exp_f32 v20, v20
 v_exp_f32 v21, v21
 v_exp_f32 v22, v22
 v_exp_f32 v23, v23
 v_exp_f32 v80, v80
 v_exp_f32 v81, v81
 v_exp_f32 v82, v82
 v_exp_f32 v83, v83
 v_cvt_pk_bf16_f32 v24, v16, v17
 v_cvt_pk_bf16_f32 v25, v18, v19
 v_cvt_pk_bf16_f32 v26, v20, v21
 v_cvt_pk_bf16_f32 v27, v22, v23
 v_cvt_pk_bf16_f32 v28, v80, v81
 v_cvt_pk_bf16_f32 v29, v82, v83
 s_waitcnt lgkmcnt(0)
 v_mfma_f32_16x16x32_bf16 v[88:91], v[56:59], v[24:27], 0
 v_add_f32 v16, v16, v20
 v_add_f32 v17, v17, v21
 v_mfma_f32_16x16x32_bf16 v[92:95], v[60:63], v[24:27], 0
 v_add_f32 v18, v18, v22
 v_add_f32 v19, v19, v23
 v_mfma_f32_16x16x32_bf16 v[96:99], v[64:67], v[24:27], 0
 v_add_f32 v80, v80, v82
 v_add_f32 v81, v81, v83
 v_mfma_f32_16x16x32_bf16 v[100:103], v[68:71], v[24:27], 0
 v_add_f32 v16, v16, v18
 v_add_f32 v17, v17, v19
 v_mfma_f32_16x16x16_bf16 v[88:91], v[72:73], v[28:29], v[88:91]
 v_add_f32 v80, v80, v81
 v_add_f32 v16, v16, v17
 v_mfma_f32_16x16x16_bf16 v[92:95], v[74:75], v[28:29], v[92:95]
 v_fmac_f32 v16, 0.5, v80
 v_mov_b32 v17, v16
 v_mfma_f32_16x16x16_bf16 v[96:99], v[76:77], v[28:29], v[96:99]
 s_nop 0
 v_permlane16_swap_b32 v16, v17
 v_add_f32 v16, v16, v17
 v_mfma_f32_16x16x16_bf16 v[100:103], v[78:79], v[28:29], v[100:103]
 v_mov_b32 v17, v16
 s_nop 1
 v_permlane32_swap_b32 v16, v17
 v_add_f32 v16, v16, v17
 v_rcp_f32 v16, v16
 s_nop 0
 v_pk_mul_f32 v[88:89], v[88:89], v[16:17] op_sel_hi:[1,0]
 v_pk_mul_f32 v[90:91], v[90:91], v[16:17] op_sel_hi:[1,0]
 v_pk_mul_f32 v[92:93], v[92:93], v[16:17] op_sel_hi:[1,0]
 v_pk_mul_f32 v[94:95], v[94:95], v[16:17] op_sel_hi:[1,0]
 v_cvt_pk_bf16_f32 v104, v88, v89
 v_cvt_pk_bf16_f32 v105, v90, v91
 v_cvt_pk_bf16_f32 v106, v92, v93
 v_cvt_pk_bf16_f32 v107, v94, v95
 buffer_store_dwordx4 v[104:107], v1, s[32:35], s61 offen offset:0 sc1
 v_pk_mul_f32 v[96:97], v[96:97], v[16:17] op_sel_hi:[1,0]
 v_pk_mul_f32 v[98:99], v[98:99], v[16:17] op_sel_hi:[1,0]
 v_pk_mul_f32 v[100:101], v[100:101], v[16:17] op_sel_hi:[1,0]
 v_pk_mul_f32 v[102:103], v[102:103], v[16:17] op_sel_hi:[1,0]
 v_cvt_pk_bf16_f32 v108, v96, v97
 v_cvt_pk_bf16_f32 v109, v98, v99
 v_cvt_pk_bf16_f32 v110, v100, v101
 v_cvt_pk_bf16_f32 v111, v102, v103
 buffer_store_dwordx4 v[108:111], v1, s[32:35], s61 offen offset:2048 sc1
 s_branch L_wa_attd
L_wo:
 s_cmp_eq_u32 s47, 0
 s_cbranch_scc1 L_ln0_done
 v_and_b32 v0, 63, v0
 v_mov_b32 v5, 1
 s_lshl_b32 s62, s45, 2
 s_add_u32 s62, s62, s46
 s_and_b32 s61, s62, 7
 s_lshr_b32 s62, s62, 3
 s_and_b32 s48, s61, 1
 s_lshr_b32 s49, s61, 1
 s_lshl_b32 s49, s49, 2
 v_and_b32 v96, 3, v0
 v_add_u32 v96, s49, v96
 v_lshrrev_b32 v97, 2, v0
 s_lshl_b32 s49, s48, 8
 v_lshl_add_u32 v98, v96, 4, s49
 s_lshl_b32 s49, s48, 10
 v_lshl_add_u32 v99, v96, 11, s49
 s_lshl_b32 s49, s48, 9
 s_lshr_b32 s50, s61, 1
 s_lshl_b32 s50, s50, 7
 s_add_u32 s49, s49, s50
 v_and_b32 v102, 7, v0
 v_lshl_add_u32 v102, v102, 4, s49
 s_lshl_b32 s49, s48, 10
 v_lshl_add_u32 v12, v96, 4, s49
 v_lshl_add_u32 v12, v97, 11, v12
 v_lshrrev_b32 v100, 1, v97
 v_and_b32_e64 v101, 1, v97
 v_lshl_add_u32 v100, v100, 3, v101
 v_lshl_add_u32 v8, v100, 4, v99
 s_mov_b32 s40, s4
 s_mov_b32 s41, s5
 s_mov_b32 s42, 0x200000
 s_mov_b32 s43, 0x20000
 s_lshl_b32 s48, s62, 15
 buffer_load_dwordx4 v[144:147], v8, s[40:43], s48 offen offset:0
 buffer_load_dwordx4 v[148:151], v8, s[40:43], s48 offen offset:32
 buffer_load_dwordx4 v[152:155], v8, s[40:43], s48 offen offset:64
 buffer_load_dwordx4 v[156:159], v8, s[40:43], s48 offen offset:96
 s_add_u32 s48, s48, 524288
 buffer_load_dwordx4 v[160:163], v8, s[40:43], s48 offen offset:0
 buffer_load_dwordx4 v[164:167], v8, s[40:43], s48 offen offset:32
 buffer_load_dwordx4 v[168:171], v8, s[40:43], s48 offen offset:64
 buffer_load_dwordx4 v[172:175], v8, s[40:43], s48 offen offset:96
 s_add_u32 s48, s48, 524288
 buffer_load_dwordx4 v[176:179], v8, s[40:43], s48 offen offset:0
 buffer_load_dwordx4 v[180:183], v8, s[40:43], s48 offen offset:32
 buffer_load_dwordx4 v[184:187], v8, s[40:43], s48 offen offset:64
 buffer_load_dwordx4 v[188:191], v8, s[40:43], s48 offen offset:96
 s_add_u32 s48, s48, 524288
 buffer_load_dwordx4 v[192:195], v8, s[40:43], s48 offen offset:0
 buffer_load_dwordx4 v[196:199], v8, s[40:43], s48 offen offset:32
 buffer_load_dwordx4 v[200:203], v8, s[40:43], s48 offen offset:64
 buffer_load_dwordx4 v[204:207], v8, s[40:43], s48 offen offset:96
 s_lshl_b32 s59, s62, 15
 s_add_u32 s59, s59, 0x1400000
 s_lshl_b32 s57, s62, 11
 s_lshl_b32 s48, s61, 2
 s_add_u32 s57, s57, s48
 s_mov_b32 s62, 0
 s_waitcnt vmcnt(0)
 v_lshrrev_b32 v100, 1, v97
 v_lshl_add_u32 v8, v100, 12, v102
L_ln0_loop:
 s_sub_u32 s48, s59, 0x400000
 buffer_store_dwordx4 v[144:147], v8, s[32:35], s48 offen offset:0 sc1
 buffer_store_dwordx4 v[148:151], v8, s[32:35], s48 offen offset:1024 sc1
 buffer_store_dwordx4 v[152:155], v8, s[32:35], s48 offen offset:2048 sc1
 buffer_store_dwordx4 v[156:159], v8, s[32:35], s48 offen offset:3072 sc1
 v_lshlrev_b32 v16, 16, v144
 v_and_b32 v17, 0xffff0000, v144
 v_lshlrev_b32 v18, 16, v145
 v_and_b32 v19, 0xffff0000, v145
 v_lshlrev_b32 v20, 16, v146
 v_and_b32 v21, 0xffff0000, v146
 v_lshlrev_b32 v22, 16, v147
 v_and_b32 v23, 0xffff0000, v147
 v_lshlrev_b32 v24, 16, v148
 v_and_b32 v25, 0xffff0000, v148
 v_lshlrev_b32 v26, 16, v149
 v_and_b32 v27, 0xffff0000, v149
 v_lshlrev_b32 v28, 16, v150
 v_and_b32 v29, 0xffff0000, v150
 v_lshlrev_b32 v30, 16, v151
 v_and_b32 v31, 0xffff0000, v151
 v_lshlrev_b32 v32, 16, v152
 v_and_b32 v33, 0xffff0000, v152
 v_lshlrev_b32 v34, 16, v153
 v_and_b32 v35, 0xffff0000, v153
 v_lshlrev_b32 v36, 16, v154
 v_and_b32 v37, 0xffff0000, v154
 v_lshlrev_b32 v38, 16, v155
 v_and_b32 v39, 0xffff0000, v155
 v_lshlrev_b32 v40, 16, v156
 v_and_b32 v41, 0xffff0000, v156
 v_lshlrev_b32 v42, 16, v157
 v_and_b32 v43, 0xffff0000, v157
 v_lshlrev_b32 v44, 16, v158
 v_and_b32 v45, 0xffff0000, v158
 v_lshlrev_b32 v46, 16, v159
 v_and_b32 v47, 0xffff0000, v159
 v_pk_add_f32 v[48:49], v[16:17], v[18:19]
 v_pk_mul_f32 v[52:53], v[16:17], v[16:17]
 v_pk_fma_f32 v[52:53], v[18:19], v[18:19], v[52:53]
 v_pk_add_f32 v[48:49], v[48:49], v[20:21]
 v_pk_fma_f32 v[52:53], v[20:21], v[20:21], v[52:53]
 v_pk_add_f32 v[48:49], v[48:49], v[22:23]
 v_pk_fma_f32 v[52:53], v[22:23], v[22:23], v[52:53]
 v_pk_add_f32 v[48:49], v[48:49], v[24:25]
 v_pk_fma_f32 v[52:53], v[24:25], v[24:25], v[52:53]
 v_pk_add_f32 v[48:49], v[48:49], v[26:27]
 v_pk_fma_f32 v[52:53], v[26:27], v[26:27], v[52:53]
 v_pk_add_f32 v[48:49], v[48:49], v[28:29]
 v_pk_fma_f32 v[52:53], v[28:29], v[28:29], v[52:53]
 v_pk_add_f32 v[48:49], v[48:49], v[30:31]
 v_pk_fma_f32 v[52:53], v[30:31], v[30:31], v[52:53]
 v_pk_add_f32 v[48:49], v[48:49], v[32:33]
 v_pk_fma_f32 v[52:53], v[32:33], v[32:33], v[52:53]
 v_pk_add_f32 v[48:49], v[48:49], v[34:35]
 v_pk_fma_f32 v[52:53], v[34:35], v[34:35], v[52:53]
 v_pk_add_f32 v[48:49], v[48:49], v[36:37]
 v_pk_fma_f32 v[52:53], v[36:37], v[36:37], v[52:53]
 v_pk_add_f32 v[48:49], v[48:49], v[38:39]
 v_pk_fma_f32 v[52:53], v[38:39], v[38:39], v[52:53]
 v_pk_add_f32 v[48:49], v[48:49], v[40:41]
 v_pk_fma_f32 v[52:53], v[40:41], v[40:41], v[52:53]
 v_pk_add_f32 v[48:49], v[48:49], v[42:43]
 v_pk_fma_f32 v[52:53], v[42:43], v[42:43], v[52:53]
 v_pk_add_f32 v[48:49], v[48:49], v[44:45]
 v_pk_fma_f32 v[52:53], v[44:45], v[44:45], v[52:53]
 v_pk_add_f32 v[48:49], v[48:49], v[46:47]
 v_pk_fma_f32 v[52:53], v[46:47], v[46:47], v[52:53]
 v_add_f32 v48, v48, v49
 v_add_f32 v52, v52, v53
 v_nop_e64
 v_add_f32_dpp v48, v48, v48 row_ror:4 row_mask:0xf bank_mask:0xf
 v_add_f32_dpp v52, v52, v52 row_ror:4 row_mask:0xf bank_mask:0xf
 v_nop_e64
 v_add_f32_dpp v48, v48, v48 row_ror:8 row_mask:0xf bank_mask:0xf
 v_add_f32_dpp v52, v52, v52 row_ror:8 row_mask:0xf bank_mask:0xf
 v_mov_b32 v50, v48
 v_mov_b32 v54, v52
 s_nop 0
 v_permlane16_swap_b32 v48, v50
 v_permlane16_swap_b32 v52, v54
 v_add_f32 v48, v48, v50
 v_add_f32 v52, v52, v54
 v_mov_b32 v50, v48
 v_mov_b32 v54, v52
 s_nop 0
 v_permlane32_swap_b32 v48, v50
 v_permlane32_swap_b32 v52, v54
 v_add_f32 v48, v48, v50
 v_add_f32 v52, v52, v54
 v_mul_f32 v48, 0x3b000000, v48
 v_mul_f32 v52, 0x3b000000, v52
 v_fma_f32 v52, -v48, v48, v52
 v_max_f32_e64 v52, 0, v52
 v_cvt_pk_bf16_f32 v48, v48, v48
 v_and_b32 v48, 0xffff0000, v48
 v_cvt_pk_bf16_f32 v52, v52, v52
 v_and_b32 v52, 0xffff0000, v52
 v_add_f32 v52, 0x3727c5ac, v52
 v_cvt_pk_bf16_f32 v52, v52, v52
 v_and_b32 v52, 0xffff0000, v52
 v_sqrt_f32 v52, v52
 s_nop 0
 v_cvt_pk_bf16_f32 v52, v52, v52
 v_and_b32 v52, 0xffff0000, v52
 v_rcp_f32 v52, v52
 s_nop 0
 v_mul_f32_e64 v48, v48, v52
 v_pk_fma_f32 v[16:17], v[16:17], v[52:53], v[48:49] op_sel_hi:[1,0,0] neg_lo:[0,0,1] neg_hi:[0,0,1]
 v_pk_fma_f32 v[18:19], v[18:19], v[52:53], v[48:49] op_sel_hi:[1,0,0] neg_lo:[0,0,1] neg_hi:[0,0,1]
 v_pk_fma_f32 v[20:21], v[20:21], v[52:53], v[48:49] op_sel_hi:[1,0,0] neg_lo:[0,0,1] neg_hi:[0,0,1]
 v_pk_fma_f32 v[22:23], v[22:23], v[52:53], v[48:49] op_sel_hi:[1,0,0] neg_lo:[0,0,1] neg_hi:[0,0,1]
 v_pk_fma_f32 v[24:25], v[24:25], v[52:53], v[48:49] op_sel_hi:[1,0,0] neg_lo:[0,0,1] neg_hi:[0,0,1]
 v_pk_fma_f32 v[26:27], v[26:27], v[52:53], v[48:49] op_sel_hi:[1,0,0] neg_lo:[0,0,1] neg_hi:[0,0,1]
 v_pk_fma_f32 v[28:29], v[28:29], v[52:53], v[48:49] op_sel_hi:[1,0,0] neg_lo:[0,0,1] neg_hi:[0,0,1]
 v_pk_fma_f32 v[30:31], v[30:31], v[52:53], v[48:49] op_sel_hi:[1,0,0] neg_lo:[0,0,1] neg_hi:[0,0,1]
 v_pk_fma_f32 v[32:33], v[32:33], v[52:53], v[48:49] op_sel_hi:[1,0,0] neg_lo:[0,0,1] neg_hi:[0,0,1]
 v_pk_fma_f32 v[34:35], v[34:35], v[52:53], v[48:49] op_sel_hi:[1,0,0] neg_lo:[0,0,1] neg_hi:[0,0,1]
 v_pk_fma_f32 v[36:37], v[36:37], v[52:53], v[48:49] op_sel_hi:[1,0,0] neg_lo:[0,0,1] neg_hi:[0,0,1]
 v_pk_fma_f32 v[38:39], v[38:39], v[52:53], v[48:49] op_sel_hi:[1,0,0] neg_lo:[0,0,1] neg_hi:[0,0,1]
 v_pk_fma_f32 v[40:41], v[40:41], v[52:53], v[48:49] op_sel_hi:[1,0,0] neg_lo:[0,0,1] neg_hi:[0,0,1]
 v_pk_fma_f32 v[42:43], v[42:43], v[52:53], v[48:49] op_sel_hi:[1,0,0] neg_lo:[0,0,1] neg_hi:[0,0,1]
 v_pk_fma_f32 v[44:45], v[44:45], v[52:53], v[48:49] op_sel_hi:[1,0,0] neg_lo:[0,0,1] neg_hi:[0,0,1]
 v_pk_fma_f32 v[46:47], v[46:47], v[52:53], v[48:49] op_sel_hi:[1,0,0] neg_lo:[0,0,1] neg_hi:[0,0,1]
 v_cvt_pk_bf16_f32 v128, v16, v32
 v_cvt_pk_bf16_f32 v129, v24, v40
 v_cvt_pk_bf16_f32 v130, v17, v33
 v_cvt_pk_bf16_f32 v131, v25, v41
 buffer_store_dwordx4 v[128:131], v12, s[32:35], s59 offen offset:0 sc1
 v_cvt_pk_bf16_f32 v132, v18, v34
 v_cvt_pk_bf16_f32 v133, v26, v42
 v_cvt_pk_bf16_f32 v134, v19, v35
 v_cvt_pk_bf16_f32 v135, v27, v43
 buffer_store_dwordx4 v[132:135], v12, s[32:35], s59 offen offset:256 sc1
 v_cvt_pk_bf16_f32 v136, v20, v36
 v_cvt_pk_bf16_f32 v137, v28, v44
 v_cvt_pk_bf16_f32 v138, v21, v37
 v_cvt_pk_bf16_f32 v139, v29, v45
 buffer_store_dwordx4 v[136:139], v12, s[32:35], s59 offen offset:512 sc1
 v_cvt_pk_bf16_f32 v140, v22, v38
 v_cvt_pk_bf16_f32 v141, v30, v46
 v_cvt_pk_bf16_f32 v142, v23, v39
 v_cvt_pk_bf16_f32 v143, v31, v47
 buffer_store_dwordx4 v[140:143], v12, s[32:35], s59 offen offset:768 sc1
 v_mov_b64 v[144:145], v[160:161]
 v_mov_b64 v[146:147], v[162:163]
 v_mov_b64 v[148:149], v[164:165]
 v_mov_b64 v[150:151], v[166:167]
 v_mov_b64 v[152:153], v[168:169]
 v_mov_b64 v[154:155], v[170:171]
 v_mov_b64 v[156:157], v[172:173]
 v_mov_b64 v[158:159], v[174:175]
 v_mov_b64 v[160:161], v[176:177]
 v_mov_b64 v[162:163], v[178:179]
 v_mov_b64 v[164:165], v[180:181]
 v_mov_b64 v[166:167], v[182:183]
 v_mov_b64 v[168:169], v[184:185]
 v_mov_b64 v[170:171], v[186:187]
 v_mov_b64 v[172:173], v[188:189]
 v_mov_b64 v[174:175], v[190:191]
 v_mov_b64 v[176:177], v[192:193]
 v_mov_b64 v[178:179], v[194:195]
 v_mov_b64 v[180:181], v[196:197]
 v_mov_b64 v[182:183], v[198:199]
 v_mov_b64 v[184:185], v[200:201]
 v_mov_b64 v[186:187], v[202:203]
 v_mov_b64 v[188:189], v[204:205]
 v_mov_b64 v[190:191], v[206:207]
 s_cmp_lg_u32 s62, 0
 s_cbranch_scc1 L_l0g_123
 s_mov_b32 s30, 0
L_winit_124:
 v_mov_b32 v124, 0
 global_load_dword v125, v124, s[26:27] offset:192 sc1
L_wchk_126:
 s_add_u32 s30, s30, 1
 s_cmp_gt_u32 s30, 524288
 s_cbranch_scc1 L_exit
 s_waitcnt vmcnt(0)
 v_readfirstlane_b32 s54, v125
 s_nop 0
 s_cmp_lg_u32 s54, 0
 s_cbranch_scc1 L_wdone_125
 s_sleep 8
 s_branch L_winit_124
L_wdone_125:
 s_lshr_b32 s3, s54, s44
 s_and_b32 s3, s3, 1
L_l0g_123:
 s_waitcnt vmcnt(0)
 s_mov_b64 exec, 1
 buffer_store_dword v5, off, s[32:35], s57 offset:0 sc1
 s_mov_b64 exec, -1
 s_add_u32 s59, s59, 524288
 s_add_u32 s57, s57, 32768
 s_add_u32 s62, s62, 1
 s_cmp_lt_u32 s62, 4
 s_cbranch_scc1 L_ln0_loop
L_ln0_done:
 s_cmp_lt_u32 s45, 16
 s_cbranch_scc1 L_ra
 s_cmp_lt_u32 s45, 24
 s_cbranch_scc1 L_rc
 s_cmp_lt_u32 s45, 28
 s_cbranch_scc1 L_rd
 s_branch L_rows
L_ra:
 v_and_b32 v0, 63, v0
 v_lshlrev_b32 v1, 4, v0
 s_lshl_b32 s66, s46, 15
 v_mov_b32 v5, 1
 s_lshl_b32 s55, s47, 6
 s_add_u32 s56, s55, 64
 s_mov_b32 s92, 0
 s_mov_b32 s75, 0
 s_lshl_b32 s94, s47, 21
 s_add_u32 s94, s94, 0x2000000
 s_lshr_b32 s61, s45, 2
 s_and_b32 s62, s45, 3
 v_lshrrev_b32 v96, 2, v0
 v_mul_u32_u24 v96, 1024, v96
 v_and_b32 v2, 3, v0
 v_lshl_add_u32 v96, v2, 4, v96
 v_lshrrev_b32 v2, 5, v0
 v_mul_u32_u24 v97, 256, v2
 v_bfe_u32 v2, v0, 2, 2
 v_lshl_add_u32 v97, v2, 6, v97
 v_bfe_u32 v2, v0, 4, 1
 v_lshl_add_u32 v97, v2, 5, v97
 v_and_b32_e64 v2, 1, v0
 v_lshl_add_u32 v97, v2, 4, v97
 v_bfe_u32 v2, v0, 1, 1
 v_lshl_add_u32 v97, v2, 3, v97
 v_add_u32 v97, s66, v97
 s_lshl_b32 s50, s61, 20
 s_lshl_b32 s49, s62, 8
 s_add_u32 s50, s50, s49
 s_lshl_b32 s49, s46, 6
 s_add_u32 s50, s50, s49
 s_mov_b32 s36, s14
 s_mov_b32 s37, s15
 s_mov_b32 s38, 0x400000
 s_mov_b32 s39, 0x20000
 s_lshr_b32 s54, 166, s44
 s_and_b32 s54, s54, 1
 s_cbranch_scc0 L_nolate_127
 s_cmp_lg_u32 s46, 0
 s_cbranch_scc1 L_lated_129
 s_mov_b32 s30, 0
L_winit_130:
 v_mov_b32 v124, 0
 global_load_dword v125, v124, s[26:27] offset:192 sc1
L_wchk_132:
 s_add_u32 s30, s30, 1
 s_cmp_gt_u32 s30, 524288
 s_cbranch_scc1 L_exit
 s_waitcnt vmcnt(0)
 v_readfirstlane_b32 s54, v125
 s_nop 0
 s_cmp_lg_u32 s54, 0
 s_cbranch_scc1 L_wdone_131
 s_sleep 8
 s_branch L_winit_130
L_wdone_131:
 s_lshr_b32 s3, s54, s44
 s_and_b32 s3, s3, 1
 s_lshl_b32 s52, s44, 11
 s_mov_b32 s30, 0
L_late_128:
 buffer_load_dword v125, off, s[32:35], s52 offset:1792 sc1
 s_add_u32 s30, s30, 1
 s_waitcnt vmcnt(0)
 s_cmp_gt_u32 s30, 200
 s_cbranch_scc1 L_lated_129
 v_readfirstlane_b32 s54, v125
 s_nop 0
 s_cmp_ge_u32 s54, 1
 s_cbranch_scc1 L_lated_129
 s_sleep 8
 s_branch L_late_128
L_lated_129:
 s_barrier
L_nolate_127:
 s_add_u32 s48, s50, 0
 s_add_u32 m0, s66, 0
 s_nop 0
 buffer_load_dwordx4 v96, s[36:39], s48 offen offset:0 lds
 s_add_u32 s48, s48, 15360
 buffer_load_dwordx4 v96, s[36:39], s48 offen offset:1024 lds
 s_add_u32 s48, s48, 15360
 buffer_load_dwordx4 v96, s[36:39], s48 offen offset:2048 lds
 s_add_u32 s48, s48, 15360
 buffer_load_dwordx4 v96, s[36:39], s48 offen offset:3072 lds
 s_add_u32 s48, s50, 65536
 s_add_u32 m0, s66, 4096
 s_nop 0
 buffer_load_dwordx4 v96, s[36:39], s48 offen offset:0 lds
 s_add_u32 s48, s48, 15360
 buffer_load_dwordx4 v96, s[36:39], s48 offen offset:1024 lds
 s_add_u32 s48, s48, 15360
 buffer_load_dwordx4 v96, s[36:39], s48 offen offset:2048 lds
 s_add_u32 s48, s48, 15360
 buffer_load_dwordx4 v96, s[36:39], s48 offen offset:3072 lds
 s_add_u32 s48, s50, 131072
 s_add_u32 m0, s66, 8192
 s_nop 0
 buffer_load_dwordx4 v96, s[36:39], s48 offen offset:0 lds
 s_add_u32 s48, s48, 15360
 buffer_load_dwordx4 v96, s[36:39], s48 offen offset:1024 lds
 s_add_u32 s48, s48, 15360
 buffer_load_dwordx4 v96, s[36:39], s48 offen offset:2048 lds
 s_add_u32 s48, s48, 15360
 buffer_load_dwordx4 v96, s[36:39], s48 offen offset:3072 lds
 s_add_u32 s48, s50, 196608
 s_add_u32 m0, s66, 12288
 s_nop 0
 buffer_load_dwordx4 v96, s[36:39], s48 offen offset:0 lds
 s_add_u32 s48, s48, 15360
 buffer_load_dwordx4 v96, s[36:39], s48 offen offset:1024 lds
 s_add_u32 s48, s48, 15360
 buffer_load_dwordx4 v96, s[36:39], s48 offen offset:2048 lds
 s_add_u32 s48, s48, 15360
 buffer_load_dwordx4 v96, s[36:39], s48 offen offset:3072 lds
 s_add_u32 s48, s50, 262144
 s_add_u32 m0, s66, 16384
 s_nop 0
 buffer_load_dwordx4 v96, s[36:39], s48 offen offset:0 lds
 s_add_u32 s48, s48, 15360
 buffer_load_dwordx4 v96, s[36:39], s48 offen offset:1024 lds
 s_add_u32 s48, s48, 15360
 buffer_load_dwordx4 v96, s[36:39], s48 offen offset:2048 lds
 s_add_u32 s48, s48, 15360
 buffer_load_dwordx4 v96, s[36:39], s48 offen offset:3072 lds
 s_add_u32 s48, s50, 327680
 s_add_u32 m0, s66, 20480
 s_nop 0
 buffer_load_dwordx4 v96, s[36:39], s48 offen offset:0 lds
 s_add_u32 s48, s48, 15360
 buffer_load_dwordx4 v96, s[36:39], s48 offen offset:1024 lds
 s_add_u32 s48, s48, 15360
 buffer_load_dwordx4 v96, s[36:39], s48 offen offset:2048 lds
 s_add_u32 s48, s48, 15360
 buffer_load_dwordx4 v96, s[36:39], s48 offen offset:3072 lds
 s_add_u32 s48, s50, 393216
 s_add_u32 m0, s66, 24576
 s_nop 0
 buffer_load_dwordx4 v96, s[36:39], s48 offen offset:0 lds
 s_add_u32 s48, s48, 15360
 buffer_load_dwordx4 v96, s[36:39], s48 offen offset:1024 lds
 s_add_u32 s48, s48, 15360
 buffer_load_dwordx4 v96, s[36:39], s48 offen offset:2048 lds
 s_add_u32 s48, s48, 15360
 buffer_load_dwordx4 v96, s[36:39], s48 offen offset:3072 lds
 s_add_u32 s48, s50, 458752
 s_add_u32 m0, s66, 28672
 s_nop 0
 buffer_load_dwordx4 v96, s[36:39], s48 offen offset:0 lds
 s_add_u32 s48, s48, 15360
 buffer_load_dwordx4 v96, s[36:39], s48 offen offset:1024 lds
 s_add_u32 s48, s48, 15360
 buffer_load_dwordx4 v96, s[36:39], s48 offen offset:2048 lds
 s_add_u32 s48, s48, 15360
 buffer_load_dwordx4 v96, s[36:39], s48 offen offset:3072 lds
 s_waitcnt vmcnt(28)
 ds_read_b64_tr_b16 a[0:1], v97 offset:0
 ds_read_b64_tr_b16 a[2:3], v97 offset:1024
 ds_read_b64_tr_b16 a[4:5], v97 offset:512
 ds_read_b64_tr_b16 a[6:7], v97 offset:1536
 ds_read_b64_tr_b16 a[8:9], v97 offset:2048
 ds_read_b64_tr_b16 a[10:11], v97 offset:3072
 ds_read_b64_tr_b16 a[12:13], v97 offset:2560
 ds_read_b64_tr_b16 a[14:15], v97 offset:3584
 s_waitcnt lgkmcnt(0)
 s_add_u32 s48, s50, 524288
 s_add_u32 m0, s66, 0
 s_nop 0
 buffer_load_dwordx4 v96, s[36:39], s48 offen offset:0 lds
 s_add_u32 s48, s48, 15360
 buffer_load_dwordx4 v96, s[36:39], s48 offen offset:1024 lds
 s_add_u32 s48, s48, 15360
 buffer_load_dwordx4 v96, s[36:39], s48 offen offset:2048 lds
 s_add_u32 s48, s48, 15360
 buffer_load_dwordx4 v96, s[36:39], s48 offen offset:3072 lds
 s_waitcnt vmcnt(28)
 ds_read_b64_tr_b16 a[16:17], v97 offset:4096
 ds_read_b64_tr_b16 a[18:19], v97 offset:5120
 ds_read_b64_tr_b16 a[20:21], v97 offset:4608
 ds_read_b64_tr_b16 a[22:23], v97 offset:5632
 ds_read_b64_tr_b16 a[24:25], v97 offset:6144
 ds_read_b64_tr_b16 a[26:27], v97 offset:7168
 ds_read_b64_tr_b16 a[28:29], v97 offset:6656
 ds_read_b64_tr_b16 a[30:31], v97 offset:7680
 s_waitcnt lgkmcnt(0)
 s_add_u32 s48, s50, 589824
 s_add_u32 m0, s66, 4096
 s_nop 0
 buffer_load_dwordx4 v96, s[36:39], s48 offen offset:0 lds
 s_add_u32 s48, s48, 15360
 buffer_load_dwordx4 v96, s[36:39], s48 offen offset:1024 lds
 s_add_u32 s48, s48, 15360
 buffer_load_dwordx4 v96, s[36:39], s48 offen offset:2048 lds
 s_add_u32 s48, s48, 15360
 buffer_load_dwordx4 v96, s[36:39], s48 offen offset:3072 lds
 s_waitcnt vmcnt(28)
 ds_read_b64_tr_b16 a[32:33], v97 offset:8192
 ds_read_b64_tr_b16 a[34:35], v97 offset:9216
 ds_read_b64_tr_b16 a[36:37], v97 offset:8704
 ds_read_b64_tr_b16 a[38:39], v97 offset:9728
 ds_read_b64_tr_b16 a[40:41], v97 offset:10240
 ds_read_b64_tr_b16 a[42:43], v97 offset:11264
 ds_read_b64_tr_b16 a[44:45], v97 offset:10752
 ds_read_b64_tr_b16 a[46:47], v97 offset:11776
 s_waitcnt lgkmcnt(0)
 s_add_u32 s48, s50, 655360
 s_add_u32 m0, s66, 8192
 s_nop 0
 buffer_load_dwordx4 v96, s[36:39], s48 offen offset:0 lds
 s_add_u32 s48, s48, 15360
 buffer_load_dwordx4 v96, s[36:39], s48 offen offset:1024 lds
 s_add_u32 s48, s48, 15360
 buffer_load_dwordx4 v96, s[36:39], s48 offen offset:2048 lds
 s_add_u32 s48, s48, 15360
 buffer_load_dwordx4 v96, s[36:39], s48 offen offset:3072 lds
 s_waitcnt vmcnt(28)
 ds_read_b64_tr_b16 a[48:49], v97 offset:12288
 ds_read_b64_tr_b16 a[50:51], v97 offset:13312
 ds_read_b64_tr_b16 a[52:53], v97 offset:12800
 ds_read_b64_tr_b16 a[54:55], v97 offset:13824
 ds_read_b64_tr_b16 a[56:57], v97 offset:14336
 ds_read_b64_tr_b16 a[58:59], v97 offset:15360
 ds_read_b64_tr_b16 a[60:61], v97 offset:14848
 ds_read_b64_tr_b16 a[62:63], v97 offset:15872
 s_waitcnt lgkmcnt(0)
 s_add_u32 s48, s50, 720896
 s_add_u32 m0, s66, 12288
 s_nop 0
 buffer_load_dwordx4 v96, s[36:39], s48 offen offset:0 lds
 s_add_u32 s48, s48, 15360
 buffer_load_dwordx4 v96, s[36:39], s48 offen offset:1024 lds
 s_add_u32 s48, s48, 15360
 buffer_load_dwordx4 v96, s[36:39], s48 offen offset:2048 lds
 s_add_u32 s48, s48, 15360
 buffer_load_dwordx4 v96, s[36:39], s48 offen offset:3072 lds
 s_waitcnt vmcnt(28)
 ds_read_b64_tr_b16 a[64:65], v97 offset:16384
 ds_read_b64_tr_b16 a[66:67], v97 offset:17408
 ds_read_b64_tr_b16 a[68:69], v97 offset:16896
 ds_read_b64_tr_b16 a[70:71], v97 offset:17920
 ds_read_b64_tr_b16 a[72:73], v97 offset:18432
 ds_read_b64_tr_b16 a[74:75], v97 offset:19456
 ds_read_b64_tr_b16 a[76:77], v97 offset:18944
 ds_read_b64_tr_b16 a[78:79], v97 offset:19968
 s_waitcnt lgkmcnt(0)
 s_add_u32 s48, s50, 786432
 s_add_u32 m0, s66, 16384
 s_nop 0
 buffer_load_dwordx4 v96, s[36:39], s48 offen offset:0 lds
 s_add_u32 s48, s48, 15360
 buffer_load_dwordx4 v96, s[36:39], s48 offen offset:1024 lds
 s_add_u32 s48, s48, 15360
 buffer_load_dwordx4 v96, s[36:39], s48 offen offset:2048 lds
 s_add_u32 s48, s48, 15360
 buffer_load_dwordx4 v96, s[36:39], s48 offen offset:3072 lds
 s_waitcnt vmcnt(28)
 ds_read_b64_tr_b16 a[80:81], v97 offset:20480
 ds_read_b64_tr_b16 a[82:83], v97 offset:21504
 ds_read_b64_tr_b16 a[84:85], v97 offset:20992
 ds_read_b64_tr_b16 a[86:87], v97 offset:22016
 ds_read_b64_tr_b16 a[88:89], v97 offset:22528
 ds_read_b64_tr_b16 a[90:91], v97 offset:23552
 ds_read_b64_tr_b16 a[92:93], v97 offset:23040
 ds_read_b64_tr_b16 a[94:95], v97 offset:24064
 s_waitcnt lgkmcnt(0)
 s_add_u32 s48, s50, 851968
 s_add_u32 m0, s66, 20480
 s_nop 0
 buffer_load_dwordx4 v96, s[36:39], s48 offen offset:0 lds
 s_add_u32 s48, s48, 15360
 buffer_load_dwordx4 v96, s[36:39], s48 offen offset:1024 lds
 s_add_u32 s48, s48, 15360
 buffer_load_dwordx4 v96, s[36:39], s48 offen offset:2048 lds
 s_add_u32 s48, s48, 15360
 buffer_load_dwordx4 v96, s[36:39], s48 offen offset:3072 lds
 s_waitcnt vmcnt(28)
 ds_read_b64_tr_b16 a[96:97], v97 offset:24576
 ds_read_b64_tr_b16 a[98:99], v97 offset:25600
 ds_read_b64_tr_b16 a[100:101], v97 offset:25088
 ds_read_b64_tr_b16 a[102:103], v97 offset:26112
 ds_read_b64_tr_b16 a[104:105], v97 offset:26624
 ds_read_b64_tr_b16 a[106:107], v97 offset:27648
 ds_read_b64_tr_b16 a[108:109], v97 offset:27136
 ds_read_b64_tr_b16 a[110:111], v97 offset:28160
 s_waitcnt lgkmcnt(0)
 s_add_u32 s48, s50, 917504
 s_add_u32 m0, s66, 24576
 s_nop 0
 buffer_load_dwordx4 v96, s[36:39], s48 offen offset:0 lds
 s_add_u32 s48, s48, 15360
 buffer_load_dwordx4 v96, s[36:39], s48 offen offset:1024 lds
 s_add_u32 s48, s48, 15360
 buffer_load_dwordx4 v96, s[36:39], s48 offen offset:2048 lds
 s_add_u32 s48, s48, 15360
 buffer_load_dwordx4 v96, s[36:39], s48 offen offset:3072 lds
 s_waitcnt vmcnt(28)
 ds_read_b64_tr_b16 a[112:113], v97 offset:28672
 ds_read_b64_tr_b16 a[114:115], v97 offset:29696
 ds_read_b64_tr_b16 a[116:117], v97 offset:29184
 ds_read_b64_tr_b16 a[118:119], v97 offset:30208
 ds_read_b64_tr_b16 a[120:121], v97 offset:30720
 ds_read_b64_tr_b16 a[122:123], v97 offset:31744
 ds_read_b64_tr_b16 a[124:125], v97 offset:31232
 ds_read_b64_tr_b16 a[126:127], v97 offset:32256
 s_waitcnt lgkmcnt(0)
 s_add_u32 s48, s50, 983040
 s_add_u32 m0, s66, 28672
 s_nop 0
 buffer_load_dwordx4 v96, s[36:39], s48 offen offset:0 lds
 s_add_u32 s48, s48, 15360
 buffer_load_dwordx4 v96, s[36:39], s48 offen offset:1024 lds
 s_add_u32 s48, s48, 15360
 buffer_load_dwordx4 v96, s[36:39], s48 offen offset:2048 lds
 s_add_u32 s48, s48, 15360
 buffer_load_dwordx4 v96, s[36:39], s48 offen offset:3072 lds
 s_waitcnt vmcnt(28)
 ds_read_b64_tr_b16 a[128:129], v97 offset:0
 ds_read_b64_tr_b16 a[130:131], v97 offset:1024
 ds_read_b64_tr_b16 a[132:133], v97 offset:512
 ds_read_b64_tr_b16 a[134:135], v97 offset:1536
 ds_read_b64_tr_b16 a[136:137], v97 offset:2048
 ds_read_b64_tr_b16 a[138:139], v97 offset:3072
 ds_read_b64_tr_b16 a[140:141], v97 offset:2560
 ds_read_b64_tr_b16 a[142:143], v97 offset:3584
 s_waitcnt lgkmcnt(0)
 s_waitcnt vmcnt(24)
 ds_read_b64_tr_b16 a[144:145], v97 offset:4096
 ds_read_b64_tr_b16 a[146:147], v97 offset:5120
 ds_read_b64_tr_b16 a[148:149], v97 offset:4608
 ds_read_b64_tr_b16 a[150:151], v97 offset:5632
 ds_read_b64_tr_b16 a[152:153], v97 offset:6144
 ds_read_b64_tr_b16 a[154:155], v97 offset:7168
 ds_read_b64_tr_b16 a[156:157], v97 offset:6656
 ds_read_b64_tr_b16 a[158:159], v97 offset:7680
 s_waitcnt lgkmcnt(0)
 s_waitcnt vmcnt(20)
 ds_read_b64_tr_b16 a[160:161], v97 offset:8192
 ds_read_b64_tr_b16 a[162:163], v97 offset:9216
 ds_read_b64_tr_b16 a[164:165], v97 offset:8704
 ds_read_b64_tr_b16 a[166:167], v97 offset:9728
 ds_read_b64_tr_b16 a[168:169], v97 offset:10240
 ds_read_b64_tr_b16 a[170:171], v97 offset:11264
 ds_read_b64_tr_b16 a[172:173], v97 offset:10752
 ds_read_b64_tr_b16 a[174:175], v97 offset:11776
 s_waitcnt lgkmcnt(0)
 s_waitcnt vmcnt(16)
 ds_read_b64_tr_b16 a[176:177], v97 offset:12288
 ds_read_b64_tr_b16 a[178:179], v97 offset:13312
 ds_read_b64_tr_b16 a[180:181], v97 offset:12800
 ds_read_b64_tr_b16 a[182:183], v97 offset:13824
 ds_read_b64_tr_b16 a[184:185], v97 offset:14336
 ds_read_b64_tr_b16 a[186:187], v97 offset:15360
 ds_read_b64_tr_b16 a[188:189], v97 offset:14848
 ds_read_b64_tr_b16 a[190:191], v97 offset:15872
 s_waitcnt lgkmcnt(0)
 s_waitcnt vmcnt(12)
 ds_read_b64_tr_b16 a[192:193], v97 offset:16384
 ds_read_b64_tr_b16 a[194:195], v97 offset:17408
 ds_read_b64_tr_b16 a[196:197], v97 offset:16896
 ds_read_b64_tr_b16 a[198:199], v97 offset:17920
 ds_read_b64_tr_b16 a[200:201], v97 offset:18432
 ds_read_b64_tr_b16 a[202:203], v97 offset:19456
 ds_read_b64_tr_b16 a[204:205], v97 offset:18944
 ds_read_b64_tr_b16 a[206:207], v97 offset:19968
 s_waitcnt lgkmcnt(0)
 s_waitcnt vmcnt(8)
 ds_read_b64_tr_b16 a[208:209], v97 offset:20480
 ds_read_b64_tr_b16 a[210:211], v97 offset:21504
 ds_read_b64_tr_b16 a[212:213], v97 offset:20992
 ds_read_b64_tr_b16 a[214:215], v97 offset:22016
 ds_read_b64_tr_b16 a[216:217], v97 offset:22528
 ds_read_b64_tr_b16 a[218:219], v97 offset:23552
 ds_read_b64_tr_b16 a[220:221], v97 offset:23040
 ds_read_b64_tr_b16 a[222:223], v97 offset:24064
 s_waitcnt lgkmcnt(0)
 s_waitcnt vmcnt(4)
 ds_read_b64_tr_b16 a[224:225], v97 offset:24576
 ds_read_b64_tr_b16 a[226:227], v97 offset:25600
 ds_read_b64_tr_b16 a[228:229], v97 offset:25088
 ds_read_b64_tr_b16 a[230:231], v97 offset:26112
 ds_read_b64_tr_b16 a[232:233], v97 offset:26624
 ds_read_b64_tr_b16 a[234:235], v97 offset:27648
 ds_read_b64_tr_b16 a[236:237], v97 offset:27136
 ds_read_b64_tr_b16 a[238:239], v97 offset:28160
 s_waitcnt lgkmcnt(0)
 s_waitcnt vmcnt(0)
 ds_read_b64_tr_b16 a[240:241], v97 offset:28672
 ds_read_b64_tr_b16 a[242:243], v97 offset:29696
 ds_read_b64_tr_b16 a[244:245], v97 offset:29184
 ds_read_b64_tr_b16 a[246:247], v97 offset:30208
 ds_read_b64_tr_b16 a[248:249], v97 offset:30720
 ds_read_b64_tr_b16 a[250:251], v97 offset:31744
 ds_read_b64_tr_b16 a[252:253], v97 offset:31232
 ds_read_b64_tr_b16 a[254:255], v97 offset:32256
 s_waitcnt lgkmcnt(0)
 v_and_b32 v4, 31, v0
 v_lshlrev_b32 v4, 2, v4
 s_lshl_b32 s48, s61, 7
 s_add_u32 s48, s48, 1024
 v_add_u32 v4, s48, v4
 s_mov_b32 s78, 0
 v_and_b32 v8, 7, v0
 v_lshlrev_b32_e64 v8, 2, v8
 v_add_u32 v8, 128, v8
 v_add_u32 v2, 8192, v4
 v_cmp_gt_u32 vcc, 32, v0
 s_nop 1
 v_cndmask_b32_e64 v8, v8, v2, vcc
 v_bfe_u32 v2, v0, 4, 1
 v_mul_u32_u24 v7, 512, v2
 v_lshrrev_b32 v2, 5, v0
 v_mul_u32_u24 v2, 64, v2
 v_add_u32_e64 v7, v7, v2
 v_bfe_u32 v2, v0, 2, 2
 v_lshl_add_u32 v7, v2, 7, v7
 v_and_b32_e64 v2, 3, v0
 v_lshl_add_u32 v7, v2, 4, v7
 v_bfe_u32 v2, v0, 4, 1
 v_mul_u32_u24 v9, 1024, v2
 v_lshrrev_b32 v2, 5, v0
 v_mul_u32_u24 v2, 256, v2
 v_add_u32 v9, v9, v2
 v_and_b32 v2, 15, v0
 v_lshl_add_u32 v9, v2, 4, v9
 s_lshl_b32 s48, s62, 13
 s_lshl_b32 s49, s46, 11
 s_add_u32 s48, s48, s49
 s_lshl_b32 s49, s61, 15
 s_add_u32 s48, s48, s49
 v_add_u32 v7, s48, v7
 s_mov_b32 s60, 0
 s_mul_i32 s48, s45, 49152
 s_mul_i32 s49, s46, 12288
 s_add_u32 s48, s48, s49
 s_add_u32 s48, s48, s94
 buffer_load_dwordx4 v[100:103], v1, s[32:35], s48 offen offset:0 sc1
 buffer_load_dwordx4 v[100:103], v1, s[32:35], s48 offen offset:1024 sc1
 buffer_load_dwordx4 v[100:103], v1, s[32:35], s48 offen offset:2048 sc1
 buffer_load_dwordx4 v[100:103], v1, s[32:35], s48 offen offset:3072 sc1
 s_add_u32 s48, s48, 4096
 buffer_load_dwordx4 v[100:103], v1, s[32:35], s48 offen offset:0 sc1
 buffer_load_dwordx4 v[100:103], v1, s[32:35], s48 offen offset:1024 sc1
 buffer_load_dwordx4 v[100:103], v1, s[32:35], s48 offen offset:2048 sc1
 buffer_load_dwordx4 v[100:103], v1, s[32:35], s48 offen offset:3072 sc1
 s_add_u32 s48, s48, 4096
 buffer_load_dwordx4 v[100:103], v1, s[32:35], s48 offen offset:0 sc1
 buffer_load_dwordx4 v[100:103], v1, s[32:35], s48 offen offset:1024 sc1
 buffer_load_dwordx4 v[100:103], v1, s[32:35], s48 offen offset:2048 sc1
 buffer_load_dwordx4 v[100:103], v1, s[32:35], s48 offen offset:3072 sc1
 s_waitcnt vmcnt(0)
 s_mov_b32 s30, 0
L_winit_133:
 v_mov_b32 v124, 0
 global_load_dword v125, v124, s[26:27] offset:192 sc1
L_wchk_135:
 s_add_u32 s30, s30, 1
 s_cmp_gt_u32 s30, 524288
 s_cbranch_scc1 L_exit
 s_waitcnt vmcnt(0)
 v_readfirstlane_b32 s54, v125
 s_nop 0
 s_cmp_lg_u32 s54, 0
 s_cbranch_scc1 L_wdone_134
 s_sleep 8
 s_branch L_winit_133
L_wdone_134:
 s_lshr_b32 s3, s54, s44
 s_and_b32 s3, s3, 1
 s_barrier
 s_lshl_b32 s48, s45, 12
 s_lshl_b32 s49, s46, 10
 s_add_u32 s48, s48, s49
 s_lshl_b32 s49, s47, 17
 s_add_u32 s48, s48, s49
 buffer_load_dwordx4 v[100:103], v1, s[32:35], s48 offen sc1
 s_waitcnt vmcnt(0)
 s_cmp_eq_u32 s3, 0
 s_cbranch_scc1 L_ra_G
L_ra_L:
 s_lshl_b32 s57, s55, 11
 s_sub_u32 s79, s57, s78
 s_add_u32 s93, s79, 2048
 s_cmp_lg_u32 s92, 0
 s_cbranch_scc1 L_pre_136
 s_mov_b32 s30, 0
L_pf_137:
 buffer_load_dword v2, v4, s[32:35], s79 offen sc1
 s_add_u32 s30, s30, 1
 s_cmp_gt_u32 s30, 524288
 s_cbranch_scc1 L_exit
 s_waitcnt vmcnt(0)
 v_cmp_eq_u32 vcc, 0, v2
 s_cbranch_vccz L_pfd_138
 s_sleep 1
 s_branch L_pf_137
L_pfd_138:
 s_lshl_b32 s58, s55, 18
 s_lshl_b32 s48, s61, 16
 s_add_u32 s58, s58, s48
 s_add_u32 s58, s58, 0x4000000
 s_mul_i32 s48, s46, 4096
 s_add_u32 s64, s58, s48
 s_add_u32 s95, s60, s48
 s_add_u32 m0, s95, 0
 s_add_u32 s65, s64, 0
 buffer_load_dwordx4 v1, s[32:35], s65 offen offset:0 sc1 lds
 buffer_load_dwordx4 v1, s[32:35], s65 offen offset:1024 sc1 lds
 buffer_load_dwordx4 v1, s[32:35], s65 offen offset:2048 sc1 lds
 buffer_load_dwordx4 v1, s[32:35], s65 offen offset:3072 sc1 lds
 s_add_u32 m0, s95, 16384
 s_add_u32 s65, s64, 16384
 buffer_load_dwordx4 v1, s[32:35], s65 offen offset:0 sc1 lds
 buffer_load_dwordx4 v1, s[32:35], s65 offen offset:1024 sc1 lds
 buffer_load_dwordx4 v1, s[32:35], s65 offen offset:2048 sc1 lds
 buffer_load_dwordx4 v1, s[32:35], s65 offen offset:3072 sc1 lds
L_pre_136:
 v_add_u32 v6, s60, v9
 s_xor_b32 s60, s60, 65536
 s_and_b32 s48, s55, 63
 s_cmp_lg_u32 s48, 3
 s_cbranch_scc1 L_nocr_139
 v_mov_b32 v4, v8
 s_mov_b32 s78, 8192
 s_sub_u32 s93, s93, 8192
L_nocr_139:
 s_and_b32 s59, s55, 3
 s_lshl_b32 s59, s59, 17
 s_add_u32 s59, s59, s94
 s_lshl_b32 s48, s45, 2
 s_add_u32 s48, s48, s46
 s_lshl_b32 s48, s48, 2
 s_add_u32 s57, s57, s48
 s_waitcnt vmcnt(6)
 s_cmp_lg_u32 s75, 0
 s_cbranch_scc1 L_np_140
 s_waitcnt vmcnt(4)
L_np_140:
 s_barrier
 ds_read_b128 v[32:35], v6 offset:0
 ds_read_b128 v[36:39], v6 offset:512
 ds_read_b128 v[40:43], v6 offset:2048
 ds_read_b128 v[44:47], v6 offset:2560
 s_waitcnt lgkmcnt(2)
 v_mfma_f32_32x32x16_bf16 v[16:31], a[0:3], v[32:35], 0
 ds_read_b128 v[48:51], v6 offset:4096
 ds_read_b128 v[52:55], v6 offset:4608
 s_add_u32 m0, s95, 32768
 s_add_u32 s65, s64, 32768
 buffer_load_dwordx4 v1, s[32:35], s65 offen offset:0 sc1 lds
 v_mfma_f32_32x32x16_bf16 v[16:31], a[4:7], v[36:39], v[16:31]
 s_waitcnt lgkmcnt(2)
 v_mfma_f32_32x32x16_bf16 v[16:31], a[8:11], v[40:43], v[16:31]
 ds_read_b128 v[32:35], v6 offset:6144
 ds_read_b128 v[36:39], v6 offset:6656
 buffer_load_dwordx4 v1, s[32:35], s65 offen offset:1024 sc1 lds
 v_mfma_f32_32x32x16_bf16 v[16:31], a[12:15], v[44:47], v[16:31]
 s_waitcnt lgkmcnt(2)
 v_mfma_f32_32x32x16_bf16 v[16:31], a[16:19], v[48:51], v[16:31]
 ds_read_b128 v[40:43], v6 offset:8192
 ds_read_b128 v[44:47], v6 offset:8704
 buffer_load_dwordx4 v1, s[32:35], s65 offen offset:2048 sc1 lds
 v_mfma_f32_32x32x16_bf16 v[16:31], a[20:23], v[52:55], v[16:31]
 s_waitcnt lgkmcnt(2)
 v_mfma_f32_32x32x16_bf16 v[16:31], a[24:27], v[32:35], v[16:31]
 ds_read_b128 v[48:51], v6 offset:10240
 ds_read_b128 v[52:55], v6 offset:10752
 buffer_load_dwordx4 v1, s[32:35], s65 offen offset:3072 sc1 lds
 v_mfma_f32_32x32x16_bf16 v[16:31], a[28:31], v[36:39], v[16:31]
 s_waitcnt lgkmcnt(2)
 v_mfma_f32_32x32x16_bf16 v[16:31], a[32:35], v[40:43], v[16:31]
 ds_read_b128 v[32:35], v6 offset:12288
 ds_read_b128 v[36:39], v6 offset:12800
 s_add_u32 m0, s95, 49152
 s_add_u32 s65, s64, 49152
 buffer_load_dwordx4 v1, s[32:35], s65 offen offset:0 sc1 lds
 v_mfma_f32_32x32x16_bf16 v[16:31], a[36:39], v[44:47], v[16:31]
 s_waitcnt lgkmcnt(2)
 v_mfma_f32_32x32x16_bf16 v[16:31], a[40:43], v[48:51], v[16:31]
 ds_read_b128 v[40:43], v6 offset:14336
 ds_read_b128 v[44:47], v6 offset:14848
 buffer_load_dwordx4 v1, s[32:35], s65 offen offset:1024 sc1 lds
 v_mfma_f32_32x32x16_bf16 v[16:31], a[44:47], v[52:55], v[16:31]
 s_waitcnt vmcnt(6)
 s_cmp_eq_u32 s75, 0
 s_cbranch_scc1 L_np_141
 s_mov_b64 exec, 1
 buffer_store_dword v5, off, s[32:35], s67 offset:1536
 s_mov_b64 exec, -1
L_np_141:
 s_barrier
 s_waitcnt lgkmcnt(2)
 v_mfma_f32_32x32x16_bf16 v[16:31], a[48:51], v[32:35], v[16:31]
 ds_read_b128 v[48:51], v6 offset:16384
 ds_read_b128 v[52:55], v6 offset:16896
 buffer_load_dwordx4 v1, s[32:35], s65 offen offset:2048 sc1 lds
 v_mfma_f32_32x32x16_bf16 v[16:31], a[52:55], v[36:39], v[16:31]
 s_waitcnt lgkmcnt(2)
 v_mfma_f32_32x32x16_bf16 v[16:31], a[56:59], v[40:43], v[16:31]
 ds_read_b128 v[32:35], v6 offset:18432
 ds_read_b128 v[36:39], v6 offset:18944
 buffer_load_dwordx4 v1, s[32:35], s65 offen offset:3072 sc1 lds
 v_mfma_f32_32x32x16_bf16 v[16:31], a[60:63], v[44:47], v[16:31]
 s_waitcnt lgkmcnt(2)
 v_mfma_f32_32x32x16_bf16 v[16:31], a[64:67], v[48:51], v[16:31]
 ds_read_b128 v[40:43], v6 offset:20480
 ds_read_b128 v[44:47], v6 offset:20992
 v_mfma_f32_32x32x16_bf16 v[16:31], a[68:71], v[52:55], v[16:31]
 s_waitcnt lgkmcnt(2)
 v_mfma_f32_32x32x16_bf16 v[16:31], a[72:75], v[32:35], v[16:31]
 ds_read_b128 v[48:51], v6 offset:22528
 ds_read_b128 v[52:55], v6 offset:23040
 v_mfma_f32_32x32x16_bf16 v[16:31], a[76:79], v[36:39], v[16:31]
 s_waitcnt lgkmcnt(2)
 v_mfma_f32_32x32x16_bf16 v[16:31], a[80:83], v[40:43], v[16:31]
 ds_read_b128 v[32:35], v6 offset:24576
 ds_read_b128 v[36:39], v6 offset:25088
 v_mfma_f32_32x32x16_bf16 v[16:31], a[84:87], v[44:47], v[16:31]
 s_waitcnt lgkmcnt(2)
 v_mfma_f32_32x32x16_bf16 v[16:31], a[88:91], v[48:51], v[16:31]
 ds_read_b128 v[40:43], v6 offset:26624
 ds_read_b128 v[44:47], v6 offset:27136
 v_mfma_f32_32x32x16_bf16 v[16:31], a[92:95], v[52:55], v[16:31]
 s_waitcnt lgkmcnt(2)
 v_mfma_f32_32x32x16_bf16 v[16:31], a[96:99], v[32:35], v[16:31]
 ds_read_b128 v[48:51], v6 offset:28672
 ds_read_b128 v[52:55], v6 offset:29184
 v_mfma_f32_32x32x16_bf16 v[16:31], a[100:103], v[36:39], v[16:31]
 s_waitcnt lgkmcnt(2)
 v_mfma_f32_32x32x16_bf16 v[16:31], a[104:107], v[40:43], v[16:31]
 ds_read_b128 v[32:35], v6 offset:30720
 ds_read_b128 v[36:39], v6 offset:31232
 v_mfma_f32_32x32x16_bf16 v[16:31], a[108:111], v[44:47], v[16:31]
 s_waitcnt vmcnt(4)
 s_barrier
 s_waitcnt lgkmcnt(2)
 v_mfma_f32_32x32x16_bf16 v[16:31], a[112:115], v[48:51], v[16:31]
 ds_read_b128 v[40:43], v6 offset:32768
 ds_read_b128 v[44:47], v6 offset:33280
 buffer_load_dword v13, v4, s[32:35], s93 offen sc1
 v_mfma_f32_32x32x16_bf16 v[16:31], a[116:119], v[52:55], v[16:31]
 s_waitcnt lgkmcnt(2)
 v_mfma_f32_32x32x16_bf16 v[16:31], a[120:123], v[32:35], v[16:31]
 ds_read_b128 v[48:51], v6 offset:34816
 ds_read_b128 v[52:55], v6 offset:35328
 v_mfma_f32_32x32x16_bf16 v[16:31], a[124:127], v[36:39], v[16:31]
 s_waitcnt lgkmcnt(2)
 v_mfma_f32_32x32x16_bf16 v[16:31], a[128:131], v[40:43], v[16:31]
 ds_read_b128 v[32:35], v6 offset:36864
 ds_read_b128 v[36:39], v6 offset:37376
 v_mfma_f32_32x32x16_bf16 v[16:31], a[132:135], v[44:47], v[16:31]
 s_waitcnt lgkmcnt(2)
 v_mfma_f32_32x32x16_bf16 v[16:31], a[136:139], v[48:51], v[16:31]
 ds_read_b128 v[40:43], v6 offset:38912
 ds_read_b128 v[44:47], v6 offset:39424
 v_mfma_f32_32x32x16_bf16 v[16:31], a[140:143], v[52:55], v[16:31]
 s_waitcnt lgkmcnt(2)
 v_mfma_f32_32x32x16_bf16 v[16:31], a[144:147], v[32:35], v[16:31]
 ds_read_b128 v[48:51], v6 offset:40960
 ds_read_b128 v[52:55], v6 offset:41472
 v_mfma_f32_32x32x16_bf16 v[16:31], a[148:151], v[36:39], v[16:31]
 s_waitcnt lgkmcnt(2)
 v_mfma_f32_32x32x16_bf16 v[16:31], a[152:155], v[40:43], v[16:31]
 ds_read_b128 v[32:35], v6 offset:43008
 ds_read_b128 v[36:39], v6 offset:43520
 v_mfma_f32_32x32x16_bf16 v[16:31], a[156:159], v[44:47], v[16:31]
 s_waitcnt lgkmcnt(2)
 v_mfma_f32_32x32x16_bf16 v[16:31], a[160:163], v[48:51], v[16:31]
 ds_read_b128 v[40:43], v6 offset:45056
 ds_read_b128 v[44:47], v6 offset:45568
 v_mfma_f32_32x32x16_bf16 v[16:31], a[164:167], v[52:55], v[16:31]
 s_waitcnt lgkmcnt(2)
 v_mfma_f32_32x32x16_bf16 v[16:31], a[168:171], v[32:35], v[16:31]
 ds_read_b128 v[48:51], v6 offset:47104
 ds_read_b128 v[52:55], v6 offset:47616
 v_mfma_f32_32x32x16_bf16 v[16:31], a[172:175], v[36:39], v[16:31]
 s_waitcnt vmcnt(1)
 s_barrier
 s_waitcnt lgkmcnt(2)
 v_mfma_f32_32x32x16_bf16 v[16:31], a[176:179], v[40:43], v[16:31]
 ds_read_b128 v[32:35], v6 offset:49152
 ds_read_b128 v[36:39], v6 offset:49664
 v_mfma_f32_32x32x16_bf16 v[16:31], a[180:183], v[44:47], v[16:31]
 s_waitcnt lgkmcnt(2)
 v_mfma_f32_32x32x16_bf16 v[16:31], a[184:187], v[48:51], v[16:31]
 ds_read_b128 v[40:43], v6 offset:51200
 ds_read_b128 v[44:47], v6 offset:51712
 v_mfma_f32_32x32x16_bf16 v[16:31], a[188:191], v[52:55], v[16:31]
 s_waitcnt vmcnt(0)
 v_cmp_eq_u32 vcc, 0, v13
 s_mov_b32 s92, 0
 s_add_u32 s50, s55, 1
 s_cmp_ge_u32 s50, s56
 s_cbranch_scc1 L_Hn_142
 s_cbranch_vccnz L_Hn_142
 s_lshl_b32 s58, s50, 18
 s_lshl_b32 s48, s61, 16
 s_add_u32 s58, s58, s48
 s_add_u32 s58, s58, 0x4000000
 s_mul_i32 s48, s46, 4096
 s_add_u32 s64, s58, s48
 s_add_u32 s95, s60, s48
 s_mov_b32 s92, 1
 s_waitcnt lgkmcnt(2)
 v_mfma_f32_32x32x16_bf16 v[16:31], a[192:195], v[32:35], v[16:31]
 ds_read_b128 v[48:51], v6 offset:53248
 ds_read_b128 v[52:55], v6 offset:53760
 s_add_u32 m0, s95, 0
 s_add_u32 s65, s64, 0
 buffer_load_dwordx4 v1, s[32:35], s65 offen offset:0 sc1 lds
 v_mfma_f32_32x32x16_bf16 v[16:31], a[196:199], v[36:39], v[16:31]
 s_waitcnt lgkmcnt(2)
 v_mfma_f32_32x32x16_bf16 v[16:31], a[200:203], v[40:43], v[16:31]
 ds_read_b128 v[32:35], v6 offset:55296
 ds_read_b128 v[36:39], v6 offset:55808
 buffer_load_dwordx4 v1, s[32:35], s65 offen offset:1024 sc1 lds
 v_mfma_f32_32x32x16_bf16 v[16:31], a[204:207], v[44:47], v[16:31]
 s_waitcnt lgkmcnt(2)
 v_mfma_f32_32x32x16_bf16 v[16:31], a[208:211], v[48:51], v[16:31]
 ds_read_b128 v[40:43], v6 offset:57344
 ds_read_b128 v[44:47], v6 offset:57856
 buffer_load_dwordx4 v1, s[32:35], s65 offen offset:2048 sc1 lds
 v_mfma_f32_32x32x16_bf16 v[16:31], a[212:215], v[52:55], v[16:31]
 s_waitcnt lgkmcnt(2)
 v_mfma_f32_32x32x16_bf16 v[16:31], a[216:219], v[32:35], v[16:31]
 ds_read_b128 v[48:51], v6 offset:59392
 ds_read_b128 v[52:55], v6 offset:59904
 buffer_load_dwordx4 v1, s[32:35], s65 offen offset:3072 sc1 lds
 v_mfma_f32_32x32x16_bf16 v[16:31], a[220:223], v[36:39], v[16:31]
 s_waitcnt lgkmcnt(2)
 v_mfma_f32_32x32x16_bf16 v[16:31], a[224:227], v[40:43], v[16:31]
 ds_read_b128 v[32:35], v6 offset:61440
 ds_read_b128 v[36:39], v6 offset:61952
 s_add_u32 m0, s95, 16384
 s_add_u32 s65, s64, 16384
 buffer_load_dwordx4 v1, s[32:35], s65 offen offset:0 sc1 lds
 v_mfma_f32_32x32x16_bf16 v[16:31], a[228:231], v[44:47], v[16:31]
 s_waitcnt lgkmcnt(2)
 v_mfma_f32_32x32x16_bf16 v[16:31], a[232:235], v[48:51], v[16:31]
 ds_read_b128 v[40:43], v6 offset:63488
 ds_read_b128 v[44:47], v6 offset:64000
 buffer_load_dwordx4 v1, s[32:35], s65 offen offset:1024 sc1 lds
 v_mfma_f32_32x32x16_bf16 v[16:31], a[236:239], v[52:55], v[16:31]
 s_waitcnt lgkmcnt(2)
 v_mfma_f32_32x32x16_bf16 v[16:31], a[240:243], v[32:35], v[16:31]
 buffer_load_dwordx4 v1, s[32:35], s65 offen offset:2048 sc1 lds
 v_mfma_f32_32x32x16_bf16 v[16:31], a[244:247], v[36:39], v[16:31]
 s_waitcnt lgkmcnt(0)
 v_mfma_f32_32x32x16_bf16 v[16:31], a[248:251], v[40:43], v[16:31]
 buffer_load_dwordx4 v1, s[32:35], s65 offen offset:3072 sc1 lds
 v_mfma_f32_32x32x16_bf16 v[16:31], a[252:255], v[44:47], v[16:31]
 s_branch L_He_143
L_Hn_142:
 s_waitcnt lgkmcnt(2)
 v_mfma_f32_32x32x16_bf16 v[16:31], a[192:195], v[32:35], v[16:31]
 ds_read_b128 v[48:51], v6 offset:53248
 ds_read_b128 v[52:55], v6 offset:53760
 v_mfma_f32_32x32x16_bf16 v[16:31], a[196:199], v[36:39], v[16:31]
 s_waitcnt lgkmcnt(2)
 v_mfma_f32_32x32x16_bf16 v[16:31], a[200:203], v[40:43], v[16:31]
 ds_read_b128 v[32:35], v6 offset:55296
 ds_read_b128 v[36:39], v6 offset:55808
 v_mfma_f32_32x32x16_bf16 v[16:31], a[204:207], v[44:47], v[16:31]
 s_waitcnt lgkmcnt(2)
 v_mfma_f32_32x32x16_bf16 v[16:31], a[208:211], v[48:51], v[16:31]
 ds_read_b128 v[40:43], v6 offset:57344
 ds_read_b128 v[44:47], v6 offset:57856
 v_mfma_f32_32x32x16_bf16 v[16:31], a[212:215], v[52:55], v[16:31]
 s_waitcnt lgkmcnt(2)
 v_mfma_f32_32x32x16_bf16 v[16:31], a[216:219], v[32:35], v[16:31]
 ds_read_b128 v[48:51], v6 offset:59392
 ds_read_b128 v[52:55], v6 offset:59904
 v_mfma_f32_32x32x16_bf16 v[16:31], a[220:223], v[36:39], v[16:31]
 s_waitcnt lgkmcnt(2)
 v_mfma_f32_32x32x16_bf16 v[16:31], a[224:227], v[40:43], v[16:31]
 ds_read_b128 v[32:35], v6 offset:61440
 ds_read_b128 v[36:39], v6 offset:61952
 v_mfma_f32_32x32x16_bf16 v[16:31], a[228:231], v[44:47], v[16:31]
 s_waitcnt lgkmcnt(2)
 v_mfma_f32_32x32x16_bf16 v[16:31], a[232:235], v[48:51], v[16:31]
 ds_read_b128 v[40:43], v6 offset:63488
 ds_read_b128 v[44:47], v6 offset:64000
 buffer_load_dword v13, v4, s[32:35], s93 offen sc1
 v_mfma_f32_32x32x16_bf16 v[16:31], a[236:239], v[52:55], v[16:31]
 s_waitcnt lgkmcnt(2)
 v_mfma_f32_32x32x16_bf16 v[16:31], a[240:243], v[32:35], v[16:31]
 v_mfma_f32_32x32x16_bf16 v[16:31], a[244:247], v[36:39], v[16:31]
 s_waitcnt lgkmcnt(0)
 v_mfma_f32_32x32x16_bf16 v[16:31], a[248:251], v[40:43], v[16:31]
 v_mfma_f32_32x32x16_bf16 v[16:31], a[252:255], v[44:47], v[16:31]
L_He_143:
 s_nop 11
 v_cvt_pk_bf16_f32 v56, v16, v17
 v_cvt_pk_bf16_f32 v57, v18, v19
 v_cvt_pk_bf16_f32 v58, v20, v21
 v_cvt_pk_bf16_f32 v59, v22, v23
 buffer_store_dwordx4 v[56:59], v7, s[32:35], s59 offen offset:0
 v_cvt_pk_bf16_f32 v60, v24, v25
 v_cvt_pk_bf16_f32 v61, v26, v27
 v_cvt_pk_bf16_f32 v62, v28, v29
 v_cvt_pk_bf16_f32 v63, v30, v31
 buffer_store_dwordx4 v[60:63], v7, s[32:35], s59 offen offset:1024
 s_mov_b32 s67, s57
 s_mov_b32 s75, s92
 s_cmp_lg_u32 s92, 0
 s_cbranch_scc1 L_fin_146
 s_waitcnt vmcnt(2)
 v_cmp_eq_u32 vcc, 0, v13
 s_add_u32 s50, s55, 1
 s_cmp_ge_u32 s50, s56
 s_cbranch_scc1 L_noE_144
 s_cbranch_vccnz L_noE_144
 s_lshl_b32 s58, s50, 18
 s_lshl_b32 s48, s61, 16
 s_add_u32 s58, s58, s48
 s_add_u32 s58, s58, 0x4000000
 s_mul_i32 s48, s46, 4096
 s_add_u32 s64, s58, s48
 s_add_u32 s95, s60, s48
 s_add_u32 m0, s95, 0
 s_add_u32 s65, s64, 0
 buffer_load_dwordx4 v1, s[32:35], s65 offen offset:0 sc1 lds
 buffer_load_dwordx4 v1, s[32:35], s65 offen offset:1024 sc1 lds
 buffer_load_dwordx4 v1, s[32:35], s65 offen offset:2048 sc1 lds
 buffer_load_dwordx4 v1, s[32:35], s65 offen offset:3072 sc1 lds
 s_add_u32 m0, s95, 16384
 s_add_u32 s65, s64, 16384
 buffer_load_dwordx4 v1, s[32:35], s65 offen offset:0 sc1 lds
 buffer_load_dwordx4 v1, s[32:35], s65 offen offset:1024 sc1 lds
 buffer_load_dwordx4 v1, s[32:35], s65 offen offset:2048 sc1 lds
 buffer_load_dwordx4 v1, s[32:35], s65 offen offset:3072 sc1 lds
 s_mov_b32 s92, 1
 s_waitcnt vmcnt(8)
 s_branch L_goE_145
L_noE_144:
 s_waitcnt vmcnt(0)
L_goE_145:
 s_mov_b64 exec, 1
 buffer_store_dword v5, off, s[32:35], s57 offset:1536
 s_mov_b64 exec, -1
L_fin_146:
 s_add_u32 s55, s55, 1
 s_cmp_lt_u32 s55, s56
 s_cbranch_scc1 L_ra_L
 s_waitcnt vmcnt(0)
 s_branch L_done
L_ra_G:
 s_lshl_b32 s57, s55, 11
 s_sub_u32 s79, s57, s78
 s_add_u32 s93, s79, 2048
 s_cmp_lg_u32 s92, 0
 s_cbranch_scc1 L_pre_147
 s_mov_b32 s30, 0
L_pf_148:
 buffer_load_dword v2, v4, s[32:35], s79 offen sc1
 s_add_u32 s30, s30, 1
 s_cmp_gt_u32 s30, 524288
 s_cbranch_scc1 L_exit
 s_waitcnt vmcnt(0)
 v_cmp_eq_u32 vcc, 0, v2
 s_cbranch_vccz L_pfd_149
 s_sleep 1
 s_branch L_pf_148
L_pfd_149:
 s_lshl_b32 s58, s55, 18
 s_lshl_b32 s48, s61, 16
 s_add_u32 s58, s58, s48
 s_add_u32 s58, s58, 0x4000000
 s_mul_i32 s48, s46, 4096
 s_add_u32 s64, s58, s48
 s_add_u32 s95, s60, s48
 s_add_u32 m0, s95, 0
 s_add_u32 s65, s64, 0
 buffer_load_dwordx4 v1, s[32:35], s65 offen offset:0 sc1 lds
 buffer_load_dwordx4 v1, s[32:35], s65 offen offset:1024 sc1 lds
 buffer_load_dwordx4 v1, s[32:35], s65 offen offset:2048 sc1 lds
 buffer_load_dwordx4 v1, s[32:35], s65 offen offset:3072 sc1 lds
 s_add_u32 m0, s95, 16384
 s_add_u32 s65, s64, 16384
 buffer_load_dwordx4 v1, s[32:35], s65 offen offset:0 sc1 lds
 buffer_load_dwordx4 v1, s[32:35], s65 offen offset:1024 sc1 lds
 buffer_load_dwordx4 v1, s[32:35], s65 offen offset:2048 sc1 lds
 buffer_load_dwordx4 v1, s[32:35], s65 offen offset:3072 sc1 lds
L_pre_147:
 v_add_u32 v6, s60, v9
 s_xor_b32 s60, s60, 65536
 s_and_b32 s48, s55, 63
 s_cmp_lg_u32 s48, 3
 s_cbranch_scc1 L_nocr_150
 v_mov_b32 v4, v8
 s_mov_b32 s78, 8192
 s_sub_u32 s93, s93, 8192
L_nocr_150:
 s_and_b32 s59, s55, 3
 s_lshl_b32 s59, s59, 17
 s_add_u32 s59, s59, s94
 s_lshl_b32 s48, s45, 2
 s_add_u32 s48, s48, s46
 s_lshl_b32 s48, s48, 2
 s_add_u32 s57, s57, s48
 s_waitcnt vmcnt(6)
 s_cmp_lg_u32 s75, 0
 s_cbranch_scc1 L_np_151
 s_waitcnt vmcnt(4)
L_np_151:
 s_barrier
 ds_read_b128 v[32:35], v6 offset:0
 ds_read_b128 v[36:39], v6 offset:512
 ds_read_b128 v[40:43], v6 offset:2048
 ds_read_b128 v[44:47], v6 offset:2560
 s_waitcnt lgkmcnt(2)
 v_mfma_f32_32x32x16_bf16 v[16:31], a[0:3], v[32:35], 0
 ds_read_b128 v[48:51], v6 offset:4096
 ds_read_b128 v[52:55], v6 offset:4608
 s_add_u32 m0, s95, 32768
 s_add_u32 s65, s64, 32768
 buffer_load_dwordx4 v1, s[32:35], s65 offen offset:0 sc1 lds
 v_mfma_f32_32x32x16_bf16 v[16:31], a[4:7], v[36:39], v[16:31]
 s_waitcnt lgkmcnt(2)
 v_mfma_f32_32x32x16_bf16 v[16:31], a[8:11], v[40:43], v[16:31]
 ds_read_b128 v[32:35], v6 offset:6144
 ds_read_b128 v[36:39], v6 offset:6656
 buffer_load_dwordx4 v1, s[32:35], s65 offen offset:1024 sc1 lds
 v_mfma_f32_32x32x16_bf16 v[16:31], a[12:15], v[44:47], v[16:31]
 s_waitcnt lgkmcnt(2)
 v_mfma_f32_32x32x16_bf16 v[16:31], a[16:19], v[48:51], v[16:31]
 ds_read_b128 v[40:43], v6 offset:8192
 ds_read_b128 v[44:47], v6 offset:8704
 buffer_load_dwordx4 v1, s[32:35], s65 offen offset:2048 sc1 lds
 v_mfma_f32_32x32x16_bf16 v[16:31], a[20:23], v[52:55], v[16:31]
 s_waitcnt lgkmcnt(2)
 v_mfma_f32_32x32x16_bf16 v[16:31], a[24:27], v[32:35], v[16:31]
 ds_read_b128 v[48:51], v6 offset:10240
 ds_read_b128 v[52:55], v6 offset:10752
 buffer_load_dwordx4 v1, s[32:35], s65 offen offset:3072 sc1 lds
 v_mfma_f32_32x32x16_bf16 v[16:31], a[28:31], v[36:39], v[16:31]
 s_waitcnt lgkmcnt(2)
 v_mfma_f32_32x32x16_bf16 v[16:31], a[32:35], v[40:43], v[16:31]
 ds_read_b128 v[32:35], v6 offset:12288
 ds_read_b128 v[36:39], v6 offset:12800
 s_add_u32 m0, s95, 49152
 s_add_u32 s65, s64, 49152
 buffer_load_dwordx4 v1, s[32:35], s65 offen offset:0 sc1 lds
 v_mfma_f32_32x32x16_bf16 v[16:31], a[36:39], v[44:47], v[16:31]
 s_waitcnt lgkmcnt(2)
 v_mfma_f32_32x32x16_bf16 v[16:31], a[40:43], v[48:51], v[16:31]
 ds_read_b128 v[40:43], v6 offset:14336
 ds_read_b128 v[44:47], v6 offset:14848
 buffer_load_dwordx4 v1, s[32:35], s65 offen offset:1024 sc1 lds
 v_mfma_f32_32x32x16_bf16 v[16:31], a[44:47], v[52:55], v[16:31]
 s_waitcnt vmcnt(6)
 s_cmp_eq_u32 s75, 0
 s_cbranch_scc1 L_np_152
 s_mov_b64 exec, 1
 buffer_store_dword v5, off, s[32:35], s67 offset:1536 sc1
 s_mov_b64 exec, -1
L_np_152:
 s_barrier
 s_waitcnt lgkmcnt(2)
 v_mfma_f32_32x32x16_bf16 v[16:31], a[48:51], v[32:35], v[16:31]
 ds_read_b128 v[48:51], v6 offset:16384
 ds_read_b128 v[52:55], v6 offset:16896
 buffer_load_dwordx4 v1, s[32:35], s65 offen offset:2048 sc1 lds
 v_mfma_f32_32x32x16_bf16 v[16:31], a[52:55], v[36:39], v[16:31]
 s_waitcnt lgkmcnt(2)
 v_mfma_f32_32x32x16_bf16 v[16:31], a[56:59], v[40:43], v[16:31]
 ds_read_b128 v[32:35], v6 offset:18432
 ds_read_b128 v[36:39], v6 offset:18944
 buffer_load_dwordx4 v1, s[32:35], s65 offen offset:3072 sc1 lds
 v_mfma_f32_32x32x16_bf16 v[16:31], a[60:63], v[44:47], v[16:31]
 s_waitcnt lgkmcnt(2)
 v_mfma_f32_32x32x16_bf16 v[16:31], a[64:67], v[48:51], v[16:31]
 ds_read_b128 v[40:43], v6 offset:20480
 ds_read_b128 v[44:47], v6 offset:20992
 v_mfma_f32_32x32x16_bf16 v[16:31], a[68:71], v[52:55], v[16:31]
 s_waitcnt lgkmcnt(2)
 v_mfma_f32_32x32x16_bf16 v[16:31], a[72:75], v[32:35], v[16:31]
 ds_read_b128 v[48:51], v6 offset:22528
 ds_read_b128 v[52:55], v6 offset:23040
 v_mfma_f32_32x32x16_bf16 v[16:31], a[76:79], v[36:39], v[16:31]
 s_waitcnt lgkmcnt(2)
 v_mfma_f32_32x32x16_bf16 v[16:31], a[80:83], v[40:43], v[16:31]
 ds_read_b128 v[32:35], v6 offset:24576
 ds_read_b128 v[36:39], v6 offset:25088
 v_mfma_f32_32x32x16_bf16 v[16:31], a[84:87], v[44:47], v[16:31]
 s_waitcnt lgkmcnt(2)
 v_mfma_f32_32x32x16_bf16 v[16:31], a[88:91], v[48:51], v[16:31]
 ds_read_b128 v[40:43], v6 offset:26624
 ds_read_b128 v[44:47], v6 offset:27136
 v_mfma_f32_32x32x16_bf16 v[16:31], a[92:95], v[52:55], v[16:31]
 s_waitcnt lgkmcnt(2)
 v_mfma_f32_32x32x16_bf16 v[16:31], a[96:99], v[32:35], v[16:31]
 ds_read_b128 v[48:51], v6 offset:28672
 ds_read_b128 v[52:55], v6 offset:29184
 v_mfma_f32_32x32x16_bf16 v[16:31], a[100:103], v[36:39], v[16:31]
 s_waitcnt lgkmcnt(2)
 v_mfma_f32_32x32x16_bf16 v[16:31], a[104:107], v[40:43], v[16:31]
 ds_read_b128 v[32:35], v6 offset:30720
 ds_read_b128 v[36:39], v6 offset:31232
 v_mfma_f32_32x32x16_bf16 v[16:31], a[108:111], v[44:47], v[16:31]
 s_waitcnt vmcnt(4)
 s_barrier
 s_waitcnt lgkmcnt(2)
 v_mfma_f32_32x32x16_bf16 v[16:31], a[112:115], v[48:51], v[16:31]
 ds_read_b128 v[40:43], v6 offset:32768
 ds_read_b128 v[44:47], v6 offset:33280
 buffer_load_dword v13, v4, s[32:35], s93 offen sc1
 v_mfma_f32_32x32x16_bf16 v[16:31], a[116:119], v[52:55], v[16:31]
 s_waitcnt lgkmcnt(2)
 v_mfma_f32_32x32x16_bf16 v[16:31], a[120:123], v[32:35], v[16:31]
 ds_read_b128 v[48:51], v6 offset:34816
 ds_read_b128 v[52:55], v6 offset:35328
 v_mfma_f32_32x32x16_bf16 v[16:31], a[124:127], v[36:39], v[16:31]
 s_waitcnt lgkmcnt(2)
 v_mfma_f32_32x32x16_bf16 v[16:31], a[128:131], v[40:43], v[16:31]
 ds_read_b128 v[32:35], v6 offset:36864
 ds_read_b128 v[36:39], v6 offset:37376
 v_mfma_f32_32x32x16_bf16 v[16:31], a[132:135], v[44:47], v[16:31]
 s_waitcnt lgkmcnt(2)
 v_mfma_f32_32x32x16_bf16 v[16:31], a[136:139], v[48:51], v[16:31]
 ds_read_b128 v[40:43], v6 offset:38912
 ds_read_b128 v[44:47], v6 offset:39424
 v_mfma_f32_32x32x16_bf16 v[16:31], a[140:143], v[52:55], v[16:31]
 s_waitcnt lgkmcnt(2)
 v_mfma_f32_32x32x16_bf16 v[16:31], a[144:147], v[32:35], v[16:31]
 ds_read_b128 v[48:51], v6 offset:40960
 ds_read_b128 v[52:55], v6 offset:41472
 v_mfma_f32_32x32x16_bf16 v[16:31], a[148:151], v[36:39], v[16:31]
 s_waitcnt lgkmcnt(2)
 v_mfma_f32_32x32x16_bf16 v[16:31], a[152:155], v[40:43], v[16:31]
 ds_read_b128 v[32:35], v6 offset:43008
 ds_read_b128 v[36:39], v6 offset:43520
 v_mfma_f32_32x32x16_bf16 v[16:31], a[156:159], v[44:47], v[16:31]
 s_waitcnt lgkmcnt(2)
 v_mfma_f32_32x32x16_bf16 v[16:31], a[160:163], v[48:51], v[16:31]
 ds_read_b128 v[40:43], v6 offset:45056
 ds_read_b128 v[44:47], v6 offset:45568
 v_mfma_f32_32x32x16_bf16 v[16:31], a[164:167], v[52:55], v[16:31]
 s_waitcnt lgkmcnt(2)
 v_mfma_f32_32x32x16_bf16 v[16:31], a[168:171], v[32:35], v[16:31]
 ds_read_b128 v[48:51], v6 offset:47104
 ds_read_b128 v[52:55], v6 offset:47616
 v_mfma_f32_32x32x16_bf16 v[16:31], a[172:175], v[36:39], v[16:31]
 s_waitcnt vmcnt(1)
 s_barrier
 s_waitcnt lgkmcnt(2)
 v_mfma_f32_32x32x16_bf16 v[16:31], a[176:179], v[40:43], v[16:31]
 ds_read_b128 v[32:35], v6 offset:49152
 ds_read_b128 v[36:39], v6 offset:49664
 v_mfma_f32_32x32x16_bf16 v[16:31], a[180:183], v[44:47], v[16:31]
 s_waitcnt lgkmcnt(2)
 v_mfma_f32_32x32x16_bf16 v[16:31], a[184:187], v[48:51], v[16:31]
 ds_read_b128 v[40:43], v6 offset:51200
 ds_read_b128 v[44:47], v6 offset:51712
 v_mfma_f32_32x32x16_bf16 v[16:31], a[188:191], v[52:55], v[16:31]
 s_waitcnt vmcnt(0)
 v_cmp_eq_u32 vcc, 0, v13
 s_mov_b32 s92, 0
 s_add_u32 s50, s55, 1
 s_cmp_ge_u32 s50, s56
 s_cbranch_scc1 L_Hn_153
 s_cbranch_vccnz L_Hn_153
 s_lshl_b32 s58, s50, 18
 s_lshl_b32 s48, s61, 16
 s_add_u32 s58, s58, s48
 s_add_u32 s58, s58, 0x4000000
 s_mul_i32 s48, s46, 4096
 s_add_u32 s64, s58, s48
 s_add_u32 s95, s60, s48
 s_mov_b32 s92, 1
 s_waitcnt lgkmcnt(2)
 v_mfma_f32_32x32x16_bf16 v[16:31], a[192:195], v[32:35], v[16:31]
 ds_read_b128 v[48:51], v6 offset:53248
 ds_read_b128 v[52:55], v6 offset:53760
 s_add_u32 m0, s95, 0
 s_add_u32 s65, s64, 0
 buffer_load_dwordx4 v1, s[32:35], s65 offen offset:0 sc1 lds
 v_mfma_f32_32x32x16_bf16 v[16:31], a[196:199], v[36:39], v[16:31]
 s_waitcnt lgkmcnt(2)
 v_mfma_f32_32x32x16_bf16 v[16:31], a[200:203], v[40:43], v[16:31]
 ds_read_b128 v[32:35], v6 offset:55296
 ds_read_b128 v[36:39], v6 offset:55808
 buffer_load_dwordx4 v1, s[32:35], s65 offen offset:1024 sc1 lds
 v_mfma_f32_32x32x16_bf16 v[16:31], a[204:207], v[44:47], v[16:31]
 s_waitcnt lgkmcnt(2)
 v_mfma_f32_32x32x16_bf16 v[16:31], a[208:211], v[48:51], v[16:31]
 ds_read_b128 v[40:43], v6 offset:57344
 ds_read_b128 v[44:47], v6 offset:57856
 buffer_load_dwordx4 v1, s[32:35], s65 offen offset:2048 sc1 lds
 v_mfma_f32_32x32x16_bf16 v[16:31], a[212:215], v[52:55], v[16:31]
 s_waitcnt lgkmcnt(2)
 v_mfma_f32_32x32x16_bf16 v[16:31], a[216:219], v[32:35], v[16:31]
 ds_read_b128 v[48:51], v6 offset:59392
 ds_read_b128 v[52:55], v6 offset:59904
 buffer_load_dwordx4 v1, s[32:35], s65 offen offset:3072 sc1 lds
 v_mfma_f32_32x32x16_bf16 v[16:31], a[220:223], v[36:39], v[16:31]
 s_waitcnt lgkmcnt(2)
 v_mfma_f32_32x32x16_bf16 v[16:31], a[224:227], v[40:43], v[16:31]
 ds_read_b128 v[32:35], v6 offset:61440
 ds_read_b128 v[36:39], v6 offset:61952
 s_add_u32 m0, s95, 16384
 s_add_u32 s65, s64, 16384
 buffer_load_dwordx4 v1, s[32:35], s65 offen offset:0 sc1 lds
 v_mfma_f32_32x32x16_bf16 v[16:31], a[228:231], v[44:47], v[16:31]
 s_waitcnt lgkmcnt(2)
 v_mfma_f32_32x32x16_bf16 v[16:31], a[232:235], v[48:51], v[16:31]
 ds_read_b128 v[40:43], v6 offset:63488
 ds_read_b128 v[44:47], v6 offset:64000
 buffer_load_dwordx4 v1, s[32:35], s65 offen offset:1024 sc1 lds
 v_mfma_f32_32x32x16_bf16 v[16:31], a[236:239], v[52:55], v[16:31]
 s_waitcnt lgkmcnt(2)
 v_mfma_f32_32x32x16_bf16 v[16:31], a[240:243], v[32:35], v[16:31]
 buffer_load_dwordx4 v1, s[32:35], s65 offen offset:2048 sc1 lds
 v_mfma_f32_32x32x16_bf16 v[16:31], a[244:247], v[36:39], v[16:31]
 s_waitcnt lgkmcnt(0)
 v_mfma_f32_32x32x16_bf16 v[16:31], a[248:251], v[40:43], v[16:31]
 buffer_load_dwordx4 v1, s[32:35], s65 offen offset:3072 sc1 lds
 v_mfma_f32_32x32x16_bf16 v[16:31], a[252:255], v[44:47], v[16:31]
 s_branch L_He_154
L_Hn_153:
 s_waitcnt lgkmcnt(2)
 v_mfma_f32_32x32x16_bf16 v[16:31], a[192:195], v[32:35], v[16:31]
 ds_read_b128 v[48:51], v6 offset:53248
 ds_read_b128 v[52:55], v6 offset:53760
 v_mfma_f32_32x32x16_bf16 v[16:31], a[196:199], v[36:39], v[16:31]
 s_waitcnt lgkmcnt(2)
 v_mfma_f32_32x32x16_bf16 v[16:31], a[200:203], v[40:43], v[16:31]
 ds_read_b128 v[32:35], v6 offset:55296
 ds_read_b128 v[36:39], v6 offset:55808
 v_mfma_f32_32x32x16_bf16 v[16:31], a[204:207], v[44:47], v[16:31]
 s_waitcnt lgkmcnt(2)
 v_mfma_f32_32x32x16_bf16 v[16:31], a[208:211], v[48:51], v[16:31]
 ds_read_b128 v[40:43], v6 offset:57344
 ds_read_b128 v[44:47], v6 offset:57856
 v_mfma_f32_32x32x16_bf16 v[16:31], a[212:215], v[52:55], v[16:31]
 s_waitcnt lgkmcnt(2)
 v_mfma_f32_32x32x16_bf16 v[16:31], a[216:219], v[32:35], v[16:31]
 ds_read_b128 v[48:51], v6 offset:59392
 ds_read_b128 v[52:55], v6 offset:59904
 v_mfma_f32_32x32x16_bf16 v[16:31], a[220:223], v[36:39], v[16:31]
 s_waitcnt lgkmcnt(2)
 v_mfma_f32_32x32x16_bf16 v[16:31], a[224:227], v[40:43], v[16:31]
 ds_read_b128 v[32:35], v6 offset:61440
 ds_read_b128 v[36:39], v6 offset:61952
 v_mfma_f32_32x32x16_bf16 v[16:31], a[228:231], v[44:47], v[16:31]
 s_waitcnt lgkmcnt(2)
 v_mfma_f32_32x32x16_bf16 v[16:31], a[232:235], v[48:51], v[16:31]
 ds_read_b128 v[40:43], v6 offset:63488
 ds_read_b128 v[44:47], v6 offset:64000
 buffer_load_dword v13, v4, s[32:35], s93 offen sc1
 v_mfma_f32_32x32x16_bf16 v[16:31], a[236:239], v[52:55], v[16:31]
 s_waitcnt lgkmcnt(2)
 v_mfma_f32_32x32x16_bf16 v[16:31], a[240:243], v[32:35], v[16:31]
 v_mfma_f32_32x32x16_bf16 v[16:31], a[244:247], v[36:39], v[16:31]
 s_waitcnt lgkmcnt(0)
 v_mfma_f32_32x32x16_bf16 v[16:31], a[248:251], v[40:43], v[16:31]
 v_mfma_f32_32x32x16_bf16 v[16:31], a[252:255], v[44:47], v[16:31]
L_He_154:
 s_nop 10
 s_nop 0
 v_cvt_pk_bf16_f32 v56, v16, v17
 v_cvt_pk_bf16_f32 v57, v18, v19
 v_cvt_pk_bf16_f32 v58, v20, v21
 v_cvt_pk_bf16_f32 v59, v22, v23
 buffer_store_dwordx4 v[56:59], v7, s[32:35], s59 offen offset:0 sc1
 v_cvt_pk_bf16_f32 v60, v24, v25
 v_cvt_pk_bf16_f32 v61, v26, v27
 v_cvt_pk_bf16_f32 v62, v28, v29
 v_cvt_pk_bf16_f32 v63, v30, v31
 buffer_store_dwordx4 v[60:63], v7, s[32:35], s59 offen offset:1024 sc1
 s_mov_b32 s67, s57
 s_mov_b32 s75, s92
 s_cmp_lg_u32 s92, 0
 s_cbranch_scc1 L_fin_157
 s_waitcnt vmcnt(2)
 v_cmp_eq_u32 vcc, 0, v13
 s_add_u32 s50, s55, 1
 s_cmp_ge_u32 s50, s56
 s_cbranch_scc1 L_noE_155
 s_cbranch_vccnz L_noE_155
 s_lshl_b32 s58, s50, 18
 s_lshl_b32 s48, s61, 16
 s_add_u32 s58, s58, s48
 s_add_u32 s58, s58, 0x4000000
 s_mul_i32 s48, s46, 4096
 s_add_u32 s64, s58, s48
 s_add_u32 s95, s60, s48
 s_add_u32 m0, s95, 0
 s_add_u32 s65, s64, 0
 buffer_load_dwordx4 v1, s[32:35], s65 offen offset:0 sc1 lds
 buffer_load_dwordx4 v1, s[32:35], s65 offen offset:1024 sc1 lds
 buffer_load_dwordx4 v1, s[32:35], s65 offen offset:2048 sc1 lds
 buffer_load_dwordx4 v1, s[32:35], s65 offen offset:3072 sc1 lds
 s_add_u32 m0, s95, 16384
 s_add_u32 s65, s64, 16384
 buffer_load_dwordx4 v1, s[32:35], s65 offen offset:0 sc1 lds
 buffer_load_dwordx4 v1, s[32:35], s65 offen offset:1024 sc1 lds
 buffer_load_dwordx4 v1, s[32:35], s65 offen offset:2048 sc1 lds
 buffer_load_dwordx4 v1, s[32:35], s65 offen offset:3072 sc1 lds
 s_mov_b32 s92, 1
 s_waitcnt vmcnt(8)
 s_branch L_goE_156
L_noE_155:
 s_waitcnt vmcnt(0)
L_goE_156:
 s_mov_b64 exec, 1
 buffer_store_dword v5, off, s[32:35], s57 offset:1536 sc1
 s_mov_b64 exec, -1
L_fin_157:
 s_add_u32 s55, s55, 1
 s_cmp_lt_u32 s55, s56
 s_cbranch_scc1 L_ra_G
 s_waitcnt vmcnt(0)
 s_branch L_done
L_rc:
 v_and_b32 v0, 63, v0
 v_lshlrev_b32 v1, 4, v0
 s_lshl_b32 s66, s46, 15
 v_mov_b32 v5, 1
 s_lshl_b32 s55, s47, 6
 s_add_u32 s56, s55, 64
 s_mov_b32 s92, 0
 s_mov_b32 s75, 0
 s_lshl_b32 s94, s47, 21
 s_add_u32 s94, s94, 0x2000000
 s_sub_u32 s61, s45, 16
 s_lshl_b32 s61, s61, 2
 s_add_u32 s61, s61, s46
 v_lshrrev_b32 v96, 1, v0
 v_mul_u32_u24 v96, 3072, v96
 v_and_b32 v2, 1, v0
 v_lshl_add_u32 v96, v2, 4, v96
 v_lshrrev_b32 v2, 4, v0
 v_lshlrev_b32 v97, 8, v2
 v_bfe_u32 v2, v0, 2, 2
 v_lshl_add_u32 v97, v2, 5, v97
 v_and_b32 v2, 3, v0
 v_lshl_add_u32 v97, v2, 3, v97
 v_add_u32 v97, s66, v97
 s_lshl_b32 s50, s61, 5
 s_mov_b32 s36, s20
 s_mov_b32 s37, s21
 s_mov_b32 s38, 0x180000
 s_mov_b32 s39, 0x20000
 s_lshr_b32 s54, 166, s44
 s_and_b32 s54, s54, 1
 s_cbranch_scc0 L_nolate_158
 s_cmp_lg_u32 s46, 0
 s_cbranch_scc1 L_lated_160
 s_mov_b32 s30, 0
L_winit_161:
 v_mov_b32 v124, 0
 global_load_dword v125, v124, s[26:27] offset:192 sc1
L_wchk_163:
 s_add_u32 s30, s30, 1
 s_cmp_gt_u32 s30, 524288
 s_cbranch_scc1 L_exit
 s_waitcnt vmcnt(0)
 v_readfirstlane_b32 s54, v125
 s_nop 0
 s_cmp_lg_u32 s54, 0
 s_cbranch_scc1 L_wdone_162
 s_sleep 8
 s_branch L_winit_161
L_wdone_162:
 s_lshr_b32 s3, s54, s44
 s_and_b32 s3, s3, 1
 s_lshl_b32 s52, s44, 11
 s_mov_b32 s30, 0
L_late_159:
 buffer_load_dword v125, off, s[32:35], s52 offset:1792 sc1
 s_add_u32 s30, s30, 1
 s_waitcnt vmcnt(0)
 s_cmp_gt_u32 s30, 200
 s_cbranch_scc1 L_lated_160
 v_readfirstlane_b32 s54, v125
 s_nop 0
 s_cmp_ge_u32 s54, 1
 s_cbranch_scc1 L_lated_160
 s_sleep 8
 s_branch L_late_159
L_lated_160:
 s_barrier
L_nolate_158:
 s_add_u32 s48, s50, 0
 s_add_u32 m0, s66, 0
 s_nop 0
 buffer_load_dwordx4 v96, s[36:39], s48 offen offset:0 lds
 s_add_u32 s48, s48, 97280
 buffer_load_dwordx4 v96, s[36:39], s48 offen offset:1024 lds
 s_add_u32 s48, s48, 97280
 buffer_load_dwordx4 v96, s[36:39], s48 offen offset:2048 lds
 s_add_u32 s48, s48, 97280
 buffer_load_dwordx4 v96, s[36:39], s48 offen offset:3072 lds
 s_add_u32 s48, s50, 393216
 s_add_u32 m0, s66, 4096
 s_nop 0
 buffer_load_dwordx4 v96, s[36:39], s48 offen offset:0 lds
 s_add_u32 s48, s48, 97280
 buffer_load_dwordx4 v96, s[36:39], s48 offen offset:1024 lds
 s_add_u32 s48, s48, 97280
 buffer_load_dwordx4 v96, s[36:39], s48 offen offset:2048 lds
 s_add_u32 s48, s48, 97280
 buffer_load_dwordx4 v96, s[36:39], s48 offen offset:3072 lds
 s_add_u32 s48, s50, 786432
 s_add_u32 m0, s66, 8192
 s_nop 0
 buffer_load_dwordx4 v96, s[36:39], s48 offen offset:0 lds
 s_add_u32 s48, s48, 97280
 buffer_load_dwordx4 v96, s[36:39], s48 offen offset:1024 lds
 s_add_u32 s48, s48, 97280
 buffer_load_dwordx4 v96, s[36:39], s48 offen offset:2048 lds
 s_add_u32 s48, s48, 97280
 buffer_load_dwordx4 v96, s[36:39], s48 offen offset:3072 lds
 s_add_u32 s48, s50, 1179648
 s_add_u32 m0, s66, 12288
 s_nop 0
 buffer_load_dwordx4 v96, s[36:39], s48 offen offset:0 lds
 s_add_u32 s48, s48, 97280
 buffer_load_dwordx4 v96, s[36:39], s48 offen offset:1024 lds
 s_add_u32 s48, s48, 97280
 buffer_load_dwordx4 v96, s[36:39], s48 offen offset:2048 lds
 s_add_u32 s48, s48, 97280
 buffer_load_dwordx4 v96, s[36:39], s48 offen offset:3072 lds
 s_add_u32 s48, s50, 1024
 s_add_u32 m0, s66, 16384
 s_nop 0
 buffer_load_dwordx4 v96, s[36:39], s48 offen offset:0 lds
 s_add_u32 s48, s48, 97280
 buffer_load_dwordx4 v96, s[36:39], s48 offen offset:1024 lds
 s_add_u32 s48, s48, 97280
 buffer_load_dwordx4 v96, s[36:39], s48 offen offset:2048 lds
 s_add_u32 s48, s48, 97280
 buffer_load_dwordx4 v96, s[36:39], s48 offen offset:3072 lds
 s_add_u32 s48, s50, 394240
 s_add_u32 m0, s66, 20480
 s_nop 0
 buffer_load_dwordx4 v96, s[36:39], s48 offen offset:0 lds
 s_add_u32 s48, s48, 97280
 buffer_load_dwordx4 v96, s[36:39], s48 offen offset:1024 lds
 s_add_u32 s48, s48, 97280
 buffer_load_dwordx4 v96, s[36:39], s48 offen offset:2048 lds
 s_add_u32 s48, s48, 97280
 buffer_load_dwordx4 v96, s[36:39], s48 offen offset:3072 lds
 s_add_u32 s48, s50, 787456
 s_add_u32 m0, s66, 24576
 s_nop 0
 buffer_load_dwordx4 v96, s[36:39], s48 offen offset:0 lds
 s_add_u32 s48, s48, 97280
 buffer_load_dwordx4 v96, s[36:39], s48 offen offset:1024 lds
 s_add_u32 s48, s48, 97280
 buffer_load_dwordx4 v96, s[36:39], s48 offen offset:2048 lds
 s_add_u32 s48, s48, 97280
 buffer_load_dwordx4 v96, s[36:39], s48 offen offset:3072 lds
 s_add_u32 s48, s50, 1180672
 s_add_u32 m0, s66, 28672
 s_nop 0
 buffer_load_dwordx4 v96, s[36:39], s48 offen offset:0 lds
 s_add_u32 s48, s48, 97280
 buffer_load_dwordx4 v96, s[36:39], s48 offen offset:1024 lds
 s_add_u32 s48, s48, 97280
 buffer_load_dwordx4 v96, s[36:39], s48 offen offset:2048 lds
 s_add_u32 s48, s48, 97280
 buffer_load_dwordx4 v96, s[36:39], s48 offen offset:3072 lds
 s_waitcnt vmcnt(28)
 ds_read_b64_tr_b16 a[0:1], v97 offset:0
 ds_read_b64_tr_b16 a[2:3], v97 offset:128
 ds_read_b64_tr_b16 a[12:13], v97 offset:1024
 ds_read_b64_tr_b16 a[14:15], v97 offset:1152
 ds_read_b64_tr_b16 a[24:25], v97 offset:2048
 ds_read_b64_tr_b16 a[26:27], v97 offset:2176
 ds_read_b64_tr_b16 a[36:37], v97 offset:3072
 ds_read_b64_tr_b16 a[38:39], v97 offset:3200
 s_waitcnt lgkmcnt(0)
 s_add_u32 s48, s50, 2048
 s_add_u32 m0, s66, 0
 s_nop 0
 buffer_load_dwordx4 v96, s[36:39], s48 offen offset:0 lds
 s_add_u32 s48, s48, 97280
 buffer_load_dwordx4 v96, s[36:39], s48 offen offset:1024 lds
 s_add_u32 s48, s48, 97280
 buffer_load_dwordx4 v96, s[36:39], s48 offen offset:2048 lds
 s_add_u32 s48, s48, 97280
 buffer_load_dwordx4 v96, s[36:39], s48 offen offset:3072 lds
 s_waitcnt vmcnt(28)
 ds_read_b64_tr_b16 a[48:49], v97 offset:4096
 ds_read_b64_tr_b16 a[50:51], v97 offset:4224
 ds_read_b64_tr_b16 a[60:61], v97 offset:5120
 ds_read_b64_tr_b16 a[62:63], v97 offset:5248
 ds_read_b64_tr_b16 a[72:73], v97 offset:6144
 ds_read_b64_tr_b16 a[74:75], v97 offset:6272
 ds_read_b64_tr_b16 a[84:85], v97 offset:7168
 ds_read_b64_tr_b16 a[86:87], v97 offset:7296
 s_waitcnt lgkmcnt(0)
 s_add_u32 s48, s50, 395264
 s_add_u32 m0, s66, 4096
 s_nop 0
 buffer_load_dwordx4 v96, s[36:39], s48 offen offset:0 lds
 s_add_u32 s48, s48, 97280
 buffer_load_dwordx4 v96, s[36:39], s48 offen offset:1024 lds
 s_add_u32 s48, s48, 97280
 buffer_load_dwordx4 v96, s[36:39], s48 offen offset:2048 lds
 s_add_u32 s48, s48, 97280
 buffer_load_dwordx4 v96, s[36:39], s48 offen offset:3072 lds
 s_waitcnt vmcnt(28)
 ds_read_b64_tr_b16 a[96:97], v97 offset:8192
 ds_read_b64_tr_b16 a[98:99], v97 offset:8320
 ds_read_b64_tr_b16 a[108:109], v97 offset:9216
 ds_read_b64_tr_b16 a[110:111], v97 offset:9344
 ds_read_b64_tr_b16 a[120:121], v97 offset:10240
 ds_read_b64_tr_b16 a[122:123], v97 offset:10368
 ds_read_b64_tr_b16 a[132:133], v97 offset:11264
 ds_read_b64_tr_b16 a[134:135], v97 offset:11392
 s_waitcnt lgkmcnt(0)
 s_add_u32 s48, s50, 788480
 s_add_u32 m0, s66, 8192
 s_nop 0
 buffer_load_dwordx4 v96, s[36:39], s48 offen offset:0 lds
 s_add_u32 s48, s48, 97280
 buffer_load_dwordx4 v96, s[36:39], s48 offen offset:1024 lds
 s_add_u32 s48, s48, 97280
 buffer_load_dwordx4 v96, s[36:39], s48 offen offset:2048 lds
 s_add_u32 s48, s48, 97280
 buffer_load_dwordx4 v96, s[36:39], s48 offen offset:3072 lds
 s_waitcnt vmcnt(28)
 ds_read_b64_tr_b16 a[144:145], v97 offset:12288
 ds_read_b64_tr_b16 a[146:147], v97 offset:12416
 ds_read_b64_tr_b16 a[156:157], v97 offset:13312
 ds_read_b64_tr_b16 a[158:159], v97 offset:13440
 ds_read_b64_tr_b16 a[168:169], v97 offset:14336
 ds_read_b64_tr_b16 a[170:171], v97 offset:14464
 ds_read_b64_tr_b16 a[180:181], v97 offset:15360
 ds_read_b64_tr_b16 a[182:183], v97 offset:15488
 s_waitcnt lgkmcnt(0)
 s_add_u32 s48, s50, 1181696
 s_add_u32 m0, s66, 12288
 s_nop 0
 buffer_load_dwordx4 v96, s[36:39], s48 offen offset:0 lds
 s_add_u32 s48, s48, 97280
 buffer_load_dwordx4 v96, s[36:39], s48 offen offset:1024 lds
 s_add_u32 s48, s48, 97280
 buffer_load_dwordx4 v96, s[36:39], s48 offen offset:2048 lds
 s_add_u32 s48, s48, 97280
 buffer_load_dwordx4 v96, s[36:39], s48 offen offset:3072 lds
 s_waitcnt vmcnt(28)
 ds_read_b64_tr_b16 a[4:5], v97 offset:16384
 ds_read_b64_tr_b16 a[6:7], v97 offset:16512
 ds_read_b64_tr_b16 a[16:17], v97 offset:17408
 ds_read_b64_tr_b16 a[18:19], v97 offset:17536
 ds_read_b64_tr_b16 a[28:29], v97 offset:18432
 ds_read_b64_tr_b16 a[30:31], v97 offset:18560
 ds_read_b64_tr_b16 a[40:41], v97 offset:19456
 ds_read_b64_tr_b16 a[42:43], v97 offset:19584
 s_waitcnt lgkmcnt(0)
 s_waitcnt vmcnt(24)
 ds_read_b64_tr_b16 a[52:53], v97 offset:20480
 ds_read_b64_tr_b16 a[54:55], v97 offset:20608
 ds_read_b64_tr_b16 a[64:65], v97 offset:21504
 ds_read_b64_tr_b16 a[66:67], v97 offset:21632
 ds_read_b64_tr_b16 a[76:77], v97 offset:22528
 ds_read_b64_tr_b16 a[78:79], v97 offset:22656
 ds_read_b64_tr_b16 a[88:89], v97 offset:23552
 ds_read_b64_tr_b16 a[90:91], v97 offset:23680
 s_waitcnt lgkmcnt(0)
 s_waitcnt vmcnt(20)
 ds_read_b64_tr_b16 a[100:101], v97 offset:24576
 ds_read_b64_tr_b16 a[102:103], v97 offset:24704
 ds_read_b64_tr_b16 a[112:113], v97 offset:25600
 ds_read_b64_tr_b16 a[114:115], v97 offset:25728
 ds_read_b64_tr_b16 a[124:125], v97 offset:26624
 ds_read_b64_tr_b16 a[126:127], v97 offset:26752
 ds_read_b64_tr_b16 a[136:137], v97 offset:27648
 ds_read_b64_tr_b16 a[138:139], v97 offset:27776
 s_waitcnt lgkmcnt(0)
 s_waitcnt vmcnt(16)
 ds_read_b64_tr_b16 a[148:149], v97 offset:28672
 ds_read_b64_tr_b16 a[150:151], v97 offset:28800
 ds_read_b64_tr_b16 a[160:161], v97 offset:29696
 ds_read_b64_tr_b16 a[162:163], v97 offset:29824
 ds_read_b64_tr_b16 a[172:173], v97 offset:30720
 ds_read_b64_tr_b16 a[174:175], v97 offset:30848
 ds_read_b64_tr_b16 a[184:185], v97 offset:31744
 ds_read_b64_tr_b16 a[186:187], v97 offset:31872
 s_waitcnt lgkmcnt(0)
 s_waitcnt vmcnt(12)
 ds_read_b64_tr_b16 a[8:9], v97 offset:0
 ds_read_b64_tr_b16 a[10:11], v97 offset:128
 ds_read_b64_tr_b16 a[20:21], v97 offset:1024
 ds_read_b64_tr_b16 a[22:23], v97 offset:1152
 ds_read_b64_tr_b16 a[32:33], v97 offset:2048
 ds_read_b64_tr_b16 a[34:35], v97 offset:2176
 ds_read_b64_tr_b16 a[44:45], v97 offset:3072
 ds_read_b64_tr_b16 a[46:47], v97 offset:3200
 s_waitcnt lgkmcnt(0)
 s_waitcnt vmcnt(8)
 ds_read_b64_tr_b16 a[56:57], v97 offset:4096
 ds_read_b64_tr_b16 a[58:59], v97 offset:4224
 ds_read_b64_tr_b16 a[68:69], v97 offset:5120
 ds_read_b64_tr_b16 a[70:71], v97 offset:5248
 ds_read_b64_tr_b16 a[80:81], v97 offset:6144
 ds_read_b64_tr_b16 a[82:83], v97 offset:6272
 ds_read_b64_tr_b16 a[92:93], v97 offset:7168
 ds_read_b64_tr_b16 a[94:95], v97 offset:7296
 s_waitcnt lgkmcnt(0)
 s_waitcnt vmcnt(4)
 ds_read_b64_tr_b16 a[104:105], v97 offset:8192
 ds_read_b64_tr_b16 a[106:107], v97 offset:8320
 ds_read_b64_tr_b16 a[116:117], v97 offset:9216
 ds_read_b64_tr_b16 a[118:119], v97 offset:9344
 ds_read_b64_tr_b16 a[128:129], v97 offset:10240
 ds_read_b64_tr_b16 a[130:131], v97 offset:10368
 ds_read_b64_tr_b16 a[140:141], v97 offset:11264
 ds_read_b64_tr_b16 a[142:143], v97 offset:11392
 s_waitcnt lgkmcnt(0)
 s_waitcnt vmcnt(0)
 ds_read_b64_tr_b16 a[152:153], v97 offset:12288
 ds_read_b64_tr_b16 a[154:155], v97 offset:12416
 ds_read_b64_tr_b16 a[164:165], v97 offset:13312
 ds_read_b64_tr_b16 a[166:167], v97 offset:13440
 ds_read_b64_tr_b16 a[176:177], v97 offset:14336
 ds_read_b64_tr_b16 a[178:179], v97 offset:14464
 ds_read_b64_tr_b16 a[188:189], v97 offset:15360
 ds_read_b64_tr_b16 a[190:191], v97 offset:15488
 s_waitcnt lgkmcnt(0)
 v_and_b32 v4, 7, v0
 v_lshlrev_b32 v4, 2, v4
 v_add_u32 v4, 128, v4
 v_lshrrev_b32 v2, 4, v0
 v_lshlrev_b32 v2, 9, v2
 v_and_b32 v8, 15, v0
 v_lshl_add_u32 v8, v8, 4, v2
 v_mov_b32 v7, 0xcf6e6b28
 s_mov_b32 s96, 0x3eb8aa3b
 s_mov_b32 s97, s96
 v_and_b32 v96, 15, v0
 v_lshrrev_b32 v97, 4, v0
 v_lshlrev_b32 v97, 2, v97
 v_add_u32 v98, 0, v97
 v_add_u32 v99, 9, v96
 v_cmp_ge_u32 s[76:77], v98, v99
 v_sub_u32 v99, v96, v98
 v_cmp_ge_u32 s[84:85], 7, v99
 v_add_u32 v98, 1, v97
 v_add_u32 v99, 9, v96
 v_cmp_ge_u32 s[78:79], v98, v99
 v_sub_u32 v99, v96, v98
 v_cmp_ge_u32 s[86:87], 7, v99
 v_add_u32 v98, 2, v97
 v_add_u32 v99, 9, v96
 v_cmp_ge_u32 s[80:81], v98, v99
 v_sub_u32 v99, v96, v98
 v_cmp_ge_u32 s[88:89], 7, v99
 v_add_u32 v98, 3, v97
 v_add_u32 v99, 9, v96
 v_cmp_ge_u32 s[82:83], v98, v99
 v_sub_u32 v99, v96, v98
 v_cmp_ge_u32 s[90:91], 7, v99
 v_mov_b32 v16, 0
 v_mov_b32 v17, 0
 v_mov_b32 v18, 0
 v_mov_b32 v19, 0
 v_mov_b32 v20, 0
 v_mov_b32 v21, 0
 v_mov_b32 v22, 0
 v_mov_b32 v23, 0
 v_mov_b32 v24, 0
 v_mov_b32 v25, 0
 v_mov_b32 v26, 0
 v_mov_b32 v27, 0
 v_mov_b32 v28, 0
 v_mov_b32 v29, 0
 v_mov_b32 v30, 0
 v_mov_b32 v31, 0
 s_mov_b32 s60, 0
 s_mov_b64 s[8:9], 0
 s_mov_b64 s[10:11], 0
 s_mov_b64 s[12:13], 0
 s_mov_b64 s[14:15], 0
 s_mul_i32 s48, s45, 49152
 s_mul_i32 s49, s46, 12288
 s_add_u32 s48, s48, s49
 s_add_u32 s48, s48, s94
 buffer_load_dwordx4 v[100:103], v1, s[32:35], s48 offen offset:0 sc1
 buffer_load_dwordx4 v[100:103], v1, s[32:35], s48 offen offset:1024 sc1
 buffer_load_dwordx4 v[100:103], v1, s[32:35], s48 offen offset:2048 sc1
 buffer_load_dwordx4 v[100:103], v1, s[32:35], s48 offen offset:3072 sc1
 s_add_u32 s48, s48, 4096
 buffer_load_dwordx4 v[100:103], v1, s[32:35], s48 offen offset:0 sc1
 buffer_load_dwordx4 v[100:103], v1, s[32:35], s48 offen offset:1024 sc1
 buffer_load_dwordx4 v[100:103], v1, s[32:35], s48 offen offset:2048 sc1
 buffer_load_dwordx4 v[100:103], v1, s[32:35], s48 offen offset:3072 sc1
 s_add_u32 s48, s48, 4096
 buffer_load_dwordx4 v[100:103], v1, s[32:35], s48 offen offset:0 sc1
 buffer_load_dwordx4 v[100:103], v1, s[32:35], s48 offen offset:1024 sc1
 buffer_load_dwordx4 v[100:103], v1, s[32:35], s48 offen offset:2048 sc1
 buffer_load_dwordx4 v[100:103], v1, s[32:35], s48 offen offset:3072 sc1
 s_waitcnt vmcnt(0)
 s_mov_b32 s30, 0
L_winit_164:
 v_mov_b32 v124, 0
 global_load_dword v125, v124, s[26:27] offset:192 sc1
L_wchk_166:
 s_add_u32 s30, s30, 1
 s_cmp_gt_u32 s30, 524288
 s_cbranch_scc1 L_exit
 s_waitcnt vmcnt(0)
 v_readfirstlane_b32 s54, v125
 s_nop 0
 s_cmp_lg_u32 s54, 0
 s_cbranch_scc1 L_wdone_165
 s_sleep 8
 s_branch L_winit_164
L_wdone_165:
 s_lshr_b32 s3, s54, s44
 s_and_b32 s3, s3, 1
 s_barrier
 s_lshl_b32 s48, s45, 12
 s_lshl_b32 s49, s46, 10
 s_add_u32 s48, s48, s49
 s_lshl_b32 s49, s47, 17
 s_add_u32 s48, s48, s49
 buffer_load_dwordx4 v[100:103], v1, s[32:35], s48 offen sc1
 s_waitcnt vmcnt(0)
 s_cmp_eq_u32 s3, 0
 s_cbranch_scc1 L_rc_G
L_rc_L:
 s_lshl_b32 s57, s55, 11
 s_add_u32 s93, s57, 2048
 s_cmp_lg_u32 s92, 0
 s_cbranch_scc1 L_pre_167
 s_mov_b32 s30, 0
L_pf_168:
 buffer_load_dword v2, v4, s[32:35], s57 offen sc1
 s_add_u32 s30, s30, 1
 s_cmp_gt_u32 s30, 524288
 s_cbranch_scc1 L_exit
 s_waitcnt vmcnt(0)
 v_cmp_eq_u32 vcc, 0, v2
 s_cbranch_vccz L_pfd_169
 s_sleep 1
 s_branch L_pf_168
L_pfd_169:
 s_and_b32 s58, s55, 7
 s_lshl_b32 s58, s58, 17
 s_add_u32 s58, s58, s94
 s_add_u32 s58, s58, 0x88000
 s_mul_i32 s48, s46, 2048
 s_add_u32 s64, s58, s48
 s_add_u32 s95, s60, s48
 s_add_u32 m0, s95, 0
 s_add_u32 s65, s64, 0
 buffer_load_dwordx4 v1, s[32:35], s65 offen offset:0 sc1 lds
 buffer_load_dwordx4 v1, s[32:35], s65 offen offset:1024 sc1 lds
 s_add_u32 m0, s95, 8192
 s_add_u32 s65, s64, 8192
 buffer_load_dwordx4 v1, s[32:35], s65 offen offset:0 sc1 lds
 buffer_load_dwordx4 v1, s[32:35], s65 offen offset:1024 sc1 lds
L_pre_167:
 v_add_u32 v6, s60, v8
 s_xor_b32 s60, s60, 32768
 s_and_b32 s59, s55, 7
 s_lshl_b32 s59, s59, 17
 s_add_u32 s59, s59, s94
 s_add_u32 s59, s59, 0x90000
 s_lshl_b32 s48, s61, 10
 s_add_u32 s59, s59, s48
 s_lshl_b32 s48, s61, 2
 s_add_u32 s57, s57, s48
 s_waitcnt vmcnt(3)
 s_cmp_lg_u32 s75, 0
 s_cbranch_scc1 L_np_170
 s_waitcnt vmcnt(2)
L_np_170:
 s_barrier
 ds_read_b128 v[128:131], v6 offset:0
 ds_read_b128 v[132:135], v6 offset:256
 ds_read_b128 v[136:139], v6 offset:2048
 ds_read_b128 v[140:143], v6 offset:2304
 s_mov_b32 s92, 0
 s_waitcnt lgkmcnt(2)
 v_mfma_f32_16x16x32_bf16 v[56:59], a[0:3], v[128:131], 0
 ds_read_b128 v[144:147], v6 offset:4096
 ds_read_b128 v[148:151], v6 offset:4352
 v_mfma_f32_16x16x32_bf16 v[60:63], a[4:7], v[128:131], 0
 s_add_u32 m0, s95, 16384
 s_add_u32 s65, s64, 16384
 buffer_load_dwordx4 v1, s[32:35], s65 offen offset:0 sc1 lds
 v_mfma_f32_16x16x32_bf16 v[64:67], v[128:131], a[8:11], 0
 s_waitcnt lgkmcnt(2)
 v_mfma_f32_16x16x32_bf16 v[56:59], a[12:15], v[136:139], v[56:59]
 ds_read_b128 v[152:155], v6 offset:6144
 ds_read_b128 v[156:159], v6 offset:6400
 v_mfma_f32_16x16x32_bf16 v[60:63], a[16:19], v[136:139], v[60:63]
 buffer_load_dwordx4 v1, s[32:35], s65 offen offset:1024 sc1 lds
 v_mfma_f32_16x16x32_bf16 v[64:67], v[136:139], a[20:23], v[64:67]
 s_waitcnt vmcnt(2)
 s_cmp_eq_u32 s75, 0
 s_cbranch_scc1 L_np_171
 s_mov_b64 exec, 1
 buffer_store_dword v5, off, s[32:35], s67 offset:256
 s_mov_b64 exec, -1
L_np_171:
 s_barrier
 s_waitcnt lgkmcnt(2)
 v_mfma_f32_16x16x32_bf16 v[56:59], a[24:27], v[144:147], v[56:59]
 ds_read_b128 v[160:163], v6 offset:8192
 ds_read_b128 v[164:167], v6 offset:8448
 v_mfma_f32_16x16x32_bf16 v[60:63], a[28:31], v[144:147], v[60:63]
 s_add_u32 m0, s95, 24576
 s_add_u32 s65, s64, 24576
 buffer_load_dwordx4 v1, s[32:35], s65 offen offset:0 sc1 lds
 v_mfma_f32_16x16x32_bf16 v[64:67], v[144:147], a[32:35], v[64:67]
 s_waitcnt lgkmcnt(2)
 v_mfma_f32_16x16x32_bf16 v[56:59], a[36:39], v[152:155], v[56:59]
 ds_read_b128 v[168:171], v6 offset:10240
 ds_read_b128 v[172:175], v6 offset:10496
 v_mfma_f32_16x16x32_bf16 v[60:63], a[40:43], v[152:155], v[60:63]
 buffer_load_dwordx4 v1, s[32:35], s65 offen offset:1024 sc1 lds
 v_mfma_f32_16x16x32_bf16 v[64:67], v[152:155], a[44:47], v[64:67]
 s_waitcnt lgkmcnt(2)
 v_mfma_f32_16x16x32_bf16 v[56:59], a[48:51], v[160:163], v[56:59]
 ds_read_b128 v[176:179], v6 offset:12288
 ds_read_b128 v[180:183], v6 offset:12544
 v_mfma_f32_16x16x32_bf16 v[60:63], a[52:55], v[160:163], v[60:63]
 v_mfma_f32_16x16x32_bf16 v[64:67], v[160:163], a[56:59], v[64:67]
 s_waitcnt lgkmcnt(2)
 v_mfma_f32_16x16x32_bf16 v[56:59], a[60:63], v[168:171], v[56:59]
 ds_read_b128 v[184:187], v6 offset:14336
 ds_read_b128 v[188:191], v6 offset:14592
 v_mfma_f32_16x16x32_bf16 v[60:63], a[64:67], v[168:171], v[60:63]
 v_mfma_f32_16x16x32_bf16 v[64:67], v[168:171], a[68:71], v[64:67]
 s_waitcnt vmcnt(2)
 s_barrier
 s_waitcnt lgkmcnt(2)
 v_mfma_f32_16x16x32_bf16 v[56:59], a[72:75], v[176:179], v[56:59]
 ds_read_b128 v[192:195], v6 offset:16384
 ds_read_b128 v[196:199], v6 offset:16640
 v_mfma_f32_16x16x32_bf16 v[60:63], a[76:79], v[176:179], v[60:63]
 v_mfma_f32_16x16x32_bf16 v[64:67], v[176:179], a[80:83], v[64:67]
 s_waitcnt lgkmcnt(2)
 v_mfma_f32_16x16x32_bf16 v[56:59], a[84:87], v[184:187], v[56:59]
 ds_read_b128 v[200:203], v6 offset:18432
 ds_read_b128 v[204:207], v6 offset:18688
 v_mfma_f32_16x16x32_bf16 v[60:63], a[88:91], v[184:187], v[60:63]
 v_mfma_f32_16x16x32_bf16 v[64:67], v[184:187], a[92:95], v[64:67]
 s_waitcnt lgkmcnt(2)
 v_mfma_f32_16x16x32_bf16 v[56:59], a[96:99], v[192:195], v[56:59]
 ds_read_b128 v[208:211], v6 offset:20480
 ds_read_b128 v[212:215], v6 offset:20736
 v_mfma_f32_16x16x32_bf16 v[60:63], a[100:103], v[192:195], v[60:63]
 v_mfma_f32_16x16x32_bf16 v[64:67], v[192:195], a[104:107], v[64:67]
 s_waitcnt lgkmcnt(2)
 v_mfma_f32_16x16x32_bf16 v[56:59], a[108:111], v[200:203], v[56:59]
 ds_read_b128 v[216:219], v6 offset:22528
 ds_read_b128 v[220:223], v6 offset:22784
 v_mfma_f32_16x16x32_bf16 v[60:63], a[112:115], v[200:203], v[60:63]
 v_mfma_f32_16x16x32_bf16 v[64:67], v[200:203], a[116:119], v[64:67]
 s_waitcnt vmcnt(0)
 s_barrier
 s_waitcnt lgkmcnt(2)
 v_mfma_f32_16x16x32_bf16 v[56:59], a[120:123], v[208:211], v[56:59]
 ds_read_b128 v[224:227], v6 offset:24576
 ds_read_b128 v[228:231], v6 offset:24832
 v_mfma_f32_16x16x32_bf16 v[60:63], a[124:127], v[208:211], v[60:63]
 v_mfma_f32_16x16x32_bf16 v[64:67], v[208:211], a[128:131], v[64:67]
 s_waitcnt lgkmcnt(2)
 v_mfma_f32_16x16x32_bf16 v[56:59], a[132:135], v[216:219], v[56:59]
 ds_read_b128 v[232:235], v6 offset:26624
 ds_read_b128 v[236:239], v6 offset:26880
 v_mfma_f32_16x16x32_bf16 v[60:63], a[136:139], v[216:219], v[60:63]
 v_mfma_f32_16x16x32_bf16 v[64:67], v[216:219], a[140:143], v[64:67]
 s_waitcnt lgkmcnt(2)
 v_mfma_f32_16x16x32_bf16 v[56:59], a[144:147], v[224:227], v[56:59]
 ds_read_b128 v[240:243], v6 offset:28672
 ds_read_b128 v[244:247], v6 offset:28928
 v_mfma_f32_16x16x32_bf16 v[60:63], a[148:151], v[224:227], v[60:63]
 v_mfma_f32_16x16x32_bf16 v[64:67], v[224:227], a[152:155], v[64:67]
 s_waitcnt lgkmcnt(2)
 v_mfma_f32_16x16x32_bf16 v[56:59], a[156:159], v[232:235], v[56:59]
 ds_read_b128 v[248:251], v6 offset:30720
 ds_read_b128 v[252:255], v6 offset:30976
 v_mfma_f32_16x16x32_bf16 v[60:63], a[160:163], v[232:235], v[60:63]
 v_mfma_f32_16x16x32_bf16 v[64:67], v[232:235], a[164:167], v[64:67]
 s_waitcnt lgkmcnt(2)
 v_mfma_f32_16x16x32_bf16 v[56:59], a[168:171], v[240:243], v[56:59]
 v_mfma_f32_16x16x32_bf16 v[60:63], a[172:175], v[240:243], v[60:63]
 v_mfma_f32_16x16x32_bf16 v[64:67], v[240:243], a[176:179], v[64:67]
 s_waitcnt lgkmcnt(0)
 v_mfma_f32_16x16x32_bf16 v[56:59], a[180:183], v[248:251], v[56:59]
 v_mfma_f32_16x16x32_bf16 v[60:63], a[184:187], v[248:251], v[60:63]
 v_mfma_f32_16x16x32_bf16 v[64:67], v[248:251], a[188:191], v[64:67]
 v_mfma_f32_16x16x32_bf16 v[68:71], a[0:3], v[132:135], 0
 v_mfma_f32_16x16x32_bf16 v[72:75], a[4:7], v[132:135], 0
 s_nop 2
 s_nop 0
 v_cvt_pk_bf16_f32 v80, v56, v57
 v_mfma_f32_16x16x32_bf16 v[68:71], a[12:15], v[140:143], v[68:71]
 v_cvt_pk_bf16_f32 v81, v58, v59
 v_cvt_pk_bf16_f32 v18, v60, v61
 v_mfma_f32_16x16x32_bf16 v[72:75], a[16:19], v[140:143], v[72:75]
 v_cvt_pk_bf16_f32 v19, v62, v63
 v_mfma_f32_16x16x32_bf16 v[68:71], a[24:27], v[148:151], v[68:71]
 v_mfma_f32_16x16x16_bf16 v[96:99], v[16:17], v[80:81], 0
 v_mfma_f32_16x16x16_bf16 v[100:103], v[18:19], v[80:81], 0
 v_mfma_f32_16x16x32_bf16 v[72:75], a[28:31], v[148:151], v[72:75]
 v_mov_b64 v[16:17], v[18:19]
 v_mfma_f32_16x16x32_bf16 v[68:71], a[36:39], v[156:159], v[68:71]
 s_nop 3
 v_cndmask_b32 v96, v7, v96, s[8:9]
 v_mfma_f32_16x16x32_bf16 v[72:75], a[40:43], v[156:159], v[72:75]
 v_cndmask_b32 v97, v7, v97, s[10:11]
 v_cndmask_b32 v98, v7, v98, s[12:13]
 v_mfma_f32_16x16x32_bf16 v[68:71], a[48:51], v[164:167], v[68:71]
 v_cndmask_b32 v99, v7, v99, s[14:15]
 v_cndmask_b32 v100, v7, v100, s[84:85]
 v_mfma_f32_16x16x32_bf16 v[72:75], a[52:55], v[164:167], v[72:75]
 v_cndmask_b32 v101, v7, v101, s[86:87]
 v_cndmask_b32 v102, v7, v102, s[88:89]
 v_mfma_f32_16x16x32_bf16 v[68:71], a[60:63], v[172:175], v[68:71]
 v_cndmask_b32 v103, v7, v103, s[90:91]
 v_max3_f32 v92, v96, v97, v98
 v_mfma_f32_16x16x32_bf16 v[72:75], a[64:67], v[172:175], v[72:75]
 v_max3_f32 v92, v92, v99, v100
 v_max3_f32 v92, v92, v101, v102
 v_mfma_f32_16x16x32_bf16 v[68:71], a[72:75], v[180:183], v[68:71]
 v_max_f32 v92, v92, v103
 v_mov_b32 v93, v92
 v_mfma_f32_16x16x32_bf16 v[72:75], a[76:79], v[180:183], v[72:75]
 s_nop 0
 v_permlane16_swap_b32 v92, v93
 v_mfma_f32_16x16x32_bf16 v[68:71], a[84:87], v[188:191], v[68:71]
 v_max_f32 v92, v92, v93
 v_mov_b32 v93, v92
 v_mfma_f32_16x16x32_bf16 v[72:75], a[88:91], v[188:191], v[72:75]
 s_nop 0
 v_permlane32_swap_b32 v92, v93
 v_mfma_f32_16x16x32_bf16 v[68:71], a[96:99], v[196:199], v[68:71]
 v_max_f32 v92, v92, v93
 v_mul_f32 v92, s96, v92
 v_mfma_f32_16x16x32_bf16 v[72:75], a[100:103], v[196:199], v[72:75]
 v_fma_f32 v96, v96, s96, -v92
 v_fma_f32 v97, v97, s96, -v92
 v_mfma_f32_16x16x32_bf16 v[68:71], a[108:111], v[204:207], v[68:71]
 v_fma_f32 v98, v98, s96, -v92
 v_fma_f32 v99, v99, s96, -v92
 v_mfma_f32_16x16x32_bf16 v[72:75], a[112:115], v[204:207], v[72:75]
 v_fma_f32 v100, v100, s96, -v92
 v_fma_f32 v101, v101, s96, -v92
 v_mfma_f32_16x16x32_bf16 v[68:71], a[120:123], v[212:215], v[68:71]
 v_fma_f32 v102, v102, s96, -v92
 v_fma_f32 v103, v103, s96, -v92
 v_mfma_f32_16x16x32_bf16 v[72:75], a[124:127], v[212:215], v[72:75]
 v_exp_f32 v96, v96
 v_exp_f32 v97, v97
 v_mfma_f32_16x16x32_bf16 v[68:71], a[132:135], v[220:223], v[68:71]
 v_exp_f32 v98, v98
 v_exp_f32 v99, v99
 v_mfma_f32_16x16x32_bf16 v[72:75], a[136:139], v[220:223], v[72:75]
 v_exp_f32 v100, v100
 v_exp_f32 v101, v101
 v_mfma_f32_16x16x32_bf16 v[68:71], a[144:147], v[228:231], v[68:71]
 v_exp_f32 v102, v102
 v_exp_f32 v103, v103
 v_mfma_f32_16x16x32_bf16 v[72:75], a[148:151], v[228:231], v[72:75]
 v_cvt_pk_bf16_f32 v84, v96, v97
 v_cvt_pk_bf16_f32 v85, v98, v99
 v_mfma_f32_16x16x32_bf16 v[68:71], a[156:159], v[236:239], v[68:71]
 v_cvt_pk_bf16_f32 v86, v100, v101
 v_cvt_pk_bf16_f32 v87, v102, v103
 v_mfma_f32_16x16x32_bf16 v[72:75], a[160:163], v[236:239], v[72:75]
 v_cvt_pk_bf16_f32 v26, v64, v65
 v_cvt_pk_bf16_f32 v27, v66, v67
 v_mfma_f32_16x16x32_bf16 v[68:71], a[168:171], v[244:247], v[68:71]
 v_mfma_f32_16x16x32_bf16 v[72:75], a[172:175], v[244:247], v[72:75]
 v_mfma_f32_16x16x32_bf16 v[68:71], a[180:183], v[252:255], v[68:71]
 v_mfma_f32_16x16x32_bf16 v[72:75], a[184:187], v[252:255], v[72:75]
 buffer_load_dword v13, v4, s[32:35], s93 offen sc1
 v_mfma_f32_16x16x32_bf16 v[112:115], v[24:27], v[84:87], 0
 v_add_f32 v96, v96, v100
 v_add_f32 v97, v97, v101
 v_add_f32 v98, v98, v102
 v_mfma_f32_16x16x32_bf16 v[76:79], v[132:135], a[8:11], 0
 s_nop 0
 v_cvt_pk_bf16_f32 v82, v68, v69
 v_cvt_pk_bf16_f32 v83, v70, v71
 v_cvt_pk_bf16_f32 v22, v72, v73
 v_mfma_f32_16x16x32_bf16 v[76:79], v[140:143], a[20:23], v[76:79]
 v_cvt_pk_bf16_f32 v23, v74, v75
 v_mfma_f32_16x16x16_bf16 v[104:107], v[20:21], v[82:83], 0
 v_mfma_f32_16x16x32_bf16 v[76:79], v[148:151], a[32:35], v[76:79]
 v_mfma_f32_16x16x16_bf16 v[108:111], v[22:23], v[82:83], 0
 v_mov_b64 v[20:21], v[22:23]
 v_mfma_f32_16x16x32_bf16 v[76:79], v[156:159], a[44:47], v[76:79]
 s_nop 3
 v_cndmask_b32 v104, v7, v104, s[8:9]
 v_cndmask_b32 v105, v7, v105, s[10:11]
 v_mfma_f32_16x16x32_bf16 v[76:79], v[164:167], a[56:59], v[76:79]
 v_cndmask_b32 v106, v7, v106, s[12:13]
 v_cndmask_b32 v107, v7, v107, s[14:15]
 v_cndmask_b32 v108, v7, v108, s[84:85]
 v_mfma_f32_16x16x32_bf16 v[76:79], v[172:175], a[68:71], v[76:79]
 v_cndmask_b32 v109, v7, v109, s[86:87]
 v_cndmask_b32 v110, v7, v110, s[88:89]
 v_cndmask_b32 v111, v7, v111, s[90:91]
 v_mfma_f32_16x16x32_bf16 v[76:79], v[180:183], a[80:83], v[76:79]
 v_max3_f32 v94, v104, v105, v106
 v_max3_f32 v94, v94, v107, v108
 v_max3_f32 v94, v94, v109, v110
 v_mfma_f32_16x16x32_bf16 v[76:79], v[188:191], a[92:95], v[76:79]
 v_max_f32 v94, v94, v111
 v_mov_b32 v95, v94
 v_mfma_f32_16x16x32_bf16 v[76:79], v[196:199], a[104:107], v[76:79]
 s_nop 0
 v_permlane16_swap_b32 v94, v95
 v_max_f32 v94, v94, v95
 v_mov_b32 v95, v94
 v_mfma_f32_16x16x32_bf16 v[76:79], v[204:207], a[116:119], v[76:79]
 s_nop 0
 v_permlane32_swap_b32 v94, v95
 v_max_f32 v94, v94, v95
 v_mfma_f32_16x16x32_bf16 v[76:79], v[212:215], a[128:131], v[76:79]
 v_mul_f32 v94, s96, v94
 v_fma_f32 v104, v104, s96, -v94
 v_fma_f32 v105, v105, s96, -v94
 v_mfma_f32_16x16x32_bf16 v[76:79], v[220:223], a[140:143], v[76:79]
 v_fma_f32 v106, v106, s96, -v94
 v_fma_f32 v107, v107, s96, -v94
 v_fma_f32 v108, v108, s96, -v94
 v_mfma_f32_16x16x32_bf16 v[76:79], v[228:231], a[152:155], v[76:79]
 v_fma_f32 v109, v109, s96, -v94
 v_fma_f32 v110, v110, s96, -v94
 v_fma_f32 v111, v111, s96, -v94
 v_mfma_f32_16x16x32_bf16 v[76:79], v[236:239], a[164:167], v[76:79]
 v_exp_f32 v104, v104
 v_exp_f32 v105, v105
 v_exp_f32 v106, v106
 v_mfma_f32_16x16x32_bf16 v[76:79], v[244:247], a[176:179], v[76:79]
 v_exp_f32 v107, v107
 v_exp_f32 v108, v108
 v_exp_f32 v109, v109
 v_mfma_f32_16x16x32_bf16 v[76:79], v[252:255], a[188:191], v[76:79]
 v_exp_f32 v110, v110
 v_exp_f32 v111, v111
 v_cvt_pk_bf16_f32 v88, v104, v105
 v_cvt_pk_bf16_f32 v89, v106, v107
 v_cvt_pk_bf16_f32 v90, v108, v109
 v_cvt_pk_bf16_f32 v91, v110, v111
 s_nop 0
 s_nop 0
 v_cvt_pk_bf16_f32 v30, v76, v77
 v_cvt_pk_bf16_f32 v31, v78, v79
 v_add_f32 v99, v99, v103
 v_add_f32 v96, v96, v98
 v_add_f32 v97, v97, v99
 v_add_f32 v92, v96, v97
 v_mfma_f32_16x16x32_bf16 v[116:119], v[28:31], v[88:91], 0
 v_add_f32 v104, v104, v108
 v_add_f32 v105, v105, v109
 v_add_f32 v106, v106, v110
 v_add_f32 v107, v107, v111
 v_add_f32 v104, v104, v106
 v_add_f32 v105, v105, v107
 v_add_f32 v94, v104, v105
 v_mov_b32 v93, v92
 v_mov_b32 v95, v94
 s_nop 0
 v_permlane16_swap_b32 v92, v93
 v_permlane16_swap_b32 v94, v95
 v_add_f32 v92, v92, v93
 v_add_f32 v94, v94, v95
 v_mov_b32 v93, v92
 v_mov_b32 v95, v94
 s_nop 0
 v_permlane32_swap_b32 v92, v93
 v_permlane32_swap_b32 v94, v95
 v_add_f32 v92, v92, v93
 v_add_f32 v94, v94, v95
 v_rcp_f32 v92, v92
 v_rcp_f32 v94, v94
 v_mov_b64 v[24:25], v[26:27]
 v_mov_b64 v[28:29], v[30:31]
 s_mov_b64 s[8:9], s[76:77]
 s_mov_b64 s[10:11], s[78:79]
 s_mov_b64 s[12:13], s[80:81]
 s_mov_b64 s[14:15], s[82:83]
 s_nop 0
 v_pk_mul_f32 v[112:113], v[112:113], v[92:93] op_sel_hi:[1,0]
 v_pk_mul_f32 v[114:115], v[114:115], v[92:93] op_sel_hi:[1,0]
 v_pk_mul_f32 v[116:117], v[116:117], v[94:95] op_sel_hi:[1,0]
 v_pk_mul_f32 v[118:119], v[118:119], v[94:95] op_sel_hi:[1,0]
 v_cvt_pk_bf16_f32 v80, v112, v113
 v_cvt_pk_bf16_f32 v81, v114, v115
 v_cvt_pk_bf16_f32 v82, v116, v117
 v_cvt_pk_bf16_f32 v83, v118, v119
 s_nop 0
 v_permlane16_swap_b32 v80, v82
 v_permlane16_swap_b32 v81, v83
 buffer_store_dwordx4 v[80:83], v1, s[32:35], s59 offen
 s_mov_b32 s67, s57
 s_mov_b32 s75, s92
 s_cmp_lg_u32 s92, 0
 s_cbranch_scc1 L_fin_174
 s_waitcnt vmcnt(1)
 v_cmp_eq_u32 vcc, 0, v13
 s_add_u32 s50, s55, 1
 s_cmp_ge_u32 s50, s56
 s_cbranch_scc1 L_noE_172
 s_cbranch_vccnz L_noE_172
 s_and_b32 s58, s50, 7
 s_lshl_b32 s58, s58, 17
 s_add_u32 s58, s58, s94
 s_add_u32 s58, s58, 0x88000
 s_mul_i32 s48, s46, 2048
 s_add_u32 s64, s58, s48
 s_add_u32 s95, s60, s48
 s_add_u32 m0, s95, 0
 s_add_u32 s65, s64, 0
 buffer_load_dwordx4 v1, s[32:35], s65 offen offset:0 sc1 lds
 buffer_load_dwordx4 v1, s[32:35], s65 offen offset:1024 sc1 lds
 s_add_u32 m0, s95, 8192
 s_add_u32 s65, s64, 8192
 buffer_load_dwordx4 v1, s[32:35], s65 offen offset:0 sc1 lds
 buffer_load_dwordx4 v1, s[32:35], s65 offen offset:1024 sc1 lds
 s_mov_b32 s92, 1
 s_waitcnt vmcnt(4)
 s_branch L_goE_173
L_noE_172:
 s_waitcnt vmcnt(0)
L_goE_173:
 s_mov_b64 exec, 1
 buffer_store_dword v5, off, s[32:35], s57 offset:256
 s_mov_b64 exec, -1
L_fin_174:
 s_add_u32 s55, s55, 1
 s_cmp_lt_u32 s55, s56
 s_cbranch_scc1 L_rc_L
 s_waitcnt vmcnt(0)
 s_branch L_done
L_rc_G:
 s_lshl_b32 s57, s55, 11
 s_add_u32 s93, s57, 2048
 s_cmp_lg_u32 s92, 0
 s_cbranch_scc1 L_pre_175
 s_mov_b32 s30, 0
L_pf_176:
 buffer_load_dword v2, v4, s[32:35], s57 offen sc1
 s_add_u32 s30, s30, 1
 s_cmp_gt_u32 s30, 524288
 s_cbranch_scc1 L_exit
 s_waitcnt vmcnt(0)
 v_cmp_eq_u32 vcc, 0, v2
 s_cbranch_vccz L_pfd_177
 s_sleep 1
 s_branch L_pf_176
L_pfd_177:
 s_and_b32 s58, s55, 7
 s_lshl_b32 s58, s58, 17
 s_add_u32 s58, s58, s94
 s_add_u32 s58, s58, 0x88000
 s_mul_i32 s48, s46, 2048
 s_add_u32 s64, s58, s48
 s_add_u32 s95, s60, s48
 s_add_u32 m0, s95, 0
 s_add_u32 s65, s64, 0
 buffer_load_dwordx4 v1, s[32:35], s65 offen offset:0 sc1 lds
 buffer_load_dwordx4 v1, s[32:35], s65 offen offset:1024 sc1 lds
 s_add_u32 m0, s95, 8192
 s_add_u32 s65, s64, 8192
 buffer_load_dwordx4 v1, s[32:35], s65 offen offset:0 sc1 lds
 buffer_load_dwordx4 v1, s[32:35], s65 offen offset:1024 sc1 lds
L_pre_175:
 v_add_u32 v6, s60, v8
 s_xor_b32 s60, s60, 32768
 s_and_b32 s59, s55, 7
 s_lshl_b32 s59, s59, 17
 s_add_u32 s59, s59, s94
 s_add_u32 s59, s59, 0x90000
 s_lshl_b32 s48, s61, 10
 s_add_u32 s59, s59, s48
 s_lshl_b32 s48, s61, 2
 s_add_u32 s57, s57, s48
 s_waitcnt vmcnt(3)
 s_cmp_lg_u32 s75, 0
 s_cbranch_scc1 L_np_178
 s_waitcnt vmcnt(2)
L_np_178:
 s_barrier
 ds_read_b128 v[128:131], v6 offset:0
 ds_read_b128 v[132:135], v6 offset:256
 ds_read_b128 v[136:139], v6 offset:2048
 ds_read_b128 v[140:143], v6 offset:2304
 s_mov_b32 s92, 0
 s_waitcnt lgkmcnt(2)
 v_mfma_f32_16x16x32_bf16 v[56:59], a[0:3], v[128:131], 0
 ds_read_b128 v[144:147], v6 offset:4096
 ds_read_b128 v[148:151], v6 offset:4352
 v_mfma_f32_16x16x32_bf16 v[60:63], a[4:7], v[128:131], 0
 s_add_u32 m0, s95, 16384
 s_add_u32 s65, s64, 16384
 buffer_load_dwordx4 v1, s[32:35], s65 offen offset:0 sc1 lds
 v_mfma_f32_16x16x32_bf16 v[64:67], v[128:131], a[8:11], 0
 s_waitcnt lgkmcnt(2)
 v_mfma_f32_16x16x32_bf16 v[56:59], a[12:15], v[136:139], v[56:59]
 ds_read_b128 v[152:155], v6 offset:6144
 ds_read_b128 v[156:159], v6 offset:6400
 v_mfma_f32_16x16x32_bf16 v[60:63], a[16:19], v[136:139], v[60:63]
 buffer_load_dwordx4 v1, s[32:35], s65 offen offset:1024 sc1 lds
 v_mfma_f32_16x16x32_bf16 v[64:67], v[136:139], a[20:23], v[64:67]
 s_waitcnt vmcnt(2)
 s_cmp_eq_u32 s75, 0
 s_cbranch_scc1 L_np_179
 s_mov_b64 exec, 1
 buffer_store_dword v5, off, s[32:35], s67 offset:256 sc1
 s_mov_b64 exec, -1
L_np_179:
 s_barrier
 s_waitcnt lgkmcnt(2)
 v_mfma_f32_16x16x32_bf16 v[56:59], a[24:27], v[144:147], v[56:59]
 ds_read_b128 v[160:163], v6 offset:8192
 ds_read_b128 v[164:167], v6 offset:8448
 v_mfma_f32_16x16x32_bf16 v[60:63], a[28:31], v[144:147], v[60:63]
 s_add_u32 m0, s95, 24576
 s_add_u32 s65, s64, 24576
 buffer_load_dwordx4 v1, s[32:35], s65 offen offset:0 sc1 lds
 v_mfma_f32_16x16x32_bf16 v[64:67], v[144:147], a[32:35], v[64:67]
 s_waitcnt lgkmcnt(2)
 v_mfma_f32_16x16x32_bf16 v[56:59], a[36:39], v[152:155], v[56:59]
 ds_read_b128 v[168:171], v6 offset:10240
 ds_read_b128 v[172:175], v6 offset:10496
 v_mfma_f32_16x16x32_bf16 v[60:63], a[40:43], v[152:155], v[60:63]
 buffer_load_dwordx4 v1, s[32:35], s65 offen offset:1024 sc1 lds
 v_mfma_f32_16x16x32_bf16 v[64:67], v[152:155], a[44:47], v[64:67]
 s_waitcnt lgkmcnt(2)
 v_mfma_f32_16x16x32_bf16 v[56:59], a[48:51], v[160:163], v[56:59]
 ds_read_b128 v[176:179], v6 offset:12288
 ds_read_b128 v[180:183], v6 offset:12544
 v_mfma_f32_16x16x32_bf16 v[60:63], a[52:55], v[160:163], v[60:63]
 v_mfma_f32_16x16x32_bf16 v[64:67], v[160:163], a[56:59], v[64:67]
 s_waitcnt lgkmcnt(2)
 v_mfma_f32_16x16x32_bf16 v[56:59], a[60:63], v[168:171], v[56:59]
 ds_read_b128 v[184:187], v6 offset:14336
 ds_read_b128 v[188:191], v6 offset:14592
 v_mfma_f32_16x16x32_bf16 v[60:63], a[64:67], v[168:171], v[60:63]
 v_mfma_f32_16x16x32_bf16 v[64:67], v[168:171], a[68:71], v[64:67]
 s_waitcnt vmcnt(2)
 s_barrier
 s_waitcnt lgkmcnt(2)
 v_mfma_f32_16x16x32_bf16 v[56:59], a[72:75], v[176:179], v[56:59]
 ds_read_b128 v[192:195], v6 offset:16384
 ds_read_b128 v[196:199], v6 offset:16640
 v_mfma_f32_16x16x32_bf16 v[60:63], a[76:79], v[176:179], v[60:63]
 v_mfma_f32_16x16x32_bf16 v[64:67], v[176:179], a[80:83], v[64:67]
 s_waitcnt lgkmcnt(2)
 v_mfma_f32_16x16x32_bf16 v[56:59], a[84:87], v[184:187], v[56:59]
 ds_read_b128 v[200:203], v6 offset:18432
 ds_read_b128 v[204:207], v6 offset:18688
 v_mfma_f32_16x16x32_bf16 v[60:63], a[88:91], v[184:187], v[60:63]
 v_mfma_f32_16x16x32_bf16 v[64:67], v[184:187], a[92:95], v[64:67]
 s_waitcnt lgkmcnt(2)
 v_mfma_f32_16x16x32_bf16 v[56:59], a[96:99], v[192:195], v[56:59]
 ds_read_b128 v[208:211], v6 offset:20480
 ds_read_b128 v[212:215], v6 offset:20736
 v_mfma_f32_16x16x32_bf16 v[60:63], a[100:103], v[192:195], v[60:63]
 v_mfma_f32_16x16x32_bf16 v[64:67], v[192:195], a[104:107], v[64:67]
 s_waitcnt lgkmcnt(2)
 v_mfma_f32_16x16x32_bf16 v[56:59], a[108:111], v[200:203], v[56:59]
 ds_read_b128 v[216:219], v6 offset:22528
 ds_read_b128 v[220:223], v6 offset:22784
 v_mfma_f32_16x16x32_bf16 v[60:63], a[112:115], v[200:203], v[60:63]
 v_mfma_f32_16x16x32_bf16 v[64:67], v[200:203], a[116:119], v[64:67]
 s_waitcnt vmcnt(0)
 s_barrier
 s_waitcnt lgkmcnt(2)
 v_mfma_f32_16x16x32_bf16 v[56:59], a[120:123], v[208:211], v[56:59]
 ds_read_b128 v[224:227], v6 offset:24576
 ds_read_b128 v[228:231], v6 offset:24832
 v_mfma_f32_16x16x32_bf16 v[60:63], a[124:127], v[208:211], v[60:63]
 v_mfma_f32_16x16x32_bf16 v[64:67], v[208:211], a[128:131], v[64:67]
 s_waitcnt lgkmcnt(2)
 v_mfma_f32_16x16x32_bf16 v[56:59], a[132:135], v[216:219], v[56:59]
 ds_read_b128 v[232:235], v6 offset:26624
 ds_read_b128 v[236:239], v6 offset:26880
 v_mfma_f32_16x16x32_bf16 v[60:63], a[136:139], v[216:219], v[60:63]
 v_mfma_f32_16x16x32_bf16 v[64:67], v[216:219], a[140:143], v[64:67]
 s_waitcnt lgkmcnt(2)
 v_mfma_f32_16x16x32_bf16 v[56:59], a[144:147], v[224:227], v[56:59]
 ds_read_b128 v[240:243], v6 offset:28672
 ds_read_b128 v[244:247], v6 offset:28928
 v_mfma_f32_16x16x32_bf16 v[60:63], a[148:151], v[224:227], v[60:63]
 v_mfma_f32_16x16x32_bf16 v[64:67], v[224:227], a[152:155], v[64:67]
 s_waitcnt lgkmcnt(2)
 v_mfma_f32_16x16x32_bf16 v[56:59], a[156:159], v[232:235], v[56:59]
 ds_read_b128 v[248:251], v6 offset:30720
 ds_read_b128 v[252:255], v6 offset:30976
 v_mfma_f32_16x16x32_bf16 v[60:63], a[160:163], v[232:235], v[60:63]
 v_mfma_f32_16x16x32_bf16 v[64:67], v[232:235], a[164:167], v[64:67]
 s_waitcnt lgkmcnt(2)
 v_mfma_f32_16x16x32_bf16 v[56:59], a[168:171], v[240:243], v[56:59]
 v_mfma_f32_16x16x32_bf16 v[60:63], a[172:175], v[240:243], v[60:63]
 v_mfma_f32_16x16x32_bf16 v[64:67], v[240:243], a[176:179], v[64:67]
 s_waitcnt lgkmcnt(0)
 v_mfma_f32_16x16x32_bf16 v[56:59], a[180:183], v[248:251], v[56:59]
 v_mfma_f32_16x16x32_bf16 v[60:63], a[184:187], v[248:251], v[60:63]
 v_mfma_f32_16x16x32_bf16 v[64:67], v[248:251], a[188:191], v[64:67]
 v_mfma_f32_16x16x32_bf16 v[68:71], a[0:3], v[132:135], 0
 v_mfma_f32_16x16x32_bf16 v[72:75], a[4:7], v[132:135], 0
 s_nop 3
 v_cvt_pk_bf16_f32 v80, v56, v57
 v_mfma_f32_16x16x32_bf16 v[68:71], a[12:15], v[140:143], v[68:71]
 v_cvt_pk_bf16_f32 v81, v58, v59
 v_cvt_pk_bf16_f32 v18, v60, v61
 v_mfma_f32_16x16x32_bf16 v[72:75], a[16:19], v[140:143], v[72:75]
 v_cvt_pk_bf16_f32 v19, v62, v63
 v_mfma_f32_16x16x32_bf16 v[68:71], a[24:27], v[148:151], v[68:71]
 v_mfma_f32_16x16x16_bf16 v[96:99], v[16:17], v[80:81], 0
 v_mfma_f32_16x16x16_bf16 v[100:103], v[18:19], v[80:81], 0
 v_mfma_f32_16x16x32_bf16 v[72:75], a[28:31], v[148:151], v[72:75]
 v_mov_b64 v[16:17], v[18:19]
 v_mfma_f32_16x16x32_bf16 v[68:71], a[36:39], v[156:159], v[68:71]
 s_nop 3
 v_cndmask_b32 v96, v7, v96, s[8:9]
 v_mfma_f32_16x16x32_bf16 v[72:75], a[40:43], v[156:159], v[72:75]
 v_cndmask_b32 v97, v7, v97, s[10:11]
 v_cndmask_b32 v98, v7, v98, s[12:13]
 v_mfma_f32_16x16x32_bf16 v[68:71], a[48:51], v[164:167], v[68:71]
 v_cndmask_b32 v99, v7, v99, s[14:15]
 v_cndmask_b32 v100, v7, v100, s[84:85]
 v_mfma_f32_16x16x32_bf16 v[72:75], a[52:55], v[164:167], v[72:75]
 v_cndmask_b32 v101, v7, v101, s[86:87]
 v_cndmask_b32 v102, v7, v102, s[88:89]
 v_mfma_f32_16x16x32_bf16 v[68:71], a[60:63], v[172:175], v[68:71]
 v_cndmask_b32 v103, v7, v103, s[90:91]
 v_max3_f32 v92, v96, v97, v98
 v_mfma_f32_16x16x32_bf16 v[72:75], a[64:67], v[172:175], v[72:75]
 v_max3_f32 v92, v92, v99, v100
 v_max3_f32 v92, v92, v101, v102
 v_mfma_f32_16x16x32_bf16 v[68:71], a[72:75], v[180:183], v[68:71]
 v_max_f32 v92, v92, v103
 v_mov_b32 v93, v92
 v_mfma_f32_16x16x32_bf16 v[72:75], a[76:79], v[180:183], v[72:75]
 s_nop 0
 v_permlane16_swap_b32 v92, v93
 v_mfma_f32_16x16x32_bf16 v[68:71], a[84:87], v[188:191], v[68:71]
 v_max_f32 v92, v92, v93
 v_mov_b32 v93, v92
 v_mfma_f32_16x16x32_bf16 v[72:75], a[88:91], v[188:191], v[72:75]
 s_nop 0
 v_permlane32_swap_b32 v92, v93
 v_mfma_f32_16x16x32_bf16 v[68:71], a[96:99], v[196:199], v[68:71]
 v_max_f32 v92, v92, v93
 v_mul_f32 v92, s96, v92
 v_mfma_f32_16x16x32_bf16 v[72:75], a[100:103], v[196:199], v[72:75]
 v_fma_f32 v96, v96, s96, -v92
 v_fma_f32 v97, v97, s96, -v92
 v_mfma_f32_16x16x32_bf16 v[68:71], a[108:111], v[204:207], v[68:71]
 v_fma_f32 v98, v98, s96, -v92
 v_fma_f32 v99, v99, s96, -v92
 v_mfma_f32_16x16x32_bf16 v[72:75], a[112:115], v[204:207], v[72:75]
 v_fma_f32 v100, v100, s96, -v92
 v_fma_f32 v101, v101, s96, -v92
 v_mfma_f32_16x16x32_bf16 v[68:71], a[120:123], v[212:215], v[68:71]
 v_fma_f32 v102, v102, s96, -v92
 v_fma_f32 v103, v103, s96, -v92
 v_mfma_f32_16x16x32_bf16 v[72:75], a[124:127], v[212:215], v[72:75]
 v_exp_f32 v96, v96
 v_exp_f32 v97, v97
 v_mfma_f32_16x16x32_bf16 v[68:71], a[132:135], v[220:223], v[68:71]
 v_exp_f32 v98, v98
 v_exp_f32 v99, v99
 v_mfma_f32_16x16x32_bf16 v[72:75], a[136:139], v[220:223], v[72:75]
 v_exp_f32 v100, v100
 v_exp_f32 v101, v101
 v_mfma_f32_16x16x32_bf16 v[68:71], a[144:147], v[228:231], v[68:71]
 v_exp_f32 v102, v102
 v_exp_f32 v103, v103
 v_mfma_f32_16x16x32_bf16 v[72:75], a[148:151], v[228:231], v[72:75]
 v_cvt_pk_bf16_f32 v84, v96, v97
 v_cvt_pk_bf16_f32 v85, v98, v99
 v_mfma_f32_16x16x32_bf16 v[68:71], a[156:159], v[236:239], v[68:71]
 v_cvt_pk_bf16_f32 v86, v100, v101
 v_cvt_pk_bf16_f32 v87, v102, v103
 v_mfma_f32_16x16x32_bf16 v[72:75], a[160:163], v[236:239], v[72:75]
 v_cvt_pk_bf16_f32 v26, v64, v65
 v_cvt_pk_bf16_f32 v27, v66, v67
 v_mfma_f32_16x16x32_bf16 v[68:71], a[168:171], v[244:247], v[68:71]
 v_mfma_f32_16x16x32_bf16 v[72:75], a[172:175], v[244:247], v[72:75]
 v_mfma_f32_16x16x32_bf16 v[68:71], a[180:183], v[252:255], v[68:71]
 v_mfma_f32_16x16x32_bf16 v[72:75], a[184:187], v[252:255], v[72:75]
 buffer_load_dword v13, v4, s[32:35], s93 offen sc1
 v_mfma_f32_16x16x32_bf16 v[112:115], v[24:27], v[84:87], 0
 v_add_f32 v96, v96, v100
 v_add_f32 v97, v97, v101
 v_add_f32 v98, v98, v102
 v_mfma_f32_16x16x32_bf16 v[76:79], v[132:135], a[8:11], 0
 s_nop 0
 v_cvt_pk_bf16_f32 v82, v68, v69
 v_cvt_pk_bf16_f32 v83, v70, v71
 v_cvt_pk_bf16_f32 v22, v72, v73
 v_mfma_f32_16x16x32_bf16 v[76:79], v[140:143], a[20:23], v[76:79]
 v_cvt_pk_bf16_f32 v23, v74, v75
 v_mfma_f32_16x16x16_bf16 v[104:107], v[20:21], v[82:83], 0
 v_mfma_f32_16x16x32_bf16 v[76:79], v[148:151], a[32:35], v[76:79]
 v_mfma_f32_16x16x16_bf16 v[108:111], v[22:23], v[82:83], 0
 v_mov_b64 v[20:21], v[22:23]
 v_mfma_f32_16x16x32_bf16 v[76:79], v[156:159], a[44:47], v[76:79]
 s_nop 3
 v_cndmask_b32 v104, v7, v104, s[8:9]
 v_cndmask_b32 v105, v7, v105, s[10:11]
 v_mfma_f32_16x16x32_bf16 v[76:79], v[164:167], a[56:59], v[76:79]
 v_cndmask_b32 v106, v7, v106, s[12:13]
 v_cndmask_b32 v107, v7, v107, s[14:15]
 v_cndmask_b32 v108, v7, v108, s[84:85]
 v_mfma_f32_16x16x32_bf16 v[76:79], v[172:175], a[68:71], v[76:79]
 v_cndmask_b32 v109, v7, v109, s[86:87]
 v_cndmask_b32 v110, v7, v110, s[88:89]
 v_cndmask_b32 v111, v7, v111, s[90:91]
 v_mfma_f32_16x16x32_bf16 v[76:79], v[180:183], a[80:83], v[76:79]
 v_max3_f32 v94, v104, v105, v106
 v_max3_f32 v94, v94, v107, v108
 v_max3_f32 v94, v94, v109, v110
 v_mfma_f32_16x16x32_bf16 v[76:79], v[188:191], a[92:95], v[76:79]
 v_max_f32 v94, v94, v111
 v_mov_b32 v95, v94
 v_mfma_f32_16x16x32_bf16 v[76:79], v[196:199], a[104:107], v[76:79]
 s_nop 0
 v_permlane16_swap_b32 v94, v95
 v_max_f32 v94, v94, v95
 v_mov_b32 v95, v94
 v_mfma_f32_16x16x32_bf16 v[76:79], v[204:207], a[116:119], v[76:79]
 s_nop 0
 v_permlane32_swap_b32 v94, v95
 v_max_f32 v94, v94, v95
 v_mfma_f32_16x16x32_bf16 v[76:79], v[212:215], a[128:131], v[76:79]
 v_mul_f32 v94, s96, v94
 v_fma_f32 v104, v104, s96, -v94
 v_fma_f32 v105, v105, s96, -v94
 v_mfma_f32_16x16x32_bf16 v[76:79], v[220:223], a[140:143], v[76:79]
 v_fma_f32 v106, v106, s96, -v94
 v_fma_f32 v107, v107, s96, -v94
 v_fma_f32 v108, v108, s96, -v94
 v_mfma_f32_16x16x32_bf16 v[76:79], v[228:231], a[152:155], v[76:79]
 v_fma_f32 v109, v109, s96, -v94
 v_fma_f32 v110, v110, s96, -v94
 v_fma_f32 v111, v111, s96, -v94
 v_mfma_f32_16x16x32_bf16 v[76:79], v[236:239], a[164:167], v[76:79]
 v_exp_f32 v104, v104
 v_exp_f32 v105, v105
 v_exp_f32 v106, v106
 v_mfma_f32_16x16x32_bf16 v[76:79], v[244:247], a[176:179], v[76:79]
 v_exp_f32 v107, v107
 v_exp_f32 v108, v108
 v_exp_f32 v109, v109
 v_mfma_f32_16x16x32_bf16 v[76:79], v[252:255], a[188:191], v[76:79]
 v_exp_f32 v110, v110
 v_exp_f32 v111, v111
 v_cvt_pk_bf16_f32 v88, v104, v105
 v_cvt_pk_bf16_f32 v89, v106, v107
 v_cvt_pk_bf16_f32 v90, v108, v109
 v_cvt_pk_bf16_f32 v91, v110, v111
 s_nop 0
 s_nop 0
 v_cvt_pk_bf16_f32 v30, v76, v77
 v_cvt_pk_bf16_f32 v31, v78, v79
 v_add_f32 v99, v99, v103
 v_add_f32 v96, v96, v98
 v_add_f32 v97, v97, v99
 v_add_f32 v92, v96, v97
 v_mfma_f32_16x16x32_bf16 v[116:119], v[28:31], v[88:91], 0
 v_add_f32 v104, v104, v108
 v_add_f32 v105, v105, v109
 v_add_f32 v106, v106, v110
 v_add_f32 v107, v107, v111
 v_add_f32 v104, v104, v106
 v_add_f32 v105, v105, v107
 v_add_f32 v94, v104, v105
 v_mov_b32 v93, v92
 v_mov_b32 v95, v94
 s_nop 0
 v_permlane16_swap_b32 v92, v93
 v_permlane16_swap_b32 v94, v95
 v_add_f32 v92, v92, v93
 v_add_f32 v94, v94, v95
 v_mov_b32 v93, v92
 v_mov_b32 v95, v94
 s_nop 0
 v_permlane32_swap_b32 v92, v93
 v_permlane32_swap_b32 v94, v95
 v_add_f32 v92, v92, v93
 v_add_f32 v94, v94, v95
 v_rcp_f32 v92, v92
 v_rcp_f32 v94, v94
 v_mov_b64 v[24:25], v[26:27]
 v_mov_b64 v[28:29], v[30:31]
 s_mov_b64 s[8:9], s[76:77]
 s_mov_b64 s[10:11], s[78:79]
 s_mov_b64 s[12:13], s[80:81]
 s_mov_b64 s[14:15], s[82:83]
 s_nop 0
 v_pk_mul_f32 v[112:113], v[112:113], v[92:93] op_sel_hi:[1,0]
 v_pk_mul_f32 v[114:115], v[114:115], v[92:93] op_sel_hi:[1,0]
 v_pk_mul_f32 v[116:117], v[116:117], v[94:95] op_sel_hi:[1,0]
 v_pk_mul_f32 v[118:119], v[118:119], v[94:95] op_sel_hi:[1,0]
 v_cvt_pk_bf16_f32 v80, v112, v113
 v_cvt_pk_bf16_f32 v81, v114, v115
 v_cvt_pk_bf16_f32 v82, v116, v117
 v_cvt_pk_bf16_f32 v83, v118, v119
 s_nop 0
 v_permlane16_swap_b32 v80, v82
 v_permlane16_swap_b32 v81, v83
 buffer_store_dwordx4 v[80:83], v1, s[32:35], s59 offen sc1
 s_mov_b32 s67, s57
 s_mov_b32 s75, s92
 s_cmp_lg_u32 s92, 0
 s_cbranch_scc1 L_fin_182
 s_waitcnt vmcnt(1)
 v_cmp_eq_u32 vcc, 0, v13
 s_add_u32 s50, s55, 1
 s_cmp_ge_u32 s50, s56
 s_cbranch_scc1 L_noE_180
 s_cbranch_vccnz L_noE_180
 s_and_b32 s58, s50, 7
 s_lshl_b32 s58, s58, 17
 s_add_u32 s58, s58, s94
 s_add_u32 s58, s58, 0x88000
 s_mul_i32 s48, s46, 2048
 s_add_u32 s64, s58, s48
 s_add_u32 s95, s60, s48
 s_add_u32 m0, s95, 0
 s_add_u32 s65, s64, 0
 buffer_load_dwordx4 v1, s[32:35], s65 offen offset:0 sc1 lds
 buffer_load_dwordx4 v1, s[32:35], s65 offen offset:1024 sc1 lds
 s_add_u32 m0, s95, 8192
 s_add_u32 s65, s64, 8192
 buffer_load_dwordx4 v1, s[32:35], s65 offen offset:0 sc1 lds
 buffer_load_dwordx4 v1, s[32:35], s65 offen offset:1024 sc1 lds
 s_mov_b32 s92, 1
 s_waitcnt vmcnt(4)
 s_branch L_goE_181
L_noE_180:
 s_waitcnt vmcnt(0)
L_goE_181:
 s_mov_b64 exec, 1
 buffer_store_dword v5, off, s[32:35], s57 offset:256 sc1
 s_mov_b64 exec, -1
L_fin_182:
 s_add_u32 s55, s55, 1
 s_cmp_lt_u32 s55, s56
 s_cbranch_scc1 L_rc_G
 s_waitcnt vmcnt(0)
 s_branch L_done
L_rd:
 v_and_b32 v0, 63, v0
 v_lshlrev_b32 v1, 4, v0
 s_lshl_b32 s66, s46, 15
 v_mov_b32 v5, 1
 s_lshl_b32 s55, s47, 6
 s_add_u32 s56, s55, 64
 s_mov_b32 s92, 0
 s_mov_b32 s75, 0
 s_lshl_b32 s94, s47, 21
 s_add_u32 s94, s94, 0x2000000
 s_sub_u32 s61, s45, 24
 s_lshl_b32 s61, s61, 2
 s_add_u32 s61, s61, s46
 v_lshrrev_b32 v96, 2, v0
 v_mul_u32_u24 v96, 1024, v96
 v_and_b32 v2, 3, v0
 v_lshl_add_u32 v96, v2, 4, v96
 v_lshrrev_b32 v2, 5, v0
 v_mul_u32_u24 v97, 512, v2
 v_bfe_u32 v2, v0, 2, 2
 v_lshl_add_u32 v97, v2, 6, v97
 v_bfe_u32 v2, v0, 4, 1
 v_lshl_add_u32 v97, v2, 5, v97
 v_and_b32_e64 v2, 1, v0
 v_lshl_add_u32 v97, v2, 4, v97
 v_bfe_u32 v2, v0, 1, 1
 v_lshl_add_u32 v97, v2, 3, v97
 v_add_u32 v97, s66, v97
 s_lshl_b32 s50, s61, 6
 s_mov_b32 s36, s22
 s_mov_b32 s37, s23
 s_mov_b32 s38, 0x80000
 s_mov_b32 s39, 0x20000
 s_lshr_b32 s54, 166, s44
 s_and_b32 s54, s54, 1
 s_cbranch_scc0 L_nolate_183
 s_cmp_lg_u32 s46, 0
 s_cbranch_scc1 L_lated_185
 s_mov_b32 s30, 0
L_winit_186:
 v_mov_b32 v124, 0
 global_load_dword v125, v124, s[26:27] offset:192 sc1
L_wchk_188:
 s_add_u32 s30, s30, 1
 s_cmp_gt_u32 s30, 524288
 s_cbranch_scc1 L_exit
 s_waitcnt vmcnt(0)
 v_readfirstlane_b32 s54, v125
 s_nop 0
 s_cmp_lg_u32 s54, 0
 s_cbranch_scc1 L_wdone_187
 s_sleep 8
 s_branch L_winit_186
L_wdone_187:
 s_lshr_b32 s3, s54, s44
 s_and_b32 s3, s3, 1
 s_lshl_b32 s52, s44, 11
 s_mov_b32 s30, 0
L_late_184:
 buffer_load_dword v125, off, s[32:35], s52 offset:1792 sc1
 s_add_u32 s30, s30, 1
 s_waitcnt vmcnt(0)
 s_cmp_gt_u32 s30, 200
 s_cbranch_scc1 L_lated_185
 v_readfirstlane_b32 s54, v125
 s_nop 0
 s_cmp_ge_u32 s54, 1
 s_cbranch_scc1 L_lated_185
 s_sleep 8
 s_branch L_late_184
L_lated_185:
 s_barrier
L_nolate_183:
 s_add_u32 s48, s50, 0
 s_add_u32 m0, s66, 0
 s_nop 0
 buffer_load_dwordx4 v96, s[36:39], s48 offen offset:0 lds
 s_add_u32 s48, s48, 15360
 buffer_load_dwordx4 v96, s[36:39], s48 offen offset:1024 lds
 s_add_u32 s48, s48, 15360
 buffer_load_dwordx4 v96, s[36:39], s48 offen offset:2048 lds
 s_add_u32 s48, s48, 15360
 buffer_load_dwordx4 v96, s[36:39], s48 offen offset:3072 lds
 s_add_u32 s48, s50, 65536
 s_add_u32 m0, s66, 4096
 s_nop 0
 buffer_load_dwordx4 v96, s[36:39], s48 offen offset:0 lds
 s_add_u32 s48, s48, 15360
 buffer_load_dwordx4 v96, s[36:39], s48 offen offset:1024 lds
 s_add_u32 s48, s48, 15360
 buffer_load_dwordx4 v96, s[36:39], s48 offen offset:2048 lds
 s_add_u32 s48, s48, 15360
 buffer_load_dwordx4 v96, s[36:39], s48 offen offset:3072 lds
 s_add_u32 s48, s50, 131072
 s_add_u32 m0, s66, 8192
 s_nop 0
 buffer_load_dwordx4 v96, s[36:39], s48 offen offset:0 lds
 s_add_u32 s48, s48, 15360
 buffer_load_dwordx4 v96, s[36:39], s48 offen offset:1024 lds
 s_add_u32 s48, s48, 15360
 buffer_load_dwordx4 v96, s[36:39], s48 offen offset:2048 lds
 s_add_u32 s48, s48, 15360
 buffer_load_dwordx4 v96, s[36:39], s48 offen offset:3072 lds
 s_add_u32 s48, s50, 196608
 s_add_u32 m0, s66, 12288
 s_nop 0
 buffer_load_dwordx4 v96, s[36:39], s48 offen offset:0 lds
 s_add_u32 s48, s48, 15360
 buffer_load_dwordx4 v96, s[36:39], s48 offen offset:1024 lds
 s_add_u32 s48, s48, 15360
 buffer_load_dwordx4 v96, s[36:39], s48 offen offset:2048 lds
 s_add_u32 s48, s48, 15360
 buffer_load_dwordx4 v96, s[36:39], s48 offen offset:3072 lds
 s_add_u32 s48, s50, 262144
 s_add_u32 m0, s66, 16384
 s_nop 0
 buffer_load_dwordx4 v96, s[36:39], s48 offen offset:0 lds
 s_add_u32 s48, s48, 15360
 buffer_load_dwordx4 v96, s[36:39], s48 offen offset:1024 lds
 s_add_u32 s48, s48, 15360
 buffer_load_dwordx4 v96, s[36:39], s48 offen offset:2048 lds
 s_add_u32 s48, s48, 15360
 buffer_load_dwordx4 v96, s[36:39], s48 offen offset:3072 lds
 s_add_u32 s48, s50, 327680
 s_add_u32 m0, s66, 20480
 s_nop 0
 buffer_load_dwordx4 v96, s[36:39], s48 offen offset:0 lds
 s_add_u32 s48, s48, 15360
 buffer_load_dwordx4 v96, s[36:39], s48 offen offset:1024 lds
 s_add_u32 s48, s48, 15360
 buffer_load_dwordx4 v96, s[36:39], s48 offen offset:2048 lds
 s_add_u32 s48, s48, 15360
 buffer_load_dwordx4 v96, s[36:39], s48 offen offset:3072 lds
 s_add_u32 s48, s50, 393216
 s_add_u32 m0, s66, 24576
 s_nop 0
 buffer_load_dwordx4 v96, s[36:39], s48 offen offset:0 lds
 s_add_u32 s48, s48, 15360
 buffer_load_dwordx4 v96, s[36:39], s48 offen offset:1024 lds
 s_add_u32 s48, s48, 15360
 buffer_load_dwordx4 v96, s[36:39], s48 offen offset:2048 lds
 s_add_u32 s48, s48, 15360
 buffer_load_dwordx4 v96, s[36:39], s48 offen offset:3072 lds
 s_add_u32 s48, s50, 458752
 s_add_u32 m0, s66, 28672
 s_nop 0
 buffer_load_dwordx4 v96, s[36:39], s48 offen offset:0 lds
 s_add_u32 s48, s48, 15360
 buffer_load_dwordx4 v96, s[36:39], s48 offen offset:1024 lds
 s_add_u32 s48, s48, 15360
 buffer_load_dwordx4 v96, s[36:39], s48 offen offset:2048 lds
 s_add_u32 s48, s48, 15360
 buffer_load_dwordx4 v96, s[36:39], s48 offen offset:3072 lds
 s_waitcnt vmcnt(28)
 ds_read_b64_tr_b16 a[0:1], v97 offset:0
 ds_read_b64_tr_b16 a[2:3], v97 offset:256
 ds_read_b64_tr_b16 a[4:5], v97 offset:1024
 ds_read_b64_tr_b16 a[6:7], v97 offset:1280
 ds_read_b64_tr_b16 a[8:9], v97 offset:2048
 ds_read_b64_tr_b16 a[10:11], v97 offset:2304
 ds_read_b64_tr_b16 a[12:13], v97 offset:3072
 ds_read_b64_tr_b16 a[14:15], v97 offset:3328
 s_waitcnt lgkmcnt(0)
 s_waitcnt vmcnt(24)
 ds_read_b64_tr_b16 a[16:17], v97 offset:4096
 ds_read_b64_tr_b16 a[18:19], v97 offset:4352
 ds_read_b64_tr_b16 a[20:21], v97 offset:5120
 ds_read_b64_tr_b16 a[22:23], v97 offset:5376
 ds_read_b64_tr_b16 a[24:25], v97 offset:6144
 ds_read_b64_tr_b16 a[26:27], v97 offset:6400
 ds_read_b64_tr_b16 a[28:29], v97 offset:7168
 ds_read_b64_tr_b16 a[30:31], v97 offset:7424
 s_waitcnt lgkmcnt(0)
 s_waitcnt vmcnt(20)
 ds_read_b64_tr_b16 a[32:33], v97 offset:8192
 ds_read_b64_tr_b16 a[34:35], v97 offset:8448
 ds_read_b64_tr_b16 a[36:37], v97 offset:9216
 ds_read_b64_tr_b16 a[38:39], v97 offset:9472
 ds_read_b64_tr_b16 a[40:41], v97 offset:10240
 ds_read_b64_tr_b16 a[42:43], v97 offset:10496
 ds_read_b64_tr_b16 a[44:45], v97 offset:11264
 ds_read_b64_tr_b16 a[46:47], v97 offset:11520
 s_waitcnt lgkmcnt(0)
 s_waitcnt vmcnt(16)
 ds_read_b64_tr_b16 a[48:49], v97 offset:12288
 ds_read_b64_tr_b16 a[50:51], v97 offset:12544
 ds_read_b64_tr_b16 a[52:53], v97 offset:13312
 ds_read_b64_tr_b16 a[54:55], v97 offset:13568
 ds_read_b64_tr_b16 a[56:57], v97 offset:14336
 ds_read_b64_tr_b16 a[58:59], v97 offset:14592
 ds_read_b64_tr_b16 a[60:61], v97 offset:15360
 ds_read_b64_tr_b16 a[62:63], v97 offset:15616
 s_waitcnt lgkmcnt(0)
 s_waitcnt vmcnt(12)
 ds_read_b64_tr_b16 a[64:65], v97 offset:16384
 ds_read_b64_tr_b16 a[66:67], v97 offset:16640
 ds_read_b64_tr_b16 a[68:69], v97 offset:17408
 ds_read_b64_tr_b16 a[70:71], v97 offset:17664
 ds_read_b64_tr_b16 a[72:73], v97 offset:18432
 ds_read_b64_tr_b16 a[74:75], v97 offset:18688
 ds_read_b64_tr_b16 a[76:77], v97 offset:19456
 ds_read_b64_tr_b16 a[78:79], v97 offset:19712
 s_waitcnt lgkmcnt(0)
 s_waitcnt vmcnt(8)
 ds_read_b64_tr_b16 a[80:81], v97 offset:20480
 ds_read_b64_tr_b16 a[82:83], v97 offset:20736
 ds_read_b64_tr_b16 a[84:85], v97 offset:21504
 ds_read_b64_tr_b16 a[86:87], v97 offset:21760
 ds_read_b64_tr_b16 a[88:89], v97 offset:22528
 ds_read_b64_tr_b16 a[90:91], v97 offset:22784
 ds_read_b64_tr_b16 a[92:93], v97 offset:23552
 ds_read_b64_tr_b16 a[94:95], v97 offset:23808
 s_waitcnt lgkmcnt(0)
 s_waitcnt vmcnt(4)
 ds_read_b64_tr_b16 a[96:97], v97 offset:24576
 ds_read_b64_tr_b16 a[98:99], v97 offset:24832
 ds_read_b64_tr_b16 a[100:101], v97 offset:25600
 ds_read_b64_tr_b16 a[102:103], v97 offset:25856
 ds_read_b64_tr_b16 a[104:105], v97 offset:26624
 ds_read_b64_tr_b16 a[106:107], v97 offset:26880
 ds_read_b64_tr_b16 a[108:109], v97 offset:27648
 ds_read_b64_tr_b16 a[110:111], v97 offset:27904
 s_waitcnt lgkmcnt(0)
 s_waitcnt vmcnt(0)
 ds_read_b64_tr_b16 a[112:113], v97 offset:28672
 ds_read_b64_tr_b16 a[114:115], v97 offset:28928
 ds_read_b64_tr_b16 a[116:117], v97 offset:29696
 ds_read_b64_tr_b16 a[118:119], v97 offset:29952
 ds_read_b64_tr_b16 a[120:121], v97 offset:30720
 ds_read_b64_tr_b16 a[122:123], v97 offset:30976
 ds_read_b64_tr_b16 a[124:125], v97 offset:31744
 ds_read_b64_tr_b16 a[126:127], v97 offset:32000
 s_waitcnt lgkmcnt(0)
 v_and_b32 v4, 31, v0
 v_lshlrev_b32 v4, 2, v4
 v_add_u32 v4, 256, v4
 s_cmp_eq_u32 s47, 0
 s_mov_b32 s49, 256
 s_cselect_b32 s49, 131072, s49
 s_mov_b32 s78, 0
 v_and_b32 v12, 7, v0
 v_lshlrev_b32 v12, 2, v12
 v_add_u32 v12, s49, v12
 v_add_u32 v2, 16384, v4
 v_cmp_gt_u32 vcc, 32, v0
 s_nop 1
 v_cndmask_b32_e64 v12, v12, v2, vcc
 v_bfe_u32 v2, v0, 4, 1
 v_mul_u32_u24 v8, 256, v2
 v_lshrrev_b32 v2, 5, v0
 v_mul_u32_u24 v2, 512, v2
 v_add_u32 v8, v8, v2
 v_and_b32 v2, 15, v0
 v_lshl_add_u32 v8, v2, 4, v8
 s_lshl_b32 s48, s61, 11
 v_add_u32 v9, s48, v8
 s_mov_b32 s80, 0
 s_cmp_eq_u32 s47, 0
 s_cbranch_scc1 L_rd_l0
 s_mov_b32 s40, s24
 s_mov_b32 s41, s25
 s_mov_b32 s42, 0x200000
 s_mov_b32 s43, 0x20000
 s_mov_b32 s62, 0
 s_mov_b32 s76, 63
 s_mov_b32 s77, 15
 v_and_b32 v2, 15, v0
 v_lshlrev_b32_e64 v10, 11, v2
 v_bfe_u32 v2, v0, 4, 1
 v_lshl_add_u32 v10, v2, 10, v10
 v_lshrrev_b32 v2, 5, v0
 v_lshl_add_u32 v10, v2, 4, v10
 s_lshl_b32 s48, s61, 6
 v_add_u32 v10, s48, v10
 v_add_u32 v11, 32, v10
 s_branch L_rd_go
L_rd_l0:
 s_mov_b32 s40, s28
 s_mov_b32 s41, s29
 s_mov_b32 s42, 0x10000000
 s_mov_b32 s43, 0x20000
 s_add_u32 s62, s94, 0x98000
 s_mov_b32 s76, 7
 s_mov_b32 s77, 17
 v_bfe_u32 v2, v0, 4, 1
 v_mul_u32_u24 v10, 512, v2
 v_lshrrev_b32 v2, 5, v0
 v_mul_u32_u24 v2, 64, v2
 v_add_u32 v10, v10, v2
 v_bfe_u32 v2, v0, 2, 2
 v_lshl_add_u32 v10, v2, 7, v10
 v_and_b32 v2, 3, v0
 v_lshl_add_u32 v10, v2, 4, v10
 s_lshl_b32 s48, s61, 11
 v_add_u32 v10, s48, v10
 v_add_u32 v11, 1024, v10
L_rd_go:
 s_mov_b32 s60, 0
 s_mul_i32 s48, s45, 49152
 s_mul_i32 s49, s46, 12288
 s_add_u32 s48, s48, s49
 s_add_u32 s48, s48, s94
 buffer_load_dwordx4 v[100:103], v1, s[32:35], s48 offen offset:0 sc1
 buffer_load_dwordx4 v[100:103], v1, s[32:35], s48 offen offset:1024 sc1
 buffer_load_dwordx4 v[100:103], v1, s[32:35], s48 offen offset:2048 sc1
 buffer_load_dwordx4 v[100:103], v1, s[32:35], s48 offen offset:3072 sc1
 s_add_u32 s48, s48, 4096
 buffer_load_dwordx4 v[100:103], v1, s[32:35], s48 offen offset:0 sc1
 buffer_load_dwordx4 v[100:103], v1, s[32:35], s48 offen offset:1024 sc1
 buffer_load_dwordx4 v[100:103], v1, s[32:35], s48 offen offset:2048 sc1
 buffer_load_dwordx4 v[100:103], v1, s[32:35], s48 offen offset:3072 sc1
 s_add_u32 s48, s48, 4096
 buffer_load_dwordx4 v[100:103], v1, s[32:35], s48 offen offset:0 sc1
 buffer_load_dwordx4 v[100:103], v1, s[32:35], s48 offen offset:1024 sc1
 buffer_load_dwordx4 v[100:103], v1, s[32:35], s48 offen offset:2048 sc1
 buffer_load_dwordx4 v[100:103], v1, s[32:35], s48 offen offset:3072 sc1
 s_waitcnt vmcnt(0)
 s_mov_b32 s30, 0
L_winit_189:
 v_mov_b32 v124, 0
 global_load_dword v125, v124, s[26:27] offset:192 sc1
L_wchk_191:
 s_add_u32 s30, s30, 1
 s_cmp_gt_u32 s30, 524288
 s_cbranch_scc1 L_exit
 s_waitcnt vmcnt(0)
 v_readfirstlane_b32 s54, v125
 s_nop 0
 s_cmp_lg_u32 s54, 0
 s_cbranch_scc1 L_wdone_190
 s_sleep 8
 s_branch L_winit_189
L_wdone_190:
 s_lshr_b32 s3, s54, s44
 s_and_b32 s3, s3, 1
 s_barrier
 s_lshl_b32 s48, s45, 12
 s_lshl_b32 s49, s46, 10
 s_add_u32 s48, s48, s49
 s_lshl_b32 s49, s47, 17
 s_add_u32 s48, s48, s49
 buffer_load_dwordx4 v[100:103], v1, s[32:35], s48 offen sc1
 s_waitcnt vmcnt(0)
 s_cmp_eq_u32 s3, 0
 s_cbranch_scc1 L_rd_G
L_rd_L:
 s_lshl_b32 s57, s55, 11
 s_sub_u32 s79, s57, s78
 s_add_u32 s93, s79, 2048
 s_cmp_lg_u32 s92, 0
 s_cbranch_scc1 L_pre_192
 s_mov_b32 s30, 0
L_pf_193:
 buffer_load_dword v2, v4, s[32:35], s79 offen sc1
 s_add_u32 s30, s30, 1
 s_cmp_gt_u32 s30, 524288
 s_cbranch_scc1 L_exit
 s_waitcnt vmcnt(0)
 v_cmp_eq_u32 vcc, 0, v2
 s_cbranch_vccz L_pfd_194
 s_sleep 1
 s_branch L_pf_193
L_pfd_194:
 s_and_b32 s58, s55, 7
 s_lshl_b32 s58, s58, 17
 s_add_u32 s58, s58, s94
 s_add_u32 s58, s58, 0x90000
 s_mul_i32 s48, s46, 2048
 s_add_u32 s64, s58, s48
 s_add_u32 s95, s60, s48
 s_add_u32 m0, s95, 0
 s_add_u32 s65, s64, 0
 buffer_load_dwordx4 v1, s[32:35], s65 offen offset:0 sc1 lds
 buffer_load_dwordx4 v1, s[32:35], s65 offen offset:1024 sc1 lds
 s_add_u32 m0, s95, 8192
 s_add_u32 s65, s64, 8192
 buffer_load_dwordx4 v1, s[32:35], s65 offen offset:0 sc1 lds
 buffer_load_dwordx4 v1, s[32:35], s65 offen offset:1024 sc1 lds
L_pre_192:
 v_add_u32 v6, s60, v8
 s_xor_b32 s60, s60, 32768
 s_and_b32 s48, s55, 63
 s_cmp_lg_u32 s48, 7
 s_cbranch_scc1 L_nocr_195
 v_mov_b32 v4, v12
 s_mov_b32 s78, 16384
 s_sub_u32 s93, s93, 16384
L_nocr_195:
 s_and_b32 s63, s55, 7
 s_lshl_b32 s63, s63, 17
 s_add_u32 s63, s63, s94
 s_add_u32 s63, s63, 0x80000
 s_and_b32 s59, s55, s76
 s_lshl_b32 s59, s59, s77
 s_add_u32 s59, s59, s62
 s_lshl_b32 s48, s61, 2
 s_add_u32 s57, s57, s48
 s_waitcnt vmcnt(4)
 s_cmp_lg_u32 s75, 0
 s_cbranch_scc1 L_np_196
 s_waitcnt vmcnt(2)
L_np_196:
 s_barrier
 ds_read_b128 v[32:35], v6 offset:0
 ds_read_b128 v[36:39], v6 offset:1024
 ds_read_b128 v[40:43], v6 offset:2048
 ds_read_b128 v[44:47], v6 offset:3072
 s_mov_b32 s92, 0
 s_waitcnt lgkmcnt(2)
 v_mfma_f32_32x32x16_bf16 v[16:31], a[0:3], v[32:35], 0
 ds_read_b128 v[48:51], v6 offset:4096
 ds_read_b128 v[52:55], v6 offset:5120
 s_add_u32 m0, s95, 16384
 s_add_u32 s65, s64, 16384
 buffer_load_dwordx4 v1, s[32:35], s65 offen offset:0 sc1 lds
 v_mfma_f32_32x32x16_bf16 v[16:31], a[4:7], v[36:39], v[16:31]
 s_waitcnt lgkmcnt(2)
 v_mfma_f32_32x32x16_bf16 v[16:31], a[8:11], v[40:43], v[16:31]
 ds_read_b128 v[32:35], v6 offset:6144
 ds_read_b128 v[36:39], v6 offset:7168
 buffer_load_dwordx4 v1, s[32:35], s65 offen offset:1024 sc1 lds
 v_mfma_f32_32x32x16_bf16 v[16:31], a[12:15], v[44:47], v[16:31]
 s_waitcnt vmcnt(2)
 s_cmp_eq_u32 s75, 0
 s_cbranch_scc1 L_np_197
 s_mov_b64 exec, 1
 buffer_store_dword v5, off, s[32:35], s67 offset:384
 s_mov_b64 exec, -1
L_np_197:
 s_barrier
 s_waitcnt lgkmcnt(2)
 v_mfma_f32_32x32x16_bf16 v[16:31], a[16:19], v[48:51], v[16:31]
 ds_read_b128 v[40:43], v6 offset:8192
 ds_read_b128 v[44:47], v6 offset:9216
 s_add_u32 m0, s95, 24576
 s_add_u32 s65, s64, 24576
 buffer_load_dwordx4 v1, s[32:35], s65 offen offset:0 sc1 lds
 v_mfma_f32_32x32x16_bf16 v[16:31], a[20:23], v[52:55], v[16:31]
 s_waitcnt lgkmcnt(2)
 v_mfma_f32_32x32x16_bf16 v[16:31], a[24:27], v[32:35], v[16:31]
 ds_read_b128 v[48:51], v6 offset:10240
 ds_read_b128 v[52:55], v6 offset:11264
 buffer_load_dwordx4 v1, s[32:35], s65 offen offset:1024 sc1 lds
 v_mfma_f32_32x32x16_bf16 v[16:31], a[28:31], v[36:39], v[16:31]
 s_waitcnt lgkmcnt(2)
 v_mfma_f32_32x32x16_bf16 v[16:31], a[32:35], v[40:43], v[16:31]
 ds_read_b128 v[32:35], v6 offset:12288
 ds_read_b128 v[36:39], v6 offset:13312
 buffer_load_dwordx4 v[56:59], v9, s[32:35], s63 offen offset:0 sc1
 v_mfma_f32_32x32x16_bf16 v[16:31], a[36:39], v[44:47], v[16:31]
 buffer_load_dwordx4 v[60:63], v9, s[32:35], s63 offen offset:1024 sc1
 s_waitcnt lgkmcnt(2)
 v_mfma_f32_32x32x16_bf16 v[16:31], a[40:43], v[48:51], v[16:31]
 ds_read_b128 v[40:43], v6 offset:14336
 ds_read_b128 v[44:47], v6 offset:15360
 v_mfma_f32_32x32x16_bf16 v[16:31], a[44:47], v[52:55], v[16:31]
 s_waitcnt vmcnt(4)
 s_barrier
 s_waitcnt lgkmcnt(2)
 v_mfma_f32_32x32x16_bf16 v[16:31], a[48:51], v[32:35], v[16:31]
 ds_read_b128 v[48:51], v6 offset:16384
 ds_read_b128 v[52:55], v6 offset:17408
 v_mfma_f32_32x32x16_bf16 v[16:31], a[52:55], v[36:39], v[16:31]
 s_waitcnt lgkmcnt(2)
 v_mfma_f32_32x32x16_bf16 v[16:31], a[56:59], v[40:43], v[16:31]
 ds_read_b128 v[32:35], v6 offset:18432
 ds_read_b128 v[36:39], v6 offset:19456
 v_mfma_f32_32x32x16_bf16 v[16:31], a[60:63], v[44:47], v[16:31]
 s_waitcnt lgkmcnt(2)
 v_mfma_f32_32x32x16_bf16 v[16:31], a[64:67], v[48:51], v[16:31]
 ds_read_b128 v[40:43], v6 offset:20480
 ds_read_b128 v[44:47], v6 offset:21504
 v_mfma_f32_32x32x16_bf16 v[16:31], a[68:71], v[52:55], v[16:31]
 s_waitcnt lgkmcnt(2)
 v_mfma_f32_32x32x16_bf16 v[16:31], a[72:75], v[32:35], v[16:31]
 ds_read_b128 v[48:51], v6 offset:22528
 ds_read_b128 v[52:55], v6 offset:23552
 v_mfma_f32_32x32x16_bf16 v[16:31], a[76:79], v[36:39], v[16:31]
 s_waitcnt vmcnt(2)
 s_barrier
 s_waitcnt lgkmcnt(2)
 v_mfma_f32_32x32x16_bf16 v[16:31], a[80:83], v[40:43], v[16:31]
 ds_read_b128 v[32:35], v6 offset:24576
 ds_read_b128 v[36:39], v6 offset:25600
 v_mfma_f32_32x32x16_bf16 v[16:31], a[84:87], v[44:47], v[16:31]
 s_waitcnt lgkmcnt(2)
 v_mfma_f32_32x32x16_bf16 v[16:31], a[88:91], v[48:51], v[16:31]
 ds_read_b128 v[40:43], v6 offset:26624
 ds_read_b128 v[44:47], v6 offset:27648
 buffer_load_dword v13, v4, s[32:35], s93 offen sc1
 v_mfma_f32_32x32x16_bf16 v[16:31], a[92:95], v[52:55], v[16:31]
 s_waitcnt lgkmcnt(2)
 v_mfma_f32_32x32x16_bf16 v[16:31], a[96:99], v[32:35], v[16:31]
 ds_read_b128 v[48:51], v6 offset:28672
 ds_read_b128 v[52:55], v6 offset:29696
 v_mfma_f32_32x32x16_bf16 v[16:31], a[100:103], v[36:39], v[16:31]
 s_waitcnt lgkmcnt(2)
 v_mfma_f32_32x32x16_bf16 v[16:31], a[104:107], v[40:43], v[16:31]
 ds_read_b128 v[32:35], v6 offset:30720
 ds_read_b128 v[36:39], v6 offset:31744
 v_mfma_f32_32x32x16_bf16 v[16:31], a[108:111], v[44:47], v[16:31]
 s_waitcnt lgkmcnt(2)
 v_mfma_f32_32x32x16_bf16 v[16:31], a[112:115], v[48:51], v[16:31]
 v_mfma_f32_32x32x16_bf16 v[16:31], a[116:119], v[52:55], v[16:31]
 s_waitcnt lgkmcnt(0)
 v_mfma_f32_32x32x16_bf16 v[16:31], a[120:123], v[32:35], v[16:31]
 v_mfma_f32_32x32x16_bf16 v[16:31], a[124:127], v[36:39], v[16:31]
 s_waitcnt vmcnt(1)
 v_lshlrev_b32 v64, 16, v56
 v_and_b32 v65, 0xffff0000, v56
 v_lshlrev_b32 v66, 16, v57
 v_and_b32 v67, 0xffff0000, v57
 v_lshlrev_b32 v68, 16, v58
 v_and_b32 v69, 0xffff0000, v58
 v_lshlrev_b32 v70, 16, v59
 v_and_b32 v71, 0xffff0000, v59
 v_lshlrev_b32 v72, 16, v60
 v_and_b32 v73, 0xffff0000, v60
 v_lshlrev_b32 v74, 16, v61
 v_and_b32 v75, 0xffff0000, v61
 v_lshlrev_b32 v76, 16, v62
 v_and_b32 v77, 0xffff0000, v62
 v_lshlrev_b32 v78, 16, v63
 v_and_b32 v79, 0xffff0000, v63
 v_pk_add_f32 v[16:17], v[16:17], v[64:65]
 v_pk_add_f32 v[18:19], v[18:19], v[66:67]
 v_pk_add_f32 v[20:21], v[20:21], v[68:69]
 v_pk_add_f32 v[22:23], v[22:23], v[70:71]
 v_pk_add_f32 v[24:25], v[24:25], v[72:73]
 v_pk_add_f32 v[26:27], v[26:27], v[74:75]
 v_pk_add_f32 v[28:29], v[28:29], v[76:77]
 v_pk_add_f32 v[30:31], v[30:31], v[78:79]
 v_cvt_pk_bf16_f32 v80, v16, v17
 v_cvt_pk_bf16_f32 v81, v18, v19
 v_cvt_pk_bf16_f32 v82, v20, v21
 v_cvt_pk_bf16_f32 v83, v22, v23
 buffer_store_dwordx4 v[80:83], v10, s[40:43], s59 offen
 v_cvt_pk_bf16_f32 v84, v24, v25
 v_cvt_pk_bf16_f32 v85, v26, v27
 v_cvt_pk_bf16_f32 v86, v28, v29
 v_cvt_pk_bf16_f32 v87, v30, v31
 buffer_store_dwordx4 v[84:87], v11, s[40:43], s59 offen
 s_cmp_eq_u32 s55, 63
 s_cbranch_scc0 L_nocp_198
 s_lshl_b32 s63, s55, 15
 s_add_u32 s63, s63, 0x1200000
 buffer_store_dwordx4 v[80:83], v10, s[32:35], s63 offen sc1
 buffer_store_dwordx4 v[84:87], v11, s[32:35], s63 offen sc1
L_nocp_198:
 s_mov_b32 s67, s57
 s_mov_b32 s75, s92
 s_cmp_lg_u32 s92, 0
 s_cbranch_scc1 L_fin_201
 s_waitcnt vmcnt(2)
 v_cmp_eq_u32 vcc, 0, v13
 s_add_u32 s50, s55, 1
 s_cmp_ge_u32 s50, s56
 s_cbranch_scc1 L_noE_199
 s_cbranch_vccnz L_noE_199
 s_and_b32 s58, s50, 7
 s_lshl_b32 s58, s58, 17
 s_add_u32 s58, s58, s94
 s_add_u32 s58, s58, 0x90000
 s_mul_i32 s48, s46, 2048
 s_add_u32 s64, s58, s48
 s_add_u32 s95, s60, s48
 s_add_u32 m0, s95, 0
 s_add_u32 s65, s64, 0
 buffer_load_dwordx4 v1, s[32:35], s65 offen offset:0 sc1 lds
 buffer_load_dwordx4 v1, s[32:35], s65 offen offset:1024 sc1 lds
 s_add_u32 m0, s95, 8192
 s_add_u32 s65, s64, 8192
 buffer_load_dwordx4 v1, s[32:35], s65 offen offset:0 sc1 lds
 buffer_load_dwordx4 v1, s[32:35], s65 offen offset:1024 sc1 lds
 s_mov_b32 s92, 1
 s_waitcnt vmcnt(4)
 s_branch L_goE_200
L_noE_199:
 s_waitcnt vmcnt(0)
L_goE_200:
 s_mov_b64 exec, 1
 buffer_store_dword v5, off, s[32:35], s57 offset:384
 s_mov_b64 exec, -1
L_fin_201:
 s_cmp_lt_u32 s55, 63
 s_cbranch_scc0 L_nocp_202
 s_lshl_b32 s63, s55, 15
 s_add_u32 s63, s63, 0x1200000
 buffer_store_dwordx4 v[80:83], v10, s[32:35], s63 offen sc1
 buffer_store_dwordx4 v[84:87], v11, s[32:35], s63 offen sc1
L_nocp_202:
 s_add_u32 s55, s55, 1
 s_cmp_lt_u32 s55, s56
 s_cbranch_scc1 L_rd_L
 s_waitcnt vmcnt(0)
 s_branch L_done
L_rd_G:
 s_lshl_b32 s57, s55, 11
 s_sub_u32 s79, s57, s78
 s_add_u32 s93, s79, 2048
 s_cmp_lg_u32 s92, 0
 s_cbranch_scc1 L_pre_203
 s_mov_b32 s30, 0
L_pf_204:
 buffer_load_dword v2, v4, s[32:35], s79 offen sc1
 s_add_u32 s30, s30, 1
 s_cmp_gt_u32 s30, 524288
 s_cbranch_scc1 L_exit
 s_waitcnt vmcnt(0)
 v_cmp_eq_u32 vcc, 0, v2
 s_cbranch_vccz L_pfd_205
 s_sleep 1
 s_branch L_pf_204
L_pfd_205:
 s_and_b32 s58, s55, 7
 s_lshl_b32 s58, s58, 17
 s_add_u32 s58, s58, s94
 s_add_u32 s58, s58, 0x90000
 s_mul_i32 s48, s46, 2048
 s_add_u32 s64, s58, s48
 s_add_u32 s95, s60, s48
 s_add_u32 m0, s95, 0
 s_add_u32 s65, s64, 0
 buffer_load_dwordx4 v1, s[32:35], s65 offen offset:0 sc1 lds
 buffer_load_dwordx4 v1, s[32:35], s65 offen offset:1024 sc1 lds
 s_add_u32 m0, s95, 8192
 s_add_u32 s65, s64, 8192
 buffer_load_dwordx4 v1, s[32:35], s65 offen offset:0 sc1 lds
 buffer_load_dwordx4 v1, s[32:35], s65 offen offset:1024 sc1 lds
L_pre_203:
 v_add_u32 v6, s60, v8
 s_xor_b32 s60, s60, 32768
 s_and_b32 s48, s55, 63
 s_cmp_lg_u32 s48, 7
 s_cbranch_scc1 L_nocr_206
 v_mov_b32 v4, v12
 s_mov_b32 s78, 16384
 s_sub_u32 s93, s93, 16384
L_nocr_206:
 s_and_b32 s63, s55, 7
 s_lshl_b32 s63, s63, 17
 s_add_u32 s63, s63, s94
 s_add_u32 s63, s63, 0x80000
 s_and_b32 s59, s55, s76
 s_lshl_b32 s59, s59, s77
 s_add_u32 s59, s59, s62
 s_lshl_b32 s48, s61, 2
 s_add_u32 s57, s57, s48
 s_waitcnt vmcnt(4)
 s_cmp_lg_u32 s75, 0
 s_cbranch_scc1 L_np_207
 s_waitcnt vmcnt(2)
L_np_207:
 s_barrier
 ds_read_b128 v[32:35], v6 offset:0
 ds_read_b128 v[36:39], v6 offset:1024
 ds_read_b128 v[40:43], v6 offset:2048
 ds_read_b128 v[44:47], v6 offset:3072
 s_mov_b32 s92, 0
 s_waitcnt lgkmcnt(2)
 v_mfma_f32_32x32x16_bf16 v[16:31], a[0:3], v[32:35], 0
 ds_read_b128 v[48:51], v6 offset:4096
 ds_read_b128 v[52:55], v6 offset:5120
 s_add_u32 m0, s95, 16384
 s_add_u32 s65, s64, 16384
 buffer_load_dwordx4 v1, s[32:35], s65 offen offset:0 sc1 lds
 v_mfma_f32_32x32x16_bf16 v[16:31], a[4:7], v[36:39], v[16:31]
 s_waitcnt lgkmcnt(2)
 v_mfma_f32_32x32x16_bf16 v[16:31], a[8:11], v[40:43], v[16:31]
 ds_read_b128 v[32:35], v6 offset:6144
 ds_read_b128 v[36:39], v6 offset:7168
 buffer_load_dwordx4 v1, s[32:35], s65 offen offset:1024 sc1 lds
 v_mfma_f32_32x32x16_bf16 v[16:31], a[12:15], v[44:47], v[16:31]
 s_waitcnt vmcnt(2)
 s_cmp_eq_u32 s75, 0
 s_cbranch_scc1 L_np_208
 s_mov_b64 exec, 1
 buffer_store_dword v5, off, s[32:35], s67 offset:384 sc1
 s_mov_b64 exec, -1
L_np_208:
 s_barrier
 s_waitcnt lgkmcnt(2)
 v_mfma_f32_32x32x16_bf16 v[16:31], a[16:19], v[48:51], v[16:31]
 ds_read_b128 v[40:43], v6 offset:8192
 ds_read_b128 v[44:47], v6 offset:9216
 s_add_u32 m0, s95, 24576
 s_add_u32 s65, s64, 24576
 buffer_load_dwordx4 v1, s[32:35], s65 offen offset:0 sc1 lds
 v_mfma_f32_32x32x16_bf16 v[16:31], a[20:23], v[52:55], v[16:31]
 s_waitcnt lgkmcnt(2)
 v_mfma_f32_32x32x16_bf16 v[16:31], a[24:27], v[32:35], v[16:31]
 ds_read_b128 v[48:51], v6 offset:10240
 ds_read_b128 v[52:55], v6 offset:11264
 buffer_load_dwordx4 v1, s[32:35], s65 offen offset:1024 sc1 lds
 v_mfma_f32_32x32x16_bf16 v[16:31], a[28:31], v[36:39], v[16:31]
 s_waitcnt lgkmcnt(2)
 v_mfma_f32_32x32x16_bf16 v[16:31], a[32:35], v[40:43], v[16:31]
 ds_read_b128 v[32:35], v6 offset:12288
 ds_read_b128 v[36:39], v6 offset:13312
 buffer_load_dwordx4 v[56:59], v9, s[32:35], s63 offen offset:0 sc1
 v_mfma_f32_32x32x16_bf16 v[16:31], a[36:39], v[44:47], v[16:31]
 buffer_load_dwordx4 v[60:63], v9, s[32:35], s63 offen offset:1024 sc1
 s_waitcnt lgkmcnt(2)
 v_mfma_f32_32x32x16_bf16 v[16:31], a[40:43], v[48:51], v[16:31]
 ds_read_b128 v[40:43], v6 offset:14336
 ds_read_b128 v[44:47], v6 offset:15360
 v_mfma_f32_32x32x16_bf16 v[16:31], a[44:47], v[52:55], v[16:31]
 s_waitcnt vmcnt(4)
 s_barrier
 s_waitcnt lgkmcnt(2)
 v_mfma_f32_32x32x16_bf16 v[16:31], a[48:51], v[32:35], v[16:31]
 ds_read_b128 v[48:51], v6 offset:16384
 ds_read_b128 v[52:55], v6 offset:17408
 v_mfma_f32_32x32x16_bf16 v[16:31], a[52:55], v[36:39], v[16:31]
 s_waitcnt lgkmcnt(2)
 v_mfma_f32_32x32x16_bf16 v[16:31], a[56:59], v[40:43], v[16:31]
 ds_read_b128 v[32:35], v6 offset:18432
 ds_read_b128 v[36:39], v6 offset:19456
 v_mfma_f32_32x32x16_bf16 v[16:31], a[60:63], v[44:47], v[16:31]
 s_waitcnt lgkmcnt(2)
 v_mfma_f32_32x32x16_bf16 v[16:31], a[64:67], v[48:51], v[16:31]
 ds_read_b128 v[40:43], v6 offset:20480
 ds_read_b128 v[44:47], v6 offset:21504
 v_mfma_f32_32x32x16_bf16 v[16:31], a[68:71], v[52:55], v[16:31]
 s_waitcnt lgkmcnt(2)
 v_mfma_f32_32x32x16_bf16 v[16:31], a[72:75], v[32:35], v[16:31]
 ds_read_b128 v[48:51], v6 offset:22528
 ds_read_b128 v[52:55], v6 offset:23552
 v_mfma_f32_32x32x16_bf16 v[16:31], a[76:79], v[36:39], v[16:31]
 s_waitcnt vmcnt(2)
 s_barrier
 s_waitcnt lgkmcnt(2)
 v_mfma_f32_32x32x16_bf16 v[16:31], a[80:83], v[40:43], v[16:31]
 ds_read_b128 v[32:35], v6 offset:24576
 ds_read_b128 v[36:39], v6 offset:25600
 v_mfma_f32_32x32x16_bf16 v[16:31], a[84:87], v[44:47], v[16:31]
 s_waitcnt lgkmcnt(2)
 v_mfma_f32_32x32x16_bf16 v[16:31], a[88:91], v[48:51], v[16:31]
 ds_read_b128 v[40:43], v6 offset:26624
 ds_read_b128 v[44:47], v6 offset:27648
 buffer_load_dword v13, v4, s[32:35], s93 offen sc1
 v_mfma_f32_32x32x16_bf16 v[16:31], a[92:95], v[52:55], v[16:31]
 s_waitcnt lgkmcnt(2)
 v_mfma_f32_32x32x16_bf16 v[16:31], a[96:99], v[32:35], v[16:31]
 ds_read_b128 v[48:51], v6 offset:28672
 ds_read_b128 v[52:55], v6 offset:29696
 v_mfma_f32_32x32x16_bf16 v[16:31], a[100:103], v[36:39], v[16:31]
 s_waitcnt lgkmcnt(2)
 v_mfma_f32_32x32x16_bf16 v[16:31], a[104:107], v[40:43], v[16:31]
 ds_read_b128 v[32:35], v6 offset:30720
 ds_read_b128 v[36:39], v6 offset:31744
 v_mfma_f32_32x32x16_bf16 v[16:31], a[108:111], v[44:47], v[16:31]
 s_waitcnt lgkmcnt(2)
 v_mfma_f32_32x32x16_bf16 v[16:31], a[112:115], v[48:51], v[16:31]
 v_mfma_f32_32x32x16_bf16 v[16:31], a[116:119], v[52:55], v[16:31]
 s_waitcnt lgkmcnt(0)
 v_mfma_f32_32x32x16_bf16 v[16:31], a[120:123], v[32:35], v[16:31]
 v_mfma_f32_32x32x16_bf16 v[16:31], a[124:127], v[36:39], v[16:31]
 s_waitcnt vmcnt(1)
 v_lshlrev_b32 v64, 16, v56
 v_and_b32 v65, 0xffff0000, v56
 v_lshlrev_b32 v66, 16, v57
 v_and_b32 v67, 0xffff0000, v57
 v_lshlrev_b32 v68, 16, v58
 v_and_b32 v69, 0xffff0000, v58
 v_lshlrev_b32 v70, 16, v59
 v_and_b32 v71, 0xffff0000, v59
 v_lshlrev_b32 v72, 16, v60
 v_and_b32 v73, 0xffff0000, v60
 v_lshlrev_b32 v74, 16, v61
 v_and_b32 v75, 0xffff0000, v61
 v_lshlrev_b32 v76, 16, v62
 v_and_b32 v77, 0xffff0000, v62
 v_lshlrev_b32_e64 v78, 16, v63
 v_and_b32 v79, 0xffff0000, v63
 v_pk_add_f32 v[16:17], v[16:17], v[64:65]
 v_pk_add_f32 v[18:19], v[18:19], v[66:67]
 v_pk_add_f32 v[20:21], v[20:21], v[68:69]
 v_pk_add_f32 v[22:23], v[22:23], v[70:71]
 v_pk_add_f32 v[24:25], v[24:25], v[72:73]
 v_pk_add_f32 v[26:27], v[26:27], v[74:75]
 v_pk_add_f32 v[28:29], v[28:29], v[76:77]
 v_pk_add_f32 v[30:31], v[30:31], v[78:79]
 v_cvt_pk_bf16_f32 v80, v16, v17
 v_cvt_pk_bf16_f32 v81, v18, v19
 v_cvt_pk_bf16_f32 v82, v20, v21
 v_cvt_pk_bf16_f32 v83, v22, v23
 buffer_store_dwordx4 v[80:83], v10, s[40:43], s59 offen sc1
 v_cvt_pk_bf16_f32 v84, v24, v25
 v_cvt_pk_bf16_f32 v85, v26, v27
 v_cvt_pk_bf16_f32 v86, v28, v29
 v_cvt_pk_bf16_f32 v87, v30, v31
 buffer_store_dwordx4 v[84:87], v11, s[40:43], s59 offen sc1
 s_cmp_eq_u32 s55, 63
 s_cbranch_scc0 L_nocp_209
 s_lshl_b32 s63, s55, 15
 s_add_u32 s63, s63, 0x1200000
 buffer_store_dwordx4 v[80:83], v10, s[32:35], s63 offen sc1
 buffer_store_dwordx4 v[84:87], v11, s[32:35], s63 offen sc1
L_nocp_209:
 s_mov_b32 s67, s57
 s_mov_b32 s75, s92
 s_cmp_lg_u32 s92, 0
 s_cbranch_scc1 L_fin_212
 s_waitcnt vmcnt(2)
 v_cmp_eq_u32 vcc, 0, v13
 s_add_u32 s50, s55, 1
 s_cmp_ge_u32 s50, s56
 s_cbranch_scc1 L_noE_210
 s_cbranch_vccnz L_noE_210
 s_and_b32 s58, s50, 7
 s_lshl_b32 s58, s58, 17
 s_add_u32 s58, s58, s94
 s_add_u32 s58, s58, 0x90000
 s_mul_i32 s48, s46, 2048
 s_add_u32 s64, s58, s48
 s_add_u32 s95, s60, s48
 s_add_u32 m0, s95, 0
 s_add_u32 s65, s64, 0
 buffer_load_dwordx4 v1, s[32:35], s65 offen offset:0 sc1 lds
 buffer_load_dwordx4 v1, s[32:35], s65 offen offset:1024 sc1 lds
 s_add_u32 m0, s95, 8192
 s_add_u32 s65, s64, 8192
 buffer_load_dwordx4 v1, s[32:35], s65 offen offset:0 sc1 lds
 buffer_load_dwordx4 v1, s[32:35], s65 offen offset:1024 sc1 lds
 s_mov_b32 s92, 1
 s_waitcnt vmcnt(4)
 s_branch L_goE_211
L_noE_210:
 s_waitcnt vmcnt(0)
L_goE_211:
 s_mov_b64 exec, 1
 buffer_store_dword v5, off, s[32:35], s57 offset:384 sc1
 s_mov_b64 exec, -1
L_fin_212:
 s_cmp_lt_u32 s55, 63
 s_cbranch_scc0 L_nocp_213
 s_lshl_b32 s63, s55, 15
 s_add_u32 s63, s63, 0x1200000
 buffer_store_dwordx4 v[80:83], v10, s[32:35], s63 offen sc1
 buffer_store_dwordx4 v[84:87], v11, s[32:35], s63 offen sc1
L_nocp_213:
 s_add_u32 s55, s55, 1
 s_cmp_lt_u32 s55, s56
 s_cbranch_scc1 L_rd_G
 s_waitcnt vmcnt(0)
 s_branch L_done
L_rows:
 v_and_b32 v0, 63, v0
 v_lshlrev_b32 v1, 4, v0
 s_lshl_b32 s66, s46, 15
 v_mov_b32 v5, 1
 s_lshl_b32 s55, s47, 6
 s_add_u32 s56, s55, 64
 s_mov_b32 s92, 0
 s_mov_b32 s75, 0
 s_lshl_b32 s94, s47, 21
 s_add_u32 s94, s94, 0x2000000
 s_sub_u32 s61, s45, 28
 s_lshl_b32 s49, s61, 2
 s_add_u32 s49, s49, s46
 s_lshl_b32 s61, s61, 1
 s_and_b32 s48, s46, 1
 s_add_u32 s61, s61, s48
 s_lshr_b32 s63, s46, 1
 s_and_b32 s48, s61, 1
 s_lshr_b32 s49, s61, 1
 s_lshl_b32 s49, s49, 2
 v_and_b32 v96, 3, v0
 v_add_u32 v96, s49, v96
 v_lshrrev_b32 v97, 2, v0
 s_lshl_b32 s49, s48, 8
 v_lshl_add_u32 v98, v96, 4, s49
 s_lshl_b32 s49, s48, 10
 v_lshl_add_u32 v99, v96, 11, s49
 s_lshl_b32 s49, s48, 9
 s_lshr_b32 s50, s61, 1
 s_lshl_b32 s50, s50, 7
 s_add_u32 s49, s49, s50
 v_and_b32 v102, 7, v0
 v_lshl_add_u32 v102, v102, 4, s49
 s_cmp_eq_u32 s63, 1
 s_cbranch_scc1 L_re
 v_lshlrev_b32 v4, 2, v0
 v_add_u32 v4, 1536, v4
 v_and_b32 v13, 7, v0
 v_lshlrev_b32 v13, 2, v13
 v_bfe_u32 v100, v0, 3, 1
 v_lshl_add_u32 v102, v100, 10, v102
 v_lshrrev_b32_e64 v100, 4, v0
 v_lshl_add_u32 v7, v100, 15, v102
 v_bfe_u32 v100, v0, 4, 1
 v_lshlrev_b32_e64 v101, 12, v100
 v_bfe_u32 v100, v0, 5, 1
 v_lshl_add_u32 v101, v100, 11, v101
 v_add_u32_e64 v8, v101, v102
 v_bfe_u32 v100, v0, 2, 2
 v_lshl_add_u32 v101, v100, 9, v101
 v_add_u32 v12, v101, v98
 v_and_b32 v100, 1, v0
 v_lshlrev_b32 v100, 4, v100
 v_mov_b32 v101, 0x3f80
 v_lshlrev_b32 v100, v100, v101
 v_bfe_u32 v101, v0, 1, 2
 v_bfe_u32 v102, v0, 3, 1
 v_cmp_eq_u32 vcc, 0, v101
 s_nop 1
 v_cndmask_b32 v103, 0, v100, vcc
 v_cmp_eq_u32 vcc, 0, v102
 s_nop 1
 v_cndmask_b32 v104, 0, v103, vcc
 v_cmp_eq_u32 vcc, 1, v102
 s_nop 1
 v_cndmask_b32 v108, 0, v103, vcc
 v_cmp_eq_u32 vcc, 1, v101
 s_nop 1
 v_cndmask_b32 v103, 0, v100, vcc
 v_cmp_eq_u32 vcc, 0, v102
 s_nop 1
 v_cndmask_b32 v105, 0, v103, vcc
 v_cmp_eq_u32 vcc, 1, v102
 s_nop 1
 v_cndmask_b32 v109, 0, v103, vcc
 v_cmp_eq_u32 vcc, 2, v101
 s_nop 1
 v_cndmask_b32 v103, 0, v100, vcc
 v_cmp_eq_u32 vcc, 0, v102
 s_nop 1
 v_cndmask_b32 v106, 0, v103, vcc
 v_cmp_eq_u32 vcc, 1, v102
 s_nop 1
 v_cndmask_b32 v110, 0, v103, vcc
 v_cmp_eq_u32 vcc, 3, v101
 s_nop 1
 v_cndmask_b32 v103, 0, v100, vcc
 v_cmp_eq_u32 vcc, 0, v102
 s_nop 1
 v_cndmask_b32 v107, 0, v103, vcc
 v_cmp_eq_u32 vcc, 1, v102
 s_nop 1
 v_cndmask_b32 v111, 0, v103, vcc
 v_and_b32 v9, 15, v0
 v_lshlrev_b32 v9, 2, v9
 v_add_u32 v9, 384, v9
 s_mul_i32 s48, s45, 49152
 s_mul_i32 s49, s46, 12288
 s_add_u32 s48, s48, s49
 s_add_u32 s48, s48, s94
 buffer_load_dwordx4 v[100:103], v1, s[32:35], s48 offen offset:0 sc1
 buffer_load_dwordx4 v[100:103], v1, s[32:35], s48 offen offset:1024 sc1
 buffer_load_dwordx4 v[100:103], v1, s[32:35], s48 offen offset:2048 sc1
 buffer_load_dwordx4 v[100:103], v1, s[32:35], s48 offen offset:3072 sc1
 s_add_u32 s48, s48, 4096
 buffer_load_dwordx4 v[100:103], v1, s[32:35], s48 offen offset:0 sc1
 buffer_load_dwordx4 v[100:103], v1, s[32:35], s48 offen offset:1024 sc1
 buffer_load_dwordx4 v[100:103], v1, s[32:35], s48 offen offset:2048 sc1
 buffer_load_dwordx4 v[100:103], v1, s[32:35], s48 offen offset:3072 sc1
 s_add_u32 s48, s48, 4096
 buffer_load_dwordx4 v[100:103], v1, s[32:35], s48 offen offset:0 sc1
 buffer_load_dwordx4 v[100:103], v1, s[32:35], s48 offen offset:1024 sc1
 buffer_load_dwordx4 v[100:103], v1, s[32:35], s48 offen offset:2048 sc1
 buffer_load_dwordx4 v[100:103], v1, s[32:35], s48 offen offset:3072 sc1
 s_waitcnt vmcnt(0)
 s_mov_b32 s30, 0
L_winit_214:
 v_mov_b32 v124, 0
 global_load_dword v125, v124, s[26:27] offset:192 sc1
L_wchk_216:
 s_add_u32 s30, s30, 1
 s_cmp_gt_u32 s30, 524288
 s_cbranch_scc1 L_exit
 s_waitcnt vmcnt(0)
 v_readfirstlane_b32 s54, v125
 s_nop 0
 s_cmp_lg_u32 s54, 0
 s_cbranch_scc1 L_wdone_215
 s_sleep 8
 s_branch L_winit_214
L_wdone_215:
 s_lshr_b32 s3, s54, s44
 s_and_b32 s3, s3, 1
 s_barrier
 s_lshl_b32 s48, s45, 12
 s_lshl_b32 s49, s46, 10
 s_add_u32 s48, s48, s49
 s_lshl_b32 s49, s47, 17
 s_add_u32 s48, s48, s49
 buffer_load_dwordx4 v[100:103], v1, s[32:35], s48 offen sc1
 s_waitcnt vmcnt(0)
 s_lshl_b32 s57, s55, 11
 s_mov_b32 s30, 0
L_pf_217:
 buffer_load_dword v2, v13, s[32:35], s57 offen sc1
 s_add_u32 s30, s30, 1
 s_cmp_gt_u32 s30, 524288
 s_cbranch_scc1 L_exit
 s_waitcnt vmcnt(0)
 v_cmp_eq_u32 vcc, 0, v2
 s_cbranch_vccz L_pfd_218
 s_sleep 8
 s_branch L_pf_217
L_pfd_218:
 s_add_u32 s57, s57, 2048
 s_mov_b32 s30, 0
L_pf_219:
 buffer_load_dword v2, v13, s[32:35], s57 offen sc1
 s_add_u32 s30, s30, 1
 s_cmp_gt_u32 s30, 524288
 s_cbranch_scc1 L_exit
 s_waitcnt vmcnt(0)
 v_cmp_eq_u32 vcc, 0, v2
 s_cbranch_vccz L_pfd_220
 s_sleep 8
 s_branch L_pf_219
L_pfd_220:
 s_add_u32 s57, s57, 2048
 s_mov_b32 s30, 0
L_pf_221:
 buffer_load_dword v2, v13, s[32:35], s57 offen sc1
 s_add_u32 s30, s30, 1
 s_cmp_gt_u32 s30, 524288
 s_cbranch_scc1 L_exit
 s_waitcnt vmcnt(0)
 v_cmp_eq_u32 vcc, 0, v2
 s_cbranch_vccz L_pfd_222
 s_sleep 8
 s_branch L_pf_221
L_pfd_222:
 s_lshl_b32 s48, s55, 15
 s_add_u32 s48, s48, 0x1000000
 buffer_load_dwordx4 v[192:195], v8, s[32:35], s48 offen sc1
 s_add_u32 s48, s48, 8192
 buffer_load_dwordx4 v[196:199], v8, s[32:35], s48 offen sc1
 s_add_u32 s48, s48, 8192
 buffer_load_dwordx4 v[200:203], v8, s[32:35], s48 offen sc1
 s_add_u32 s48, s48, 8192
 buffer_load_dwordx4 v[204:207], v8, s[32:35], s48 offen sc1
 s_waitcnt vmcnt(0)
 v_permlane16_swap_b32 v192, v194
 v_permlane16_swap_b32 v193, v195
 v_permlane16_swap_b32 v196, v198
 v_permlane16_swap_b32 v197, v199
 v_permlane16_swap_b32 v200, v202
 v_permlane16_swap_b32 v201, v203
 v_permlane16_swap_b32 v204, v206
 v_permlane16_swap_b32 v205, v207
 v_lshlrev_b32 v16, 16, v192
 v_and_b32 v17, 0xffff0000, v192
 v_lshlrev_b32 v18, 16, v193
 v_and_b32 v19, 0xffff0000, v193
 v_lshlrev_b32 v20, 16, v194
 v_and_b32 v21, 0xffff0000, v194
 v_lshlrev_b32 v22, 16, v195
 v_and_b32 v23, 0xffff0000, v195
 v_lshlrev_b32 v24, 16, v196
 v_and_b32 v25, 0xffff0000, v196
 v_lshlrev_b32 v26, 16, v197
 v_and_b32 v27, 0xffff0000, v197
 v_lshlrev_b32 v28, 16, v198
 v_and_b32 v29, 0xffff0000, v198
 v_lshlrev_b32 v30, 16, v199
 v_and_b32 v31, 0xffff0000, v199
 v_lshlrev_b32 v32, 16, v200
 v_and_b32 v33, 0xffff0000, v200
 v_lshlrev_b32 v34, 16, v201
 v_and_b32 v35, 0xffff0000, v201
 v_lshlrev_b32 v36, 16, v202
 v_and_b32 v37, 0xffff0000, v202
 v_lshlrev_b32 v38, 16, v203
 v_and_b32 v39, 0xffff0000, v203
 v_lshlrev_b32 v40, 16, v204
 v_and_b32 v41, 0xffff0000, v204
 v_lshlrev_b32 v42, 16, v205
 v_and_b32 v43, 0xffff0000, v205
 v_lshlrev_b32 v44, 16, v206
 v_and_b32 v45, 0xffff0000, v206
 v_lshlrev_b32 v46, 16, v207
 v_and_b32 v47, 0xffff0000, v207
 v_mov_b32 v11, 0
 s_cmp_eq_u32 s3, 0
 s_cbranch_scc1 L_rb_G
L_rb_L:
 s_lshl_b32 s57, s55, 11
 s_and_b32 s58, s55, 3
 s_lshl_b32 s58, s58, 17
 s_add_u32 s58, s58, s94
 s_waitcnt vmcnt(1)
 v_cmp_eq_u32 vcc, 0, v11
 s_cbranch_vccz L_rbseen_223
 s_mov_b32 s30, 0
L_pf_224:
 buffer_load_dword v2, v4, s[32:35], s57 offen sc1
 s_add_u32 s30, s30, 1
 s_cmp_gt_u32 s30, 524288
 s_cbranch_scc1 L_exit
 s_waitcnt vmcnt(0)
 v_cmp_eq_u32 vcc, 0, v2
 s_cbranch_vccz L_pfd_225
 s_sleep 1
 s_branch L_pf_224
L_pfd_225:
L_rbseen_223:
 buffer_load_dwordx4 v[128:131], v7, s[32:35], s58 offen offset:0 sc1
 buffer_load_dwordx4 v[132:135], v7, s[32:35], s58 offen offset:2048 sc1
 s_add_u32 s58, s58, 4096
 buffer_load_dwordx4 v[136:139], v7, s[32:35], s58 offen offset:0 sc1
 buffer_load_dwordx4 v[140:143], v7, s[32:35], s58 offen offset:2048 sc1
 s_add_u32 s58, s58, 4096
 buffer_load_dwordx4 v[144:147], v7, s[32:35], s58 offen offset:0 sc1
 buffer_load_dwordx4 v[148:151], v7, s[32:35], s58 offen offset:2048 sc1
 s_add_u32 s58, s58, 4096
 buffer_load_dwordx4 v[152:155], v7, s[32:35], s58 offen offset:0 sc1
 buffer_load_dwordx4 v[156:159], v7, s[32:35], s58 offen offset:2048 sc1
 s_add_u32 s58, s58, 4096
 buffer_load_dwordx4 v[160:163], v7, s[32:35], s58 offen offset:0 sc1
 buffer_load_dwordx4 v[164:167], v7, s[32:35], s58 offen offset:2048 sc1
 s_add_u32 s58, s58, 4096
 buffer_load_dwordx4 v[168:171], v7, s[32:35], s58 offen offset:0 sc1
 buffer_load_dwordx4 v[172:175], v7, s[32:35], s58 offen offset:2048 sc1
 s_add_u32 s58, s58, 4096
 buffer_load_dwordx4 v[176:179], v7, s[32:35], s58 offen offset:0 sc1
 buffer_load_dwordx4 v[180:183], v7, s[32:35], s58 offen offset:2048 sc1
 s_add_u32 s58, s58, 4096
 buffer_load_dwordx4 v[184:187], v7, s[32:35], s58 offen offset:0 sc1
 buffer_load_dwordx4 v[188:191], v7, s[32:35], s58 offen offset:2048 sc1
 s_and_b32 s48, s55, 63
 s_cmp_ge_u32 s48, 8
 s_cselect_b32 s76, 17536, 0
 s_sub_u32 s76, s57, s76
 s_add_u32 s76, s76, 1152
 buffer_load_dword v10, v9, s[32:35], s76 offen sc1
 s_add_u32 s48, s55, 1
 s_lshl_b32 s48, s48, 15
 s_add_u32 s48, s48, 0x1000000
 buffer_load_dwordx4 v[192:195], v8, s[32:35], s48 offen sc1
 s_add_u32 s48, s48, 8192
 buffer_load_dwordx4 v[196:199], v8, s[32:35], s48 offen sc1
 s_add_u32 s48, s48, 8192
 buffer_load_dwordx4 v[200:203], v8, s[32:35], s48 offen sc1
 s_add_u32 s48, s48, 8192
 buffer_load_dwordx4 v[204:207], v8, s[32:35], s48 offen sc1
 s_and_b32 s50, s55, 7
 s_lshl_b32 s50, s50, 17
 s_add_u32 s50, s50, s94
 s_add_u32 s50, s50, 0x80000
 s_add_u32 s59, s50, 0x8000
 s_lshl_b32 s48, s61, 2
 s_add_u32 s57, s57, s48
 s_waitcnt vmcnt(20)
 v_mfma_f32_16x16x32_bf16 v[16:19], v[104:107], v[128:131], v[16:19]
 s_waitcnt vmcnt(19)
 v_mfma_f32_16x16x32_bf16 v[16:19], v[108:111], v[132:135], v[16:19]
 s_waitcnt vmcnt(18)
 v_mfma_f32_16x16x32_bf16 v[20:23], v[104:107], v[136:139], v[20:23]
 s_waitcnt vmcnt(17)
 v_mfma_f32_16x16x32_bf16 v[20:23], v[108:111], v[140:143], v[20:23]
 s_waitcnt vmcnt(16)
 v_mfma_f32_16x16x32_bf16 v[24:27], v[104:107], v[144:147], v[24:27]
 s_waitcnt vmcnt(15)
 v_mfma_f32_16x16x32_bf16 v[24:27], v[108:111], v[148:151], v[24:27]
 v_cvt_pk_bf16_f32 v112, v16, v17
 v_cvt_pk_bf16_f32 v113, v18, v19
 s_waitcnt vmcnt(14)
 v_mfma_f32_16x16x32_bf16 v[28:31], v[104:107], v[152:155], v[28:31]
 s_waitcnt vmcnt(13)
 v_mfma_f32_16x16x32_bf16 v[28:31], v[108:111], v[156:159], v[28:31]
 v_cvt_pk_bf16_f32 v114, v20, v21
 v_cvt_pk_bf16_f32 v115, v22, v23
 s_waitcnt vmcnt(12)
 v_mfma_f32_16x16x32_bf16 v[32:35], v[104:107], v[160:163], v[32:35]
 s_waitcnt vmcnt(11)
 v_mfma_f32_16x16x32_bf16 v[32:35], v[108:111], v[164:167], v[32:35]
 v_cvt_pk_bf16_f32 v116, v24, v25
 v_cvt_pk_bf16_f32 v117, v26, v27
 s_waitcnt vmcnt(10)
 v_mfma_f32_16x16x32_bf16 v[36:39], v[104:107], v[168:171], v[36:39]
 s_waitcnt vmcnt(9)
 v_mfma_f32_16x16x32_bf16 v[36:39], v[108:111], v[172:175], v[36:39]
 v_cvt_pk_bf16_f32 v118, v28, v29
 v_cvt_pk_bf16_f32 v119, v30, v31
 s_waitcnt vmcnt(8)
 v_mfma_f32_16x16x32_bf16 v[40:43], v[104:107], v[176:179], v[40:43]
 s_waitcnt vmcnt(7)
 v_mfma_f32_16x16x32_bf16 v[40:43], v[108:111], v[180:183], v[40:43]
 v_cvt_pk_bf16_f32 v120, v32, v33
 v_cvt_pk_bf16_f32 v121, v34, v35
 s_waitcnt vmcnt(6)
 v_mfma_f32_16x16x32_bf16 v[44:47], v[104:107], v[184:187], v[44:47]
 s_waitcnt vmcnt(5)
 v_mfma_f32_16x16x32_bf16 v[44:47], v[108:111], v[188:191], v[44:47]
 v_cvt_pk_bf16_f32 v122, v36, v37
 v_cvt_pk_bf16_f32 v123, v38, v39
 s_waitcnt vmcnt(4)
 v_cmp_eq_u32 vcc, 0, v10
 s_cbranch_vccz L_crok_226
 s_mov_b32 s30, 0
L_pf_227:
 buffer_load_dword v10, v9, s[32:35], s76 offen sc1
 s_add_u32 s30, s30, 1
 s_cmp_gt_u32 s30, 524288
 s_cbranch_scc1 L_exit
 s_waitcnt vmcnt(0)
 v_cmp_eq_u32 vcc, 0, v10
 s_cbranch_vccz L_pfd_228
 s_sleep 2
 s_branch L_pf_227
L_pfd_228:
L_crok_226:
 v_cvt_pk_bf16_f32 v124, v40, v41
 v_cvt_pk_bf16_f32 v125, v42, v43
 s_nop 0
 v_cvt_pk_bf16_f32 v126, v44, v45
 v_cvt_pk_bf16_f32 v127, v46, v47
 v_permlane16_swap_b32 v112, v114
 v_permlane16_swap_b32 v113, v115
 v_permlane16_swap_b32 v116, v118
 v_permlane16_swap_b32 v117, v119
 v_permlane16_swap_b32 v120, v122
 v_permlane16_swap_b32 v121, v123
 v_permlane16_swap_b32 v124, v126
 v_permlane16_swap_b32 v125, v127
 v_pk_add_f32 v[48:49], v[16:17], v[18:19]
 v_pk_mul_f32 v[52:53], v[16:17], v[16:17]
 v_pk_fma_f32 v[52:53], v[18:19], v[18:19], v[52:53]
 v_pk_add_f32 v[48:49], v[48:49], v[20:21]
 v_pk_fma_f32 v[52:53], v[20:21], v[20:21], v[52:53]
 v_pk_add_f32 v[48:49], v[48:49], v[22:23]
 v_pk_fma_f32 v[52:53], v[22:23], v[22:23], v[52:53]
 v_pk_add_f32 v[48:49], v[48:49], v[24:25]
 v_pk_fma_f32 v[52:53], v[24:25], v[24:25], v[52:53]
 v_pk_add_f32 v[48:49], v[48:49], v[26:27]
 v_pk_fma_f32 v[52:53], v[26:27], v[26:27], v[52:53]
 v_pk_add_f32 v[48:49], v[48:49], v[28:29]
 v_pk_fma_f32 v[52:53], v[28:29], v[28:29], v[52:53]
 v_pk_add_f32 v[48:49], v[48:49], v[30:31]
 v_pk_fma_f32 v[52:53], v[30:31], v[30:31], v[52:53]
 v_pk_add_f32 v[48:49], v[48:49], v[32:33]
 v_pk_fma_f32 v[52:53], v[32:33], v[32:33], v[52:53]
 v_pk_add_f32 v[48:49], v[48:49], v[34:35]
 v_pk_fma_f32 v[52:53], v[34:35], v[34:35], v[52:53]
 v_pk_add_f32 v[48:49], v[48:49], v[36:37]
 v_pk_fma_f32 v[52:53], v[36:37], v[36:37], v[52:53]
 v_pk_add_f32 v[48:49], v[48:49], v[38:39]
 v_pk_fma_f32 v[52:53], v[38:39], v[38:39], v[52:53]
 v_pk_add_f32 v[48:49], v[48:49], v[40:41]
 v_pk_fma_f32 v[52:53], v[40:41], v[40:41], v[52:53]
 v_pk_add_f32 v[48:49], v[48:49], v[42:43]
 v_pk_fma_f32 v[52:53], v[42:43], v[42:43], v[52:53]
 v_pk_add_f32 v[48:49], v[48:49], v[44:45]
 v_pk_fma_f32 v[52:53], v[44:45], v[44:45], v[52:53]
 v_pk_add_f32 v[48:49], v[48:49], v[46:47]
 v_pk_fma_f32 v[52:53], v[46:47], v[46:47], v[52:53]
 v_add_f32 v48, v48, v49
 v_add_f32 v52, v52, v53
 buffer_store_dwordx4 v[112:115], v12, s[32:35], s50 offen
 v_add_f32_dpp v48, v48, v48 row_ror:4 row_mask:0xf bank_mask:0xf
 v_add_f32_dpp v52, v52, v52 row_ror:4 row_mask:0xf bank_mask:0xf
 s_add_u32 s50, s50, 8192
 buffer_store_dwordx4 v[116:119], v12, s[32:35], s50 offen
 v_add_f32_dpp v48, v48, v48 row_ror:8 row_mask:0xf bank_mask:0xf
 v_add_f32_dpp v52, v52, v52 row_ror:8 row_mask:0xf bank_mask:0xf
 v_mov_b32 v50, v48
 v_mov_b32 v54, v52
 s_add_u32 s50, s50, 8192
 buffer_store_dwordx4 v[120:123], v12, s[32:35], s50 offen
 v_permlane16_swap_b32 v48, v50
 v_permlane16_swap_b32 v52, v54
 v_add_f32 v48, v48, v50
 v_add_f32 v52, v52, v54
 v_mov_b32 v50, v48
 v_mov_b32 v54, v52
 s_add_u32 s50, s50, 8192
 buffer_store_dwordx4 v[124:127], v12, s[32:35], s50 offen
 v_permlane32_swap_b32 v48, v50
 v_permlane32_swap_b32 v52, v54
 v_add_f32 v48, v48, v50
 v_add_f32 v52, v52, v54
 v_mul_f32 v48, 0x3b000000, v48
 v_mul_f32 v52, 0x3b000000, v52
 v_fma_f32 v52, -v48, v48, v52
 v_max_f32_e64 v52, 0, v52
 v_cvt_pk_bf16_f32 v48, v48, v48
 v_and_b32 v48, 0xffff0000, v48
 v_cvt_pk_bf16_f32 v52, v52, v52
 v_and_b32 v52, 0xffff0000, v52
 v_add_f32 v52, 0x3727c5ac, v52
 v_cvt_pk_bf16_f32 v52, v52, v52
 v_and_b32 v52, 0xffff0000, v52
 v_sqrt_f32 v52, v52
 s_nop 0
 v_cvt_pk_bf16_f32 v52, v52, v52
 v_and_b32 v52, 0xffff0000, v52
 v_rcp_f32 v52, v52
 s_nop 0
 v_mul_f32_e64 v48, v48, v52
 v_pk_fma_f32 v[16:17], v[16:17], v[52:53], v[48:49] op_sel_hi:[1,0,0] neg_lo:[0,0,1] neg_hi:[0,0,1]
 v_pk_fma_f32 v[18:19], v[18:19], v[52:53], v[48:49] op_sel_hi:[1,0,0] neg_lo:[0,0,1] neg_hi:[0,0,1]
 v_pk_fma_f32 v[20:21], v[20:21], v[52:53], v[48:49] op_sel_hi:[1,0,0] neg_lo:[0,0,1] neg_hi:[0,0,1]
 v_pk_fma_f32 v[22:23], v[22:23], v[52:53], v[48:49] op_sel_hi:[1,0,0] neg_lo:[0,0,1] neg_hi:[0,0,1]
 v_pk_fma_f32 v[24:25], v[24:25], v[52:53], v[48:49] op_sel_hi:[1,0,0] neg_lo:[0,0,1] neg_hi:[0,0,1]
 v_pk_fma_f32 v[26:27], v[26:27], v[52:53], v[48:49] op_sel_hi:[1,0,0] neg_lo:[0,0,1] neg_hi:[0,0,1]
 v_pk_fma_f32 v[28:29], v[28:29], v[52:53], v[48:49] op_sel_hi:[1,0,0] neg_lo:[0,0,1] neg_hi:[0,0,1]
 v_pk_fma_f32 v[30:31], v[30:31], v[52:53], v[48:49] op_sel_hi:[1,0,0] neg_lo:[0,0,1] neg_hi:[0,0,1]
 v_pk_fma_f32 v[32:33], v[32:33], v[52:53], v[48:49] op_sel_hi:[1,0,0] neg_lo:[0,0,1] neg_hi:[0,0,1]
 v_pk_fma_f32 v[34:35], v[34:35], v[52:53], v[48:49] op_sel_hi:[1,0,0] neg_lo:[0,0,1] neg_hi:[0,0,1]
 v_pk_fma_f32 v[36:37], v[36:37], v[52:53], v[48:49] op_sel_hi:[1,0,0] neg_lo:[0,0,1] neg_hi:[0,0,1]
 v_pk_fma_f32 v[38:39], v[38:39], v[52:53], v[48:49] op_sel_hi:[1,0,0] neg_lo:[0,0,1] neg_hi:[0,0,1]
 v_pk_fma_f32 v[40:41], v[40:41], v[52:53], v[48:49] op_sel_hi:[1,0,0] neg_lo:[0,0,1] neg_hi:[0,0,1]
 v_pk_fma_f32 v[42:43], v[42:43], v[52:53], v[48:49] op_sel_hi:[1,0,0] neg_lo:[0,0,1] neg_hi:[0,0,1]
 v_pk_fma_f32 v[44:45], v[44:45], v[52:53], v[48:49] op_sel_hi:[1,0,0] neg_lo:[0,0,1] neg_hi:[0,0,1]
 v_pk_fma_f32 v[46:47], v[46:47], v[52:53], v[48:49] op_sel_hi:[1,0,0] neg_lo:[0,0,1] neg_hi:[0,0,1]
 v_cvt_pk_bf16_f32 v128, v16, v17
 v_cvt_pk_bf16_f32 v129, v18, v19
 v_cvt_pk_bf16_f32 v130, v20, v21
 v_cvt_pk_bf16_f32 v131, v22, v23
 s_nop 0
 v_permlane16_swap_b32 v128, v130
 v_permlane16_swap_b32 v129, v131
 buffer_store_dwordx4 v[128:131], v12, s[32:35], s59 offen
 v_cvt_pk_bf16_f32 v132, v24, v25
 v_cvt_pk_bf16_f32 v133, v26, v27
 v_cvt_pk_bf16_f32 v134, v28, v29
 v_cvt_pk_bf16_f32 v135, v30, v31
 s_nop 0
 v_permlane16_swap_b32 v132, v134
 v_permlane16_swap_b32 v133, v135
 s_add_u32 s59, s59, 8192
 buffer_store_dwordx4 v[132:135], v12, s[32:35], s59 offen
 v_cvt_pk_bf16_f32 v136, v32, v33
 v_cvt_pk_bf16_f32 v137, v34, v35
 v_cvt_pk_bf16_f32 v138, v36, v37
 v_cvt_pk_bf16_f32 v139, v38, v39
 s_nop 0
 v_permlane16_swap_b32 v136, v138
 v_permlane16_swap_b32 v137, v139
 s_add_u32 s59, s59, 8192
 buffer_store_dwordx4 v[136:139], v12, s[32:35], s59 offen
 v_cvt_pk_bf16_f32 v140, v40, v41
 v_cvt_pk_bf16_f32 v141, v42, v43
 v_cvt_pk_bf16_f32 v142, v44, v45
 v_cvt_pk_bf16_f32 v143, v46, v47
 s_nop 0
 v_permlane16_swap_b32 v140, v142
 v_permlane16_swap_b32 v141, v143
 s_add_u32 s59, s59, 8192
 buffer_store_dwordx4 v[140:143], v12, s[32:35], s59 offen
 s_lshl_b32 s48, s55, 11
 s_add_u32 s48, s48, 2048
 buffer_load_dword v11, v4, s[32:35], s48 offen sc1
 s_waitcnt vmcnt(9)
 v_permlane16_swap_b32 v192, v194
 v_permlane16_swap_b32 v193, v195
 v_permlane16_swap_b32 v196, v198
 v_permlane16_swap_b32 v197, v199
 v_permlane16_swap_b32 v200, v202
 v_permlane16_swap_b32 v201, v203
 v_permlane16_swap_b32 v204, v206
 v_permlane16_swap_b32 v205, v207
 v_lshlrev_b32 v16, 16, v192
 v_and_b32 v17, 0xffff0000, v192
 v_lshlrev_b32 v18, 16, v193
 v_and_b32 v19, 0xffff0000, v193
 v_lshlrev_b32 v20, 16, v194
 v_and_b32 v21, 0xffff0000, v194
 v_lshlrev_b32 v22, 16, v195
 v_and_b32 v23, 0xffff0000, v195
 v_lshlrev_b32 v24, 16, v196
 v_and_b32 v25, 0xffff0000, v196
 v_lshlrev_b32 v26, 16, v197
 v_and_b32 v27, 0xffff0000, v197
 v_lshlrev_b32 v28, 16, v198
 v_and_b32 v29, 0xffff0000, v198
 v_lshlrev_b32 v30, 16, v199
 v_and_b32 v31, 0xffff0000, v199
 v_lshlrev_b32 v32, 16, v200
 v_and_b32 v33, 0xffff0000, v200
 v_lshlrev_b32 v34, 16, v201
 v_and_b32 v35, 0xffff0000, v201
 v_lshlrev_b32 v36, 16, v202
 v_and_b32 v37, 0xffff0000, v202
 v_lshlrev_b32 v38, 16, v203
 v_and_b32 v39, 0xffff0000, v203
 v_lshlrev_b32 v40, 16, v204
 v_and_b32 v41, 0xffff0000, v204
 v_lshlrev_b32 v42, 16, v205
 v_and_b32 v43, 0xffff0000, v205
 v_lshlrev_b32 v44, 16, v206
 v_and_b32 v45, 0xffff0000, v206
 v_lshlrev_b32 v46, 16, v207
 v_and_b32 v47, 0xffff0000, v207
 s_waitcnt vmcnt(1)
 s_mov_b64 exec, 1
 buffer_store_dword v5, off, s[32:35], s57 offset:128
 s_mov_b64 exec, -1
 s_add_u32 s55, s55, 1
 s_cmp_lt_u32 s55, s56
 s_cbranch_scc1 L_rb_L
 s_waitcnt vmcnt(0)
 s_branch L_done
L_rb_G:
 s_lshl_b32 s57, s55, 11
 s_and_b32 s58, s55, 3
 s_lshl_b32 s58, s58, 17
 s_add_u32 s58, s58, s94
 s_waitcnt vmcnt(1)
 v_cmp_eq_u32 vcc, 0, v11
 s_cbranch_vccz L_rbseen_229
 s_mov_b32 s30, 0
L_pf_230:
 buffer_load_dword v2, v4, s[32:35], s57 offen sc1
 s_add_u32 s30, s30, 1
 s_cmp_gt_u32 s30, 524288
 s_cbranch_scc1 L_exit
 s_waitcnt vmcnt(0)
 v_cmp_eq_u32 vcc, 0, v2
 s_cbranch_vccz L_pfd_231
 s_sleep 1
 s_branch L_pf_230
L_pfd_231:
L_rbseen_229:
 buffer_load_dwordx4 v[128:131], v7, s[32:35], s58 offen offset:0 sc1
 buffer_load_dwordx4 v[132:135], v7, s[32:35], s58 offen offset:2048 sc1
 s_add_u32 s58, s58, 4096
 buffer_load_dwordx4 v[136:139], v7, s[32:35], s58 offen offset:0 sc1
 buffer_load_dwordx4 v[140:143], v7, s[32:35], s58 offen offset:2048 sc1
 s_add_u32 s58, s58, 4096
 buffer_load_dwordx4 v[144:147], v7, s[32:35], s58 offen offset:0 sc1
 buffer_load_dwordx4 v[148:151], v7, s[32:35], s58 offen offset:2048 sc1
 s_add_u32 s58, s58, 4096
 buffer_load_dwordx4 v[152:155], v7, s[32:35], s58 offen offset:0 sc1
 buffer_load_dwordx4 v[156:159], v7, s[32:35], s58 offen offset:2048 sc1
 s_add_u32 s58, s58, 4096
 buffer_load_dwordx4 v[160:163], v7, s[32:35], s58 offen offset:0 sc1
 buffer_load_dwordx4 v[164:167], v7, s[32:35], s58 offen offset:2048 sc1
 s_add_u32 s58, s58, 4096
 buffer_load_dwordx4 v[168:171], v7, s[32:35], s58 offen offset:0 sc1
 buffer_load_dwordx4 v[172:175], v7, s[32:35], s58 offen offset:2048 sc1
 s_add_u32 s58, s58, 4096
 buffer_load_dwordx4 v[176:179], v7, s[32:35], s58 offen offset:0 sc1
 buffer_load_dwordx4 v[180:183], v7, s[32:35], s58 offen offset:2048 sc1
 s_add_u32 s58, s58, 4096
 buffer_load_dwordx4 v[184:187], v7, s[32:35], s58 offen offset:0 sc1
 buffer_load_dwordx4 v[188:191], v7, s[32:35], s58 offen offset:2048 sc1
 s_and_b32 s48, s55, 63
 s_cmp_ge_u32 s48, 8
 s_cselect_b32 s76, 17536, 0
 s_sub_u32 s76, s57, s76
 s_add_u32 s76, s76, 1152
 buffer_load_dword v10, v9, s[32:35], s76 offen sc1
 s_add_u32 s48, s55, 1
 s_lshl_b32 s48, s48, 15
 s_add_u32 s48, s48, 0x1000000
 buffer_load_dwordx4 v[192:195], v8, s[32:35], s48 offen sc1
 s_add_u32 s48, s48, 8192
 buffer_load_dwordx4 v[196:199], v8, s[32:35], s48 offen sc1
 s_add_u32 s48, s48, 8192
 buffer_load_dwordx4 v[200:203], v8, s[32:35], s48 offen sc1
 s_add_u32 s48, s48, 8192
 buffer_load_dwordx4 v[204:207], v8, s[32:35], s48 offen sc1
 s_and_b32 s50, s55, 7
 s_lshl_b32 s50, s50, 17
 s_add_u32 s50, s50, s94
 s_add_u32 s50, s50, 0x80000
 s_add_u32 s59, s50, 0x8000
 s_lshl_b32 s48, s61, 2
 s_add_u32 s57, s57, s48
 s_waitcnt vmcnt(20)
 v_mfma_f32_16x16x32_bf16 v[16:19], v[104:107], v[128:131], v[16:19]
 s_waitcnt vmcnt(19)
 v_mfma_f32_16x16x32_bf16 v[16:19], v[108:111], v[132:135], v[16:19]
 s_waitcnt vmcnt(18)
 v_mfma_f32_16x16x32_bf16 v[20:23], v[104:107], v[136:139], v[20:23]
 s_waitcnt vmcnt(17)
 v_mfma_f32_16x16x32_bf16 v[20:23], v[108:111], v[140:143], v[20:23]
 s_waitcnt vmcnt(16)
 v_mfma_f32_16x16x32_bf16 v[24:27], v[104:107], v[144:147], v[24:27]
 s_waitcnt vmcnt(15)
 v_mfma_f32_16x16x32_bf16 v[24:27], v[108:111], v[148:151], v[24:27]
 v_cvt_pk_bf16_f32 v112, v16, v17
 v_cvt_pk_bf16_f32 v113, v18, v19
 s_waitcnt vmcnt(14)
 v_mfma_f32_16x16x32_bf16 v[28:31], v[104:107], v[152:155], v[28:31]
 s_waitcnt vmcnt(13)
 v_mfma_f32_16x16x32_bf16 v[28:31], v[108:111], v[156:159], v[28:31]
 v_cvt_pk_bf16_f32 v114, v20, v21
 v_cvt_pk_bf16_f32 v115, v22, v23
 s_waitcnt vmcnt(12)
 v_mfma_f32_16x16x32_bf16 v[32:35], v[104:107], v[160:163], v[32:35]
 s_waitcnt vmcnt(11)
 v_mfma_f32_16x16x32_bf16 v[32:35], v[108:111], v[164:167], v[32:35]
 v_cvt_pk_bf16_f32 v116, v24, v25
 v_cvt_pk_bf16_f32 v117, v26, v27
 s_waitcnt vmcnt(10)
 v_mfma_f32_16x16x32_bf16 v[36:39], v[104:107], v[168:171], v[36:39]
 s_waitcnt vmcnt(9)
 v_mfma_f32_16x16x32_bf16 v[36:39], v[108:111], v[172:175], v[36:39]
 v_cvt_pk_bf16_f32 v118, v28, v29
 v_cvt_pk_bf16_f32 v119, v30, v31
 s_waitcnt vmcnt(8)
 v_mfma_f32_16x16x32_bf16 v[40:43], v[104:107], v[176:179], v[40:43]
 s_waitcnt vmcnt(7)
 v_mfma_f32_16x16x32_bf16 v[40:43], v[108:111], v[180:183], v[40:43]
 v_cvt_pk_bf16_f32 v120, v32, v33
 v_cvt_pk_bf16_f32 v121, v34, v35
 s_waitcnt vmcnt(6)
 v_mfma_f32_16x16x32_bf16 v[44:47], v[104:107], v[184:187], v[44:47]
 s_waitcnt vmcnt(5)
 v_mfma_f32_16x16x32_bf16 v[44:47], v[108:111], v[188:191], v[44:47]
 v_cvt_pk_bf16_f32 v122, v36, v37
 v_cvt_pk_bf16_f32 v123, v38, v39
 s_waitcnt vmcnt(4)
 v_cmp_eq_u32 vcc, 0, v10
 s_cbranch_vccz L_crok_232
 s_mov_b32 s30, 0
L_pf_233:
 buffer_load_dword v10, v9, s[32:35], s76 offen sc1
 s_add_u32 s30, s30, 1
 s_cmp_gt_u32 s30, 524288
 s_cbranch_scc1 L_exit
 s_waitcnt vmcnt(0)
 v_cmp_eq_u32 vcc, 0, v10
 s_cbranch_vccz L_pfd_234
 s_sleep 2
 s_branch L_pf_233
L_pfd_234:
L_crok_232:
 v_cvt_pk_bf16_f32 v124, v40, v41
 v_cvt_pk_bf16_f32 v125, v42, v43
 v_nop_e64
 v_cvt_pk_bf16_f32 v126, v44, v45
 v_cvt_pk_bf16_f32 v127, v46, v47
 v_permlane16_swap_b32 v112, v114
 v_permlane16_swap_b32 v113, v115
 v_permlane16_swap_b32 v116, v118
 v_permlane16_swap_b32 v117, v119
 v_permlane16_swap_b32 v120, v122
 v_permlane16_swap_b32 v121, v123
 v_permlane16_swap_b32 v124, v126
 v_permlane16_swap_b32 v125, v127
 v_pk_add_f32 v[48:49], v[16:17], v[18:19]
 v_pk_mul_f32 v[52:53], v[16:17], v[16:17]
 v_pk_fma_f32 v[52:53], v[18:19], v[18:19], v[52:53]
 v_pk_add_f32 v[48:49], v[48:49], v[20:21]
 v_pk_fma_f32 v[52:53], v[20:21], v[20:21], v[52:53]
 v_pk_add_f32 v[48:49], v[48:49], v[22:23]
 v_pk_fma_f32 v[52:53], v[22:23], v[22:23], v[52:53]
 v_pk_add_f32 v[48:49], v[48:49], v[24:25]
 v_pk_fma_f32 v[52:53], v[24:25], v[24:25], v[52:53]
 v_pk_add_f32 v[48:49], v[48:49], v[26:27]
 v_pk_fma_f32 v[52:53], v[26:27], v[26:27], v[52:53]
 v_pk_add_f32 v[48:49], v[48:49], v[28:29]
 v_pk_fma_f32 v[52:53], v[28:29], v[28:29], v[52:53]
 v_pk_add_f32 v[48:49], v[48:49], v[30:31]
 v_pk_fma_f32 v[52:53], v[30:31], v[30:31], v[52:53]
 v_pk_add_f32 v[48:49], v[48:49], v[32:33]
 v_pk_fma_f32 v[52:53], v[32:33], v[32:33], v[52:53]
 v_pk_add_f32 v[48:49], v[48:49], v[34:35]
 v_pk_fma_f32 v[52:53], v[34:35], v[34:35], v[52:53]
 v_pk_add_f32 v[48:49], v[48:49], v[36:37]
 v_pk_fma_f32 v[52:53], v[36:37], v[36:37], v[52:53]
 v_pk_add_f32 v[48:49], v[48:49], v[38:39]
 v_pk_fma_f32 v[52:53], v[38:39], v[38:39], v[52:53]
 v_pk_add_f32 v[48:49], v[48:49], v[40:41]
 v_pk_fma_f32 v[52:53], v[40:41], v[40:41], v[52:53]
 v_pk_add_f32 v[48:49], v[48:49], v[42:43]
 v_pk_fma_f32 v[52:53], v[42:43], v[42:43], v[52:53]
 v_pk_add_f32 v[48:49], v[48:49], v[44:45]
 v_pk_fma_f32 v[52:53], v[44:45], v[44:45], v[52:53]
 v_pk_add_f32 v[48:49], v[48:49], v[46:47]
 v_pk_fma_f32 v[52:53], v[46:47], v[46:47], v[52:53]
 v_add_f32 v48, v48, v49
 v_add_f32 v52, v52, v53
 buffer_store_dwordx4 v[112:115], v12, s[32:35], s50 offen sc1
 v_add_f32_dpp v48, v48, v48 row_ror:4 row_mask:0xf bank_mask:0xf
 v_add_f32_dpp v52, v52, v52 row_ror:4 row_mask:0xf bank_mask:0xf
 s_add_u32 s50, s50, 8192
 buffer_store_dwordx4 v[116:119], v12, s[32:35], s50 offen sc1
 v_add_f32_dpp v48, v48, v48 row_ror:8 row_mask:0xf bank_mask:0xf
 v_add_f32_dpp v52, v52, v52 row_ror:8 row_mask:0xf bank_mask:0xf
 v_mov_b32 v50, v48
 v_mov_b32 v54, v52
 s_add_u32 s50, s50, 8192
 buffer_store_dwordx4 v[120:123], v12, s[32:35], s50 offen sc1
 v_permlane16_swap_b32 v48, v50
 v_permlane16_swap_b32 v52, v54
 v_add_f32 v48, v48, v50
 v_add_f32 v52, v52, v54
 v_mov_b32 v50, v48
 v_mov_b32 v54, v52
 s_add_u32 s50, s50, 8192
 buffer_store_dwordx4 v[124:127], v12, s[32:35], s50 offen sc1
 v_permlane32_swap_b32 v48, v50
 v_permlane32_swap_b32 v52, v54
 v_add_f32 v48, v48, v50
 v_add_f32 v52, v52, v54
 v_mul_f32 v48, 0x3b000000, v48
 v_mul_f32 v52, 0x3b000000, v52
 v_fma_f32 v52, -v48, v48, v52
 v_max_f32_e64 v52, 0, v52
 v_cvt_pk_bf16_f32 v48, v48, v48
 v_and_b32 v48, 0xffff0000, v48
 v_cvt_pk_bf16_f32 v52, v52, v52
 v_and_b32 v52, 0xffff0000, v52
 v_add_f32 v52, 0x3727c5ac, v52
 v_cvt_pk_bf16_f32 v52, v52, v52
 v_and_b32 v52, 0xffff0000, v52
 v_sqrt_f32 v52, v52
 s_nop 0
 v_cvt_pk_bf16_f32 v52, v52, v52
 v_and_b32 v52, 0xffff0000, v52
 v_rcp_f32 v52, v52
 s_nop 0
 v_mul_f32_e64 v48, v48, v52
 v_pk_fma_f32 v[16:17], v[16:17], v[52:53], v[48:49] op_sel_hi:[1,0,0] neg_lo:[0,0,1] neg_hi:[0,0,1]
 v_pk_fma_f32 v[18:19], v[18:19], v[52:53], v[48:49] op_sel_hi:[1,0,0] neg_lo:[0,0,1] neg_hi:[0,0,1]
 v_pk_fma_f32 v[20:21], v[20:21], v[52:53], v[48:49] op_sel_hi:[1,0,0] neg_lo:[0,0,1] neg_hi:[0,0,1]
 v_pk_fma_f32 v[22:23], v[22:23], v[52:53], v[48:49] op_sel_hi:[1,0,0] neg_lo:[0,0,1] neg_hi:[0,0,1]
 v_pk_fma_f32 v[24:25], v[24:25], v[52:53], v[48:49] op_sel_hi:[1,0,0] neg_lo:[0,0,1] neg_hi:[0,0,1]
 v_pk_fma_f32 v[26:27], v[26:27], v[52:53], v[48:49] op_sel_hi:[1,0,0] neg_lo:[0,0,1] neg_hi:[0,0,1]
 v_pk_fma_f32 v[28:29], v[28:29], v[52:53], v[48:49] op_sel_hi:[1,0,0] neg_lo:[0,0,1] neg_hi:[0,0,1]
 v_pk_fma_f32 v[30:31], v[30:31], v[52:53], v[48:49] op_sel_hi:[1,0,0] neg_lo:[0,0,1] neg_hi:[0,0,1]
 v_pk_fma_f32 v[32:33], v[32:33], v[52:53], v[48:49] op_sel_hi:[1,0,0] neg_lo:[0,0,1] neg_hi:[0,0,1]
 v_pk_fma_f32 v[34:35], v[34:35], v[52:53], v[48:49] op_sel_hi:[1,0,0] neg_lo:[0,0,1] neg_hi:[0,0,1]
 v_pk_fma_f32 v[36:37], v[36:37], v[52:53], v[48:49] op_sel_hi:[1,0,0] neg_lo:[0,0,1] neg_hi:[0,0,1]
 v_pk_fma_f32 v[38:39], v[38:39], v[52:53], v[48:49] op_sel_hi:[1,0,0] neg_lo:[0,0,1] neg_hi:[0,0,1]
 v_pk_fma_f32 v[40:41], v[40:41], v[52:53], v[48:49] op_sel_hi:[1,0,0] neg_lo:[0,0,1] neg_hi:[0,0,1]
 v_pk_fma_f32 v[42:43], v[42:43], v[52:53], v[48:49] op_sel_hi:[1,0,0] neg_lo:[0,0,1] neg_hi:[0,0,1]
 v_pk_fma_f32 v[44:45], v[44:45], v[52:53], v[48:49] op_sel_hi:[1,0,0] neg_lo:[0,0,1] neg_hi:[0,0,1]
 v_pk_fma_f32 v[46:47], v[46:47], v[52:53], v[48:49] op_sel_hi:[1,0,0] neg_lo:[0,0,1] neg_hi:[0,0,1]
 v_cvt_pk_bf16_f32 v128, v16, v17
 v_cvt_pk_bf16_f32 v129, v18, v19
 v_cvt_pk_bf16_f32 v130, v20, v21
 v_cvt_pk_bf16_f32 v131, v22, v23
 s_nop 0
 v_permlane16_swap_b32 v128, v130
 v_permlane16_swap_b32 v129, v131
 buffer_store_dwordx4 v[128:131], v12, s[32:35], s59 offen sc1
 v_cvt_pk_bf16_f32 v132, v24, v25
 v_cvt_pk_bf16_f32 v133, v26, v27
 v_cvt_pk_bf16_f32 v134, v28, v29
 v_cvt_pk_bf16_f32 v135, v30, v31
 s_nop 0
 v_permlane16_swap_b32 v132, v134
 v_permlane16_swap_b32 v133, v135
 s_add_u32 s59, s59, 8192
 buffer_store_dwordx4 v[132:135], v12, s[32:35], s59 offen sc1
 v_cvt_pk_bf16_f32 v136, v32, v33
 v_cvt_pk_bf16_f32 v137, v34, v35
 v_cvt_pk_bf16_f32 v138, v36, v37
 v_cvt_pk_bf16_f32 v139, v38, v39
 s_nop 0
 v_permlane16_swap_b32 v136, v138
 v_permlane16_swap_b32 v137, v139
 s_add_u32 s59, s59, 8192
 buffer_store_dwordx4 v[136:139], v12, s[32:35], s59 offen sc1
 v_cvt_pk_bf16_f32 v140, v40, v41
 v_cvt_pk_bf16_f32 v141, v42, v43
 v_cvt_pk_bf16_f32 v142, v44, v45
 v_cvt_pk_bf16_f32 v143, v46, v47
 s_nop 0
 v_permlane16_swap_b32 v140, v142
 v_permlane16_swap_b32 v141, v143
 s_add_u32 s59, s59, 8192
 buffer_store_dwordx4 v[140:143], v12, s[32:35], s59 offen sc1
 s_lshl_b32 s48, s55, 11
 s_add_u32 s48, s48, 2048
 buffer_load_dword v11, v4, s[32:35], s48 offen sc1
 s_waitcnt vmcnt(9)
 v_permlane16_swap_b32 v192, v194
 v_permlane16_swap_b32 v193, v195
 v_permlane16_swap_b32 v196, v198
 v_permlane16_swap_b32 v197, v199
 v_permlane16_swap_b32 v200, v202
 v_permlane16_swap_b32 v201, v203
 v_permlane16_swap_b32 v204, v206
 v_permlane16_swap_b32 v205, v207
 v_lshlrev_b32 v16, 16, v192
 v_and_b32 v17, 0xffff0000, v192
 v_lshlrev_b32 v18, 16, v193
 v_and_b32 v19, 0xffff0000, v193
 v_lshlrev_b32 v20, 16, v194
 v_and_b32 v21, 0xffff0000, v194
 v_lshlrev_b32 v22, 16, v195
 v_and_b32 v23, 0xffff0000, v195
 v_lshlrev_b32 v24, 16, v196
 v_and_b32 v25, 0xffff0000, v196
 v_lshlrev_b32 v26, 16, v197
 v_and_b32 v27, 0xffff0000, v197
 v_lshlrev_b32 v28, 16, v198
 v_and_b32 v29, 0xffff0000, v198
 v_lshlrev_b32 v30, 16, v199
 v_and_b32 v31, 0xffff0000, v199
 v_lshlrev_b32 v32, 16, v200
 v_and_b32 v33, 0xffff0000, v200
 v_lshlrev_b32 v34, 16, v201
 v_and_b32 v35, 0xffff0000, v201
 v_lshlrev_b32 v36, 16, v202
 v_and_b32 v37, 0xffff0000, v202
 v_lshlrev_b32 v38, 16, v203
 v_and_b32 v39, 0xffff0000, v203
 v_lshlrev_b32 v40, 16, v204
 v_and_b32 v41, 0xffff0000, v204
 v_lshlrev_b32 v42, 16, v205
 v_and_b32 v43, 0xffff0000, v205
 v_lshlrev_b32 v44, 16, v206
 v_and_b32 v45, 0xffff0000, v206
 v_lshlrev_b32 v46, 16, v207
 v_and_b32 v47, 0xffff0000, v207
 s_waitcnt vmcnt(1)
 s_mov_b64 exec, 1
 buffer_store_dword v5, off, s[32:35], s57 offset:128 sc1
 s_mov_b64 exec, -1
 s_add_u32 s55, s55, 1
 s_cmp_lt_u32 s55, s56
 s_cbranch_scc1 L_rb_G
 s_waitcnt vmcnt(0)
 s_branch L_done
L_re:
 v_and_b32 v4, 15, v0
 v_lshlrev_b32 v4, 2, v4
 v_add_u32 v4, 384, v4
 s_lshl_b32 s49, s48, 10
 v_lshl_add_u32 v12, v96, 4, s49
 v_lshl_add_u32 v12, v97, 11, v12
 v_lshrrev_b32 v100, 1, v97
 v_lshl_add_u32 v8, v100, 12, v102
 s_mul_i32 s48, s45, 49152
 s_mul_i32 s49, s46, 12288
 s_add_u32 s48, s48, s49
 s_add_u32 s48, s48, s94
 buffer_load_dwordx4 v[100:103], v1, s[32:35], s48 offen offset:0 sc1
 buffer_load_dwordx4 v[100:103], v1, s[32:35], s48 offen offset:1024 sc1
 buffer_load_dwordx4 v[100:103], v1, s[32:35], s48 offen offset:2048 sc1
 buffer_load_dwordx4 v[100:103], v1, s[32:35], s48 offen offset:3072 sc1
 s_add_u32 s48, s48, 4096
 buffer_load_dwordx4 v[100:103], v1, s[32:35], s48 offen offset:0 sc1
 buffer_load_dwordx4 v[100:103], v1, s[32:35], s48 offen offset:1024 sc1
 buffer_load_dwordx4 v[100:103], v1, s[32:35], s48 offen offset:2048 sc1
 buffer_load_dwordx4 v[100:103], v1, s[32:35], s48 offen offset:3072 sc1
 s_add_u32 s48, s48, 4096
 buffer_load_dwordx4 v[100:103], v1, s[32:35], s48 offen offset:0 sc1
 buffer_load_dwordx4 v[100:103], v1, s[32:35], s48 offen offset:1024 sc1
 buffer_load_dwordx4 v[100:103], v1, s[32:35], s48 offen offset:2048 sc1
 buffer_load_dwordx4 v[100:103], v1, s[32:35], s48 offen offset:3072 sc1
 s_waitcnt vmcnt(0)
 s_cmp_eq_u32 s47, 1
 s_cbranch_scc1 L_exit
 s_mov_b32 s55, 0
 s_mov_b32 s56, 64
 s_mov_b32 s30, 0
L_winit_235:
 v_mov_b32 v124, 0
 global_load_dword v125, v124, s[26:27] offset:192 sc1
L_wchk_237:
 s_add_u32 s30, s30, 1
 s_cmp_gt_u32 s30, 524288
 s_cbranch_scc1 L_exit
 s_waitcnt vmcnt(0)
 v_readfirstlane_b32 s54, v125
 s_nop 0
 s_cmp_lg_u32 s54, 0
 s_cbranch_scc1 L_wdone_236
 s_sleep 8
 s_branch L_winit_235
L_wdone_236:
 s_lshr_b32 s3, s54, s44
 s_and_b32 s3, s3, 1
 s_barrier
L_re_loop:
 s_lshl_b32 s57, s55, 11
 s_and_b32 s58, s55, 7
 s_lshl_b32 s58, s58, 17
 s_add_u32 s58, s58, s94
 s_add_u32 s58, s58, 0x98000
 s_mov_b32 s30, 0
L_pf_238:
 buffer_load_dword v2, v4, s[32:35], s57 offen sc1
 s_add_u32 s30, s30, 1
 s_cmp_gt_u32 s30, 524288
 s_cbranch_scc1 L_exit
 s_waitcnt vmcnt(0)
 v_cmp_eq_u32 vcc, 0, v2
 s_cbranch_vccz L_pfd_239
 s_sleep 1
 s_branch L_pf_238
L_pfd_239:
 buffer_load_dwordx4 v[112:115], v8, s[32:35], s58 offen offset:0 sc1
 buffer_load_dwordx4 v[116:119], v8, s[32:35], s58 offen offset:1024 sc1
 buffer_load_dwordx4 v[120:123], v8, s[32:35], s58 offen offset:2048 sc1
 buffer_load_dwordx4 v[124:127], v8, s[32:35], s58 offen offset:3072 sc1
 s_lshl_b32 s48, s55, 15
 s_add_u32 s59, s48, 0x1600000
 s_add_u32 s58, s48, 0x1200000
 s_lshl_b32 s48, s61, 2
 s_add_u32 s57, s57, s48
 s_add_u32 s57, s57, 131072
 s_waitcnt vmcnt(0)
 v_lshlrev_b32 v16, 16, v112
 v_and_b32 v17, 0xffff0000, v112
 v_lshlrev_b32 v18, 16, v113
 v_and_b32 v19, 0xffff0000, v113
 v_lshlrev_b32 v20, 16, v114
 v_and_b32 v21, 0xffff0000, v114
 v_lshlrev_b32 v22, 16, v115
 v_and_b32 v23, 0xffff0000, v115
 v_lshlrev_b32 v24, 16, v116
 v_and_b32 v25, 0xffff0000, v116
 v_lshlrev_b32 v26, 16, v117
 v_and_b32 v27, 0xffff0000, v117
 v_lshlrev_b32 v28, 16, v118
 v_and_b32 v29, 0xffff0000, v118
 v_lshlrev_b32 v30, 16, v119
 v_and_b32 v31, 0xffff0000, v119
 v_lshlrev_b32 v32, 16, v120
 v_and_b32 v33, 0xffff0000, v120
 v_lshlrev_b32 v34, 16, v121
 v_and_b32 v35, 0xffff0000, v121
 v_lshlrev_b32 v36, 16, v122
 v_and_b32 v37, 0xffff0000, v122
 v_lshlrev_b32 v38, 16, v123
 v_and_b32 v39, 0xffff0000, v123
 v_lshlrev_b32 v40, 16, v124
 v_and_b32 v41, 0xffff0000, v124
 v_lshlrev_b32 v42, 16, v125
 v_and_b32 v43, 0xffff0000, v125
 v_lshlrev_b32 v44, 16, v126
 v_and_b32 v45, 0xffff0000, v126
 v_lshlrev_b32_e64 v46, 16, v127
 v_and_b32 v47, 0xffff0000, v127
 v_pk_add_f32 v[48:49], v[16:17], v[18:19]
 v_pk_mul_f32 v[52:53], v[16:17], v[16:17]
 v_pk_fma_f32 v[52:53], v[18:19], v[18:19], v[52:53]
 v_pk_add_f32 v[48:49], v[48:49], v[20:21]
 v_pk_fma_f32 v[52:53], v[20:21], v[20:21], v[52:53]
 v_pk_add_f32 v[48:49], v[48:49], v[22:23]
 v_pk_fma_f32 v[52:53], v[22:23], v[22:23], v[52:53]
 v_pk_add_f32 v[48:49], v[48:49], v[24:25]
 v_pk_fma_f32 v[52:53], v[24:25], v[24:25], v[52:53]
 v_pk_add_f32 v[48:49], v[48:49], v[26:27]
 v_pk_fma_f32 v[52:53], v[26:27], v[26:27], v[52:53]
 v_pk_add_f32 v[48:49], v[48:49], v[28:29]
 v_pk_fma_f32 v[52:53], v[28:29], v[28:29], v[52:53]
 v_pk_add_f32 v[48:49], v[48:49], v[30:31]
 v_pk_fma_f32 v[52:53], v[30:31], v[30:31], v[52:53]
 v_pk_add_f32 v[48:49], v[48:49], v[32:33]
 v_pk_fma_f32 v[52:53], v[32:33], v[32:33], v[52:53]
 v_pk_add_f32 v[48:49], v[48:49], v[34:35]
 v_pk_fma_f32 v[52:53], v[34:35], v[34:35], v[52:53]
 v_pk_add_f32 v[48:49], v[48:49], v[36:37]
 v_pk_fma_f32 v[52:53], v[36:37], v[36:37], v[52:53]
 v_pk_add_f32 v[48:49], v[48:49], v[38:39]
 v_pk_fma_f32 v[52:53], v[38:39], v[38:39], v[52:53]
 v_pk_add_f32 v[48:49], v[48:49], v[40:41]
 v_pk_fma_f32 v[52:53], v[40:41], v[40:41], v[52:53]
 v_pk_add_f32 v[48:49], v[48:49], v[42:43]
 v_pk_fma_f32 v[52:53], v[42:43], v[42:43], v[52:53]
 v_pk_add_f32 v[48:49], v[48:49], v[44:45]
 v_pk_fma_f32 v[52:53], v[44:45], v[44:45], v[52:53]
 v_pk_add_f32 v[48:49], v[48:49], v[46:47]
 v_pk_fma_f32 v[52:53], v[46:47], v[46:47], v[52:53]
 v_add_f32 v48, v48, v49
 v_add_f32 v52, v52, v53
 v_nop_e64
 v_add_f32_dpp v48, v48, v48 row_ror:4 row_mask:0xf bank_mask:0xf
 v_add_f32_dpp v52, v52, v52 row_ror:4 row_mask:0xf bank_mask:0xf
 v_nop_e64
 v_add_f32_dpp v48, v48, v48 row_ror:8 row_mask:0xf bank_mask:0xf
 v_add_f32_dpp v52, v52, v52 row_ror:8 row_mask:0xf bank_mask:0xf
 v_mov_b32 v50, v48
 v_mov_b32 v54, v52
 s_nop 0
 v_permlane16_swap_b32 v48, v50
 v_permlane16_swap_b32 v52, v54
 v_add_f32 v48, v48, v50
 v_add_f32 v52, v52, v54
 v_mov_b32 v50, v48
 v_mov_b32 v54, v52
 s_nop 0
 v_permlane32_swap_b32 v48, v50
 v_permlane32_swap_b32 v52, v54
 v_add_f32 v48, v48, v50
 v_add_f32 v52, v52, v54
 v_mul_f32 v48, 0x3b000000, v48
 v_mul_f32 v52, 0x3b000000, v52
 v_fma_f32 v52, -v48, v48, v52
 v_max_f32_e64 v52, 0, v52
 v_cvt_pk_bf16_f32 v48, v48, v48
 v_and_b32 v48, 0xffff0000, v48
 v_cvt_pk_bf16_f32 v52, v52, v52
 v_and_b32 v52, 0xffff0000, v52
 v_add_f32 v52, 0x3727c5ac, v52
 v_cvt_pk_bf16_f32 v52, v52, v52
 v_and_b32 v52, 0xffff0000, v52
 v_sqrt_f32 v52, v52
 s_nop 0
 v_cvt_pk_bf16_f32 v52, v52, v52
 v_and_b32 v52, 0xffff0000, v52
 v_rcp_f32 v52, v52
 s_nop 0
 v_mul_f32_e64 v48, v48, v52
 v_pk_fma_f32 v[16:17], v[16:17], v[52:53], v[48:49] op_sel_hi:[1,0,0] neg_lo:[0,0,1] neg_hi:[0,0,1]
 v_pk_fma_f32 v[18:19], v[18:19], v[52:53], v[48:49] op_sel_hi:[1,0,0] neg_lo:[0,0,1] neg_hi:[0,0,1]
 v_pk_fma_f32 v[20:21], v[20:21], v[52:53], v[48:49] op_sel_hi:[1,0,0] neg_lo:[0,0,1] neg_hi:[0,0,1]
 v_pk_fma_f32 v[22:23], v[22:23], v[52:53], v[48:49] op_sel_hi:[1,0,0] neg_lo:[0,0,1] neg_hi:[0,0,1]
 v_pk_fma_f32 v[24:25], v[24:25], v[52:53], v[48:49] op_sel_hi:[1,0,0] neg_lo:[0,0,1] neg_hi:[0,0,1]
 v_pk_fma_f32 v[26:27], v[26:27], v[52:53], v[48:49] op_sel_hi:[1,0,0] neg_lo:[0,0,1] neg_hi:[0,0,1]
 v_pk_fma_f32 v[28:29], v[28:29], v[52:53], v[48:49] op_sel_hi:[1,0,0] neg_lo:[0,0,1] neg_hi:[0,0,1]
 v_pk_fma_f32 v[30:31], v[30:31], v[52:53], v[48:49] op_sel_hi:[1,0,0] neg_lo:[0,0,1] neg_hi:[0,0,1]
 v_pk_fma_f32 v[32:33], v[32:33], v[52:53], v[48:49] op_sel_hi:[1,0,0] neg_lo:[0,0,1] neg_hi:[0,0,1]
 v_pk_fma_f32 v[34:35], v[34:35], v[52:53], v[48:49] op_sel_hi:[1,0,0] neg_lo:[0,0,1] neg_hi:[0,0,1]
 v_pk_fma_f32 v[36:37], v[36:37], v[52:53], v[48:49] op_sel_hi:[1,0,0] neg_lo:[0,0,1] neg_hi:[0,0,1]
 v_pk_fma_f32 v[38:39], v[38:39], v[52:53], v[48:49] op_sel_hi:[1,0,0] neg_lo:[0,0,1] neg_hi:[0,0,1]
 v_pk_fma_f32 v[40:41], v[40:41], v[52:53], v[48:49] op_sel_hi:[1,0,0] neg_lo:[0,0,1] neg_hi:[0,0,1]
 v_pk_fma_f32 v[42:43], v[42:43], v[52:53], v[48:49] op_sel_hi:[1,0,0] neg_lo:[0,0,1] neg_hi:[0,0,1]
 v_pk_fma_f32 v[44:45], v[44:45], v[52:53], v[48:49] op_sel_hi:[1,0,0] neg_lo:[0,0,1] neg_hi:[0,0,1]
 v_pk_fma_f32 v[46:47], v[46:47], v[52:53], v[48:49] op_sel_hi:[1,0,0] neg_lo:[0,0,1] neg_hi:[0,0,1]
 v_cvt_pk_bf16_f32 v128, v16, v32
 v_cvt_pk_bf16_f32 v129, v24, v40
 v_cvt_pk_bf16_f32 v130, v17, v33
 v_cvt_pk_bf16_f32 v131, v25, v41
 buffer_store_dwordx4 v[128:131], v12, s[32:35], s59 offen offset:0 sc1
 v_cvt_pk_bf16_f32 v132, v18, v34
 v_cvt_pk_bf16_f32 v133, v26, v42
 v_cvt_pk_bf16_f32 v134, v19, v35
 v_cvt_pk_bf16_f32 v135, v27, v43
 buffer_store_dwordx4 v[132:135], v12, s[32:35], s59 offen offset:256 sc1
 v_cvt_pk_bf16_f32 v136, v20, v36
 v_cvt_pk_bf16_f32 v137, v28, v44
 v_cvt_pk_bf16_f32 v138, v21, v37
 v_cvt_pk_bf16_f32 v139, v29, v45
 buffer_store_dwordx4 v[136:139], v12, s[32:35], s59 offen offset:512 sc1
 v_cvt_pk_bf16_f32 v140, v22, v38
 v_cvt_pk_bf16_f32 v141, v30, v46
 v_cvt_pk_bf16_f32 v142, v23, v39
 v_cvt_pk_bf16_f32 v143, v31, v47
 buffer_store_dwordx4 v[140:143], v12, s[32:35], s59 offen offset:768 sc1
 s_waitcnt vmcnt(0)
 s_mov_b64 exec, 1
 buffer_store_dword v5, off, s[32:35], s57 offset:0 sc1
 s_mov_b64 exec, -1
 s_add_u32 s55, s55, 1
 s_cmp_lt_u32 s55, s56
 s_cbranch_scc1 L_re_loop
 s_waitcnt vmcnt(0)
 s_branch L_done
L_codeend:
 s_endpgm
.section .rodata,"a"
.p2align 6
.amdhsa_kernel interleave_layers__memory_aug_recurrent_mem_tr__sliding_local_dilated__prompt_kernel
  .amdhsa_next_free_vgpr 512
  .amdhsa_next_free_sgpr 102
  .amdhsa_accum_offset 256
  .amdhsa_group_segment_fixed_size 0
  .amdhsa_kernarg_size 104
  .amdhsa_user_sgpr_count 2
  .amdhsa_user_sgpr_kernarg_segment_ptr 1
  .amdhsa_system_sgpr_workgroup_id_x 1
  .amdhsa_float_denorm_mode_32 3
.end_amdhsa_kernel
```
